```python
import torch

def _softmax(x, axis=-1):
    return torch.softmax(x, dim=axis)
def _gelu(x):
    return torch.nn.functional.gelu(x, approximate="tanh")
def _silu(x):
    return torch.nn.functional.silu(x)
def _sigmoid(x):
    return torch.sigmoid(x)
def _layernorm(x, axis=-1, eps=1e-5):
    m = x.mean(dim=axis, keepdim=True)
    v = x.var(dim=axis, keepdim=True, unbiased=False)
    return (x - m) / torch.sqrt(v + eps)
def _scatter_add(tgt, idx, src, axis=0):
    return tgt.clone().index_add_(axis, idx, src)
def _segment_sum(src, seg, n):
    out = torch.zeros((n,) + src.shape[1:], dtype=src.dtype)
    return out.index_add_(0, seg, src)
def _pad(x, pw):
    flat = tuple(v for pair in reversed(pw) for v in pair)
    return torch.nn.functional.pad(x, flat)

kernel_name = 'parallel_sum__ssm_conv_s4d__dense_activation_silu__prompt'

def setup_inputs():

    _w = (lambda a: (lambda t: t.to(torch.bfloat16) if t.is_floating_point() else t)(torch.as_tensor(a)))
    def _A_setup():
        Bsz, L, D, N = 1, 2048, 576, 128
        return {
            "u": _w((lambda *s: torch.randn(*s, dtype=torch.bfloat16) * 0.05)(Bsz, L, D)),
            "log_A_real": _w((lambda *s: torch.randn(*s, dtype=torch.bfloat16) * 3.2)(D, N) * 0.5),
            "A_imag": _w((lambda *s: torch.randn(*s, dtype=torch.bfloat16) * 0.05)(D, N) * 3.14),
            "C_real": _w((lambda *s: torch.randn(*s, dtype=torch.bfloat16) * 0.2)(D, N) / N ** 0.5),
            "C_imag": _w((lambda *s: torch.randn(*s, dtype=torch.bfloat16) * 0.2)(D, N) / N ** 0.5),
            "log_dt": _w((lambda *s: torch.randn(*s, dtype=torch.bfloat16) * 0.05)(D) * 0.5 - 4.0),
            "D_skip": _w((lambda *s: torch.randn(*s, dtype=torch.bfloat16) * 0.05)(D)),
        }
    _A_in = _A_setup()

    def _B_setup():
        B, S, D, F = 1, 2048, 576, 4608
        return {
            "x": _w((lambda *s: torch.randn(*s, dtype=torch.bfloat16) * 0.05)(B, S, D)),
            "w1": _w((lambda *s: torch.randn(*s, dtype=torch.bfloat16) * 0.8)(D, F) * (D ** -0.5)),
            "w2": _w((lambda *s: torch.randn(*s, dtype=torch.bfloat16) * 0.2)(F, D) * (F ** -0.5)),
        }
    _B_in = _B_setup()

    return {
        "A_u": _A_in["u"],
        "A_log_A_real": _A_in["log_A_real"],
        "A_A_imag": _A_in["A_imag"],
        "A_C_real": _A_in["C_real"],
        "A_C_imag": _A_in["C_imag"],
        "A_log_dt": _A_in["log_dt"],
        "A_D_skip": _A_in["D_skip"],
        "B_x": _B_in["x"],
        "B_w1": _B_in["w1"],
        "B_w2": _B_in["w2"],
    }

def reference(A_u, A_log_A_real, A_A_imag, A_C_real, A_C_imag, A_log_dt, A_D_skip, B_x, B_w1, B_w2):
    def _A_ref(u, log_A_real, A_imag, C_real, C_imag, log_dt, D_skip):
        L = u.shape[1]
        dt = torch.exp(log_dt)
        A = -torch.exp(log_A_real) + 1j * A_imag
        C = (C_real + 1j * C_imag) * dt[:, None]
        pos = (lambda x, dt: x.to(dt))(torch.arange(L), log_dt.dtype)
        P = torch.exp((A * dt[:, None])[:, :, None] * pos[None, None, :])
        K = 2.0 * torch.einsum("dn,dnl->dl", C, P).real
        L2 = 2 * L
        u_t = (lambda x, *d: x.permute(*d))(u, 0, 2, 1)
        Kf = (lambda x, *a, **k: torch.fft.rfft(x.float(), *a, **k))(K, L2)
        Uf = (lambda x, *a, **k: torch.fft.rfft(x.float(), *a, **k))(u_t, L2)
        y = (lambda x, *a, **k: torch.fft.irfft(x, *a, **k).to(torch.bfloat16))(Uf * Kf[None, :, :], L2)[:, :, :L]
        y = (lambda x, *d: x.permute(*d))(y, 0, 2, 1)
        return y + u * D_skip[None, None, :]

    def _B_ref(x, w1, w2):
        h = torch.einsum("bsd,df->bsf", x, w1)
        h = _silu(h)
        out = torch.einsum("bsf,fd->bsd", h, w2)
        return out

    x = A_u
    xn = _layernorm(x, axis=-1)
    return x + _A_ref(xn, A_log_A_real, A_A_imag, A_C_real, A_C_imag, A_log_dt, A_D_skip) + _B_ref(xn, B_w1, B_w2)
```

```asm
; @launch grid=(256,1,1) block=(256,1,1) lds=155392
.amdgcn_target "amdgcn-amd-amdhsa--gfx950"
.text
.globl parallel_sum__ssm_conv_s4d__dense_activation_silu__prompt_kernel
.p2align 8
.type parallel_sum__ssm_conv_s4d__dense_activation_silu__prompt_kernel,@function
parallel_sum__ssm_conv_s4d__dense_activation_silu__prompt_kernel:
L_pc0:
    s_load_dwordx16 s[4:19], s[0:1], 0
    s_load_dwordx8 s[20:27], s[0:1], 64
    s_load_dwordx2 s[28:29], s[0:1], 96
    v_readfirstlane_b32 s30, v0
    s_and_b32 s33, s2, 7
    s_lshr_b32 s34, s2, 3
    s_cmp_ge_u32 s34, 24
    s_cbranch_scc1 L_other
    s_lshr_b32 s35, s34, 3
    s_mul_i32 s31, s33, 3
    s_add_u32 s31, s31, s35
    s_and_b32 s32, s34, 7
    s_mul_i32 s85, s31, 92160
    s_mul_i32 s35, s32, 11520
    s_add_u32 s35, s35, s85
    s_add_u32 s85, s85, s30
    v_bfe_u32 v28, v0, 2, 4
    v_and_b32 v29, 3, v0
    v_lshlrev_b32 v2, 4, v29
    s_movk_i32 s34, 1152
    v_mad_u32_u24 v250, v28, s34, v2
    v_lshlrev_b32 v1, 7, v0
    s_bitcmp1_b32 s30, 7
    s_waitcnt lgkmcnt(0)
    s_mov_b32 s6, 2359296
    s_mov_b32 s7, 0x20000
    s_cbranch_scc1 L_notouch
    buffer_load_dword v252, v1, s[4:7], s35 offen
L_notouch:
    buffer_load_dwordx4 v[160:163], v250, s[4:7], s85 offen offset:0
    buffer_load_dwordx4 v[180:183], v250, s[4:7], s85 offen offset:256
    buffer_load_dwordx4 v[200:203], v250, s[4:7], s85 offen offset:512
    buffer_load_dwordx4 v[220:223], v250, s[4:7], s85 offen offset:768
    v_lshlrev_b32 v2, 3, v29
    s_lshr_b32 s34, s30, 1
    s_sub_u32 s34, 1024, s34
    v_sub_u32 v251, v250, v2
    v_add_u32 v251, s34, v251
    buffer_load_dwordx2 v[240:241], v251, s[4:7], s85 offen
    s_lshr_b32 s30, s30, 6
    v_and_b32 v13, 63, v0
    v_and_b32 v14, 15, v0
    v_bfe_u32 v15, v0, 4, 2
    s_getpc_b64 s[94:95]
L_pcX:
    s_add_u32 s94, s94, L_pc0 - L_pcX
    s_addc_u32 s95, s95, -1
    s_lshr_b32 s33, s2, 3
    s_mul_i32 s33, s33, 2560
    v_lshlrev_b32 v1, 7, v0
    v_add_u32 v1, s33, v1
    v_min_u32 v1, L_main_end - L_pc0, v1
    v_cmp_gt_u32 vcc, 20, v0
    s_and_saveexec_b64 s[54:55], vcc
    s_cbranch_execz L_nocw
    global_load_dword v253, v1, s[94:95]
L_nocw:
    s_mov_b64 exec, s[54:55]
    s_mul_i32 s82, s31, 80
    s_add_u32 s83, s82, 80
    s_mov_b32 s87, 0x3f803f80
    s_add_u32 s85, s85, 18432
    buffer_load_dwordx4 v[164:167], v250, s[4:7], s85 offen offset:0
    buffer_load_dwordx4 v[184:187], v250, s[4:7], s85 offen offset:256
    buffer_load_dwordx4 v[204:207], v250, s[4:7], s85 offen offset:512
    s_mov_b32 s40, s20
    s_and_b32 s41, s21, 0xffff
    s_mov_b32 s42, 5308416
    s_mov_b32 s43, 0x20000
    s_mov_b32 s44, s28
    s_and_b32 s45, s29, 0xffff
    s_mov_b32 s46, 268435456
    s_mov_b32 s47, 0x20000
    s_mov_b32 s56, s28
    s_and_b32 s57, s29, 0xffff
    s_mov_b32 s58, 2359296
    s_mov_b32 s59, 0x20000
    s_mul_i32 s58, s83, 1152
    s_mul_i32 s33, s32, 1152
    s_mov_b32 s48, 0x05040100
    s_mov_b32 s49, 0x07060302
    s_lshl_b32 s34, s30, 8
    buffer_load_dwordx4 v[224:227], v250, s[4:7], s85 offen offset:768
    v_lshlrev_b32 v32, 4, v14
    v_add_u32 v32, s34, v32
    s_mov_b32 s35, 73728
    v_mul_lo_u32 v1, v15, s35
    v_add3_u32 v1, v1, v32, s33
    v_mul_u32_u24 v33, 9216, v15
    v_add_u32 v12, v33, v32
    v_mul_u32_u24 v33, 4608, v15
    v_add_u32 v33, v33, v32
    v_accvgpr_write_b32 a246, v33
    v_add_u32 v2, 9216, v1
    v_add_u32 v3, 18432, v1
    v_add_u32 v4, 27648, v1
    v_add_u32 v5, 36864, v1
    v_add_u32 v6, 46080, v1
    v_add_u32 v7, 55296, v1
    v_add_u32 v8, 64512, v1
    buffer_load_dwordx2 v[242:243], v251, s[4:7], s85 offen
    v_lshrrev_b32 v32, 3, v13
    s_lshl_b32 s34, s30, 3
    v_add_u32 v32, s34, v32
    v_bfe_u32 v33, v32, 2, 2
    v_lshrrev_b32 v34, 4, v32
    v_lshl_add_u32 v33, v33, 1, v34
    v_and_b32 v34, 3, v32
    v_lshl_add_u32 v33, v33, 2, v34
    v_and_b32 v32, 6, v32
    v_and_b32 v34, 7, v13
    v_xor_b32 v32, v32, v34
    v_lshlrev_b32 v32, 4, v32
    v_add_u32 v32, 1024, v32
    v_mul_u32_u24 v34, 9216, v33
    v_add3_u32 v9, v34, v32, s33
    v_mul_u32_u24 v34, 1152, v33
    v_add_u32 v31, v34, v32
    s_add_u32 s85, s85, 18432
    buffer_load_dwordx4 v[168:171], v250, s[4:7], s85 offen offset:0
    s_lshl_b32 s34, s30, 5
    s_add_u32 s34, s34, 1024
    v_mul_u32_u24 v34, 1152, v14
    v_lshl_add_u32 v34, v15, 3, v34
    v_add_u32 v34, s34, v34
    v_accvgpr_write_b32 a247, v34
    v_lshrrev_b32 v11, 2, v14
    v_lshl_add_u32 v11, v15, 2, v11
    v_bfe_u32 v32, v11, 1, 2
    v_xor_b32 v32, s30, v32
    v_lshlrev_b32 v32, 5, v32
    v_lshl_add_u32 v11, v11, 7, v32
    v_and_b32 v32, 3, v14
    v_lshl_add_u32 v11, v32, 3, v11
    v_add_u32 v11, 92160, v11
    s_lshl_b32 s52, s30, 10
    s_add_u32 s52, s52, 88064
    buffer_load_dwordx4 v[188:191], v250, s[4:7], s85 offen offset:256
    v_lshrrev_b32 v32, 2, v14
    v_sub_u32 v32, 0, v32
    v_xor_b32 v33, v32, v15
    v_and_b32 v33, 3, v33
    v_lshl_add_u32 v33, v14, 2, v33
    v_lshlrev_b32 v10, 4, v33
    s_and_b32 s34, s30, 1
    s_lshl_b32 s34, s34, 1
    s_lshr_b32 s33, s30, 1
    s_mul_i32 s33, s33, 5120
    s_add_u32 s33, s33, 81920
    v_lshrrev_b32 v33, 1, v15
    v_add_u32 v33, s34, v33
    v_xor_b32 v33, v33, v32
    v_and_b32 v33, 3, v33
    v_lshl_add_u32 v33, v14, 2, v33
    v_lshlrev_b32 v33, 4, v33
    buffer_load_dwordx4 v[208:211], v250, s[4:7], s85 offen offset:512
    v_and_b32 v34, 1, v15
    v_lshl_add_u32 v33, v34, 3, v33
    v_add_u32 v33, s33, v33
    v_accvgpr_write_b32 a241, v33
    v_sub_u32 v32, 0, v15
    v_lshrrev_b32 v33, 1, v29
    v_add_u32 v33, s34, v33
    v_xor_b32 v33, v32, v33
    v_and_b32 v33, 3, v33
    v_lshl_add_u32 v33, v28, 2, v33
    v_lshlrev_b32 v33, 4, v33
    v_and_b32 v34, 1, v29
    v_lshl_add_u32 v33, v34, 3, v33
    v_add_u32 v35, s33, v33
    v_xor_b32 v33, v32, v29
    v_and_b32 v33, 3, v33
    v_lshl_add_u32 v33, v28, 2, v33
    buffer_load_dwordx4 v[228:231], v250, s[4:7], s85 offen offset:768
    v_lshlrev_b32 v33, 4, v33
    s_mul_i32 s33, s30, 5120
    v_add_u32 v26, s33, v33
    v_xor_b32 v33, v32, v14
    v_and_b32 v33, 3, v33
    v_lshl_add_u32 v33, v15, 4, v33
    v_lshlrev_b32 v33, 4, v33
    v_lshrrev_b32 v34, 2, v14
    v_mul_u32_u24 v34, 5120, v34
    s_mul_i32 s33, s30, 20480
    v_add3_u32 v33, v33, v34, s33
    v_accvgpr_write_b32 a240, v33
    v_lshlrev_b32 v33, 5, v28
    v_add_u32 v33, 116736, v33
    s_lshl_b32 s33, s30, 3
    v_add_u32 v27, s33, v33
    v_lshl_add_u32 v29, v29, 3, v33
    buffer_load_dwordx2 v[244:245], v251, s[4:7], s85 offen
    v_mov_b32 v28, v35
    s_and_b32 s33, s31, 3
    s_lshl_b32 s33, s33, 4
    s_lshr_b32 s34, s31, 2
    s_add_u32 s33, s33, s34
    s_lshl_b32 s81, s33, 2
    v_mov_b32 v36, 0x40000000
    v_cmp_gt_u32 vcc, 208, v0
    v_lshlrev_b32 v32, 4, v0
    v_accvgpr_write_b32 a244, v32
    v_add_u32 v32, 8192, v32
    v_cndmask_b32 v32, v36, v32, vcc
    v_accvgpr_write_b32 a245, v32
    s_mul_i32 s35, s32, 10
    s_add_u32 s96, s82, s35
    s_mul_i32 s86, s96, 1152
    s_mul_i32 s97, s32, 2396160
    s_add_u32 s85, s85, 18432
    buffer_load_dwordx4 v[172:175], v250, s[4:7], s85 offen offset:0
    s_mul_i32 s34, s31, 92160
    s_add_u32 s97, s97, s34
    s_add_u32 s97, s97, 8388608
    s_mov_b32 s33, 13108
    v_mul_u32_u24 v32, s33, v0
    v_lshrrev_b32 v32, 16, v32
    v_mul_u32_u24 v33, 5, v32
    v_sub_u32 v33, v0, v33
    v_mul_u32_u24 v34, 2304, v33
    v_mad_u32_u24 v34, v32, 24, v34
    v_add_u32 v35, 122880, v34
    v_lshl_add_u32 v33, v33, 1, s96
    v_lshrrev_b32 v34, 4, v33
    v_mul_u32_u24 v34, 18432, v34
    v_and_b32 v33, 15, v33
    v_lshl_add_u32 v34, v33, 3, v34
    v_mul_u32_u24 v32, 384, v32
    buffer_load_dwordx4 v[192:195], v250, s[4:7], s85 offen offset:256
    v_cmp_gt_u32 vcc, 240, v0
    v_add_u32 v34, v34, v32
    s_lshl_b32 s33, s32, 2
    v_cndmask_b32 v34, v36, v34, vcc
    v_accvgpr_write_b32 a248, v34
    v_mov_b32 v34, 135168
    v_cndmask_b32 v35, v34, v35, vcc
    v_accvgpr_write_b32 a249, v35
    s_add_u32 s89, s33, s30
    v_lshrrev_b32 v32, 5, v13
    v_bfe_u32 v33, v13, 4, 1
    v_bfe_u32 v34, v13, 2, 2
    v_bfe_u32 v35, v13, 1, 1
    v_lshl_add_u32 v35, v32, 1, v35
    v_lshl_add_u32 v34, v33, 3, v34
    v_and_b32 v36, 1, v13
    v_lshlrev_b32 v36, 3, v36
    buffer_load_dwordx4 v[212:215], v250, s[4:7], s85 offen offset:512
    v_lshl_add_u32 v36, v34, 6, v36
    v_lshlrev_b32 v34, 1, v33
    v_sub_u32 v34, 0, v34
    v_xor_b32 v34, v34, v35
    v_and_b32 v34, 3, v34
    v_lshl_add_u32 v0, v34, 4, v36
    v_lshl_add_u32 v30, v32, 4, v14
    v_lshlrev_b32 v30, 5, v30
    v_lshl_add_u32 v30, v33, 4, v30
    s_lshl_b32 s33, s31, 11
    s_add_u32 s33, s33, 33554432
    s_add_u32 s100, s28, s33
    s_addc_u32 s101, s29, 0
    s_lshr_b32 s88, s82, 4
    s_mul_i32 s88, s88, 18432
    s_add_u32 s33, s89, 0
    s_lshl_b32 s90, s33, 10
    s_mul_i32 s34, s33, 13108
    buffer_load_dwordx4 v[232:235], v250, s[4:7], s85 offen offset:768
    s_lshr_b32 s34, s34, 16
    s_mul_i32 s35, s34, 91136
    s_mul_i32 s33, s33, 18432
    s_sub_u32 s33, s33, s35
    s_add_u32 s60, s33, s88
    s_add_u32 s33, s89, 32
    s_lshl_b32 s91, s33, 10
    s_mul_i32 s34, s33, 13108
    s_lshr_b32 s34, s34, 16
    s_mul_i32 s35, s34, 91136
    s_mul_i32 s33, s33, 18432
    s_sub_u32 s33, s33, s35
    s_add_u32 s61, s33, s88
    s_add_u32 s33, s89, 64
    s_lshl_b32 s92, s33, 10
    s_mul_i32 s34, s33, 13108
    s_lshr_b32 s34, s34, 16
    buffer_load_dwordx2 v[246:247], v251, s[4:7], s85 offen
    s_mul_i32 s35, s34, 91136
    s_mul_i32 s33, s33, 18432
    s_sub_u32 s33, s33, s35
    s_add_u32 s62, s33, s88
    s_cmp_ge_u32 s89, 26
    s_cselect_b32 s62, 0x40000000, s62
    s_add_u32 s85, s85, 18432
    buffer_load_dwordx4 v[176:179], v250, s[4:7], s85 offen offset:0
    buffer_load_dwordx4 v[196:199], v250, s[4:7], s85 offen offset:256
    s_waitcnt vmcnt(17)
    v_dot2_f32_bf16 v16, v160, s87, 0
    v_dot2_f32_bf16 v17, v160, v160, 0
    v_dot2_f32_bf16 v16, v161, s87, v16
    v_dot2_f32_bf16 v17, v161, v161, v17
    v_dot2_f32_bf16 v16, v162, s87, v16
    v_dot2_f32_bf16 v17, v162, v162, v17
    v_dot2_f32_bf16 v16, v163, s87, v16
    v_dot2_f32_bf16 v17, v163, v163, v17
    v_dot2_f32_bf16 v16, v180, s87, v16
    v_dot2_f32_bf16 v17, v180, v180, v17
    v_dot2_f32_bf16 v16, v181, s87, v16
    v_dot2_f32_bf16 v17, v181, v181, v17
    v_dot2_f32_bf16 v16, v182, s87, v16
    v_dot2_f32_bf16 v17, v182, v182, v17
    v_dot2_f32_bf16 v16, v183, s87, v16
    v_dot2_f32_bf16 v17, v183, v183, v17
    v_dot2_f32_bf16 v16, v200, s87, v16
    v_dot2_f32_bf16 v17, v200, v200, v17
    v_dot2_f32_bf16 v16, v201, s87, v16
    v_dot2_f32_bf16 v17, v201, v201, v17
    v_dot2_f32_bf16 v16, v202, s87, v16
    v_dot2_f32_bf16 v17, v202, v202, v17
    v_dot2_f32_bf16 v16, v203, s87, v16
    v_dot2_f32_bf16 v17, v203, v203, v17
    v_dot2_f32_bf16 v16, v220, s87, v16
    v_dot2_f32_bf16 v17, v220, v220, v17
    v_dot2_f32_bf16 v16, v221, s87, v16
    v_dot2_f32_bf16 v17, v221, v221, v17
    v_dot2_f32_bf16 v16, v222, s87, v16
    v_dot2_f32_bf16 v17, v222, v222, v17
    v_dot2_f32_bf16 v16, v223, s87, v16
    v_dot2_f32_bf16 v17, v223, v223, v17
    v_dot2_f32_bf16 v16, v240, s87, v16
    v_dot2_f32_bf16 v17, v240, v240, v17
    v_dot2_f32_bf16 v16, v241, s87, v16
    v_dot2_f32_bf16 v17, v241, v241, v17
    buffer_load_dwordx4 v[216:219], v250, s[4:7], s85 offen offset:512
    buffer_load_dwordx4 v[236:239], v250, s[4:7], s85 offen offset:768
    s_waitcnt vmcnt(14)
    v_dot2_f32_bf16 v18, v164, s87, 0
    v_dot2_f32_bf16 v19, v164, v164, 0
    v_dot2_f32_bf16 v18, v165, s87, v18
    v_dot2_f32_bf16 v19, v165, v165, v19
    v_dot2_f32_bf16 v18, v166, s87, v18
    v_dot2_f32_bf16 v19, v166, v166, v19
    v_dot2_f32_bf16 v18, v167, s87, v18
    v_dot2_f32_bf16 v19, v167, v167, v19
    v_dot2_f32_bf16 v18, v184, s87, v18
    v_dot2_f32_bf16 v19, v184, v184, v19
    v_dot2_f32_bf16 v18, v185, s87, v18
    v_dot2_f32_bf16 v19, v185, v185, v19
    v_dot2_f32_bf16 v18, v186, s87, v18
    v_dot2_f32_bf16 v19, v186, v186, v19
    v_dot2_f32_bf16 v18, v187, s87, v18
    v_dot2_f32_bf16 v19, v187, v187, v19
    v_dot2_f32_bf16 v18, v204, s87, v18
    v_dot2_f32_bf16 v19, v204, v204, v19
    v_dot2_f32_bf16 v18, v205, s87, v18
    v_dot2_f32_bf16 v19, v205, v205, v19
    v_dot2_f32_bf16 v18, v206, s87, v18
    v_dot2_f32_bf16 v19, v206, v206, v19
    v_dot2_f32_bf16 v18, v207, s87, v18
    v_dot2_f32_bf16 v19, v207, v207, v19
    v_dot2_f32_bf16 v18, v224, s87, v18
    v_dot2_f32_bf16 v19, v224, v224, v19
    v_dot2_f32_bf16 v18, v225, s87, v18
    v_dot2_f32_bf16 v19, v225, v225, v19
    v_dot2_f32_bf16 v18, v226, s87, v18
    v_dot2_f32_bf16 v19, v226, v226, v19
    v_dot2_f32_bf16 v18, v227, s87, v18
    v_dot2_f32_bf16 v19, v227, v227, v19
    v_dot2_f32_bf16 v18, v242, s87, v18
    v_dot2_f32_bf16 v19, v242, v242, v19
    v_dot2_f32_bf16 v18, v243, s87, v18
    v_dot2_f32_bf16 v19, v243, v243, v19
    buffer_load_dwordx2 v[248:249], v251, s[4:7], s85 offen
    s_waitcnt vmcnt(10)
    v_dot2_f32_bf16 v20, v168, s87, 0
    v_dot2_f32_bf16 v21, v168, v168, 0
    v_dot2_f32_bf16 v20, v169, s87, v20
    v_dot2_f32_bf16 v21, v169, v169, v21
    v_dot2_f32_bf16 v20, v170, s87, v20
    v_dot2_f32_bf16 v21, v170, v170, v21
    v_dot2_f32_bf16 v20, v171, s87, v20
    v_dot2_f32_bf16 v21, v171, v171, v21
    v_dot2_f32_bf16 v20, v188, s87, v20
    s_mov_b32 s50, 0
    s_nop 0
    buffer_load_dwordx4 v[32:35], v1, s[40:43], s50 offen
    v_dot2_f32_bf16 v21, v188, v188, v21
    v_dot2_f32_bf16 v20, v189, s87, v20
    v_dot2_f32_bf16 v21, v189, v189, v21
    v_dot2_f32_bf16 v20, v190, s87, v20
    v_dot2_f32_bf16 v21, v190, v190, v21
    v_dot2_f32_bf16 v20, v191, s87, v20
    v_dot2_f32_bf16 v21, v191, v191, v21
    v_dot2_f32_bf16 v20, v208, s87, v20
    v_dot2_f32_bf16 v21, v208, v208, v21
    buffer_load_dwordx4 v[36:39], v2, s[40:43], s50 offen
    v_dot2_f32_bf16 v20, v209, s87, v20
    v_dot2_f32_bf16 v21, v209, v209, v21
    v_dot2_f32_bf16 v20, v210, s87, v20
    v_dot2_f32_bf16 v21, v210, v210, v21
    v_dot2_f32_bf16 v20, v211, s87, v20
    v_dot2_f32_bf16 v21, v211, v211, v21
    v_dot2_f32_bf16 v20, v228, s87, v20
    v_dot2_f32_bf16 v21, v228, v228, v21
    v_dot2_f32_bf16 v20, v229, s87, v20
    buffer_load_dwordx4 v[40:43], v3, s[40:43], s50 offen
    v_dot2_f32_bf16 v21, v229, v229, v21
    v_dot2_f32_bf16 v20, v230, s87, v20
    v_dot2_f32_bf16 v21, v230, v230, v21
    v_dot2_f32_bf16 v20, v231, s87, v20
    v_dot2_f32_bf16 v21, v231, v231, v21
    v_dot2_f32_bf16 v20, v244, s87, v20
    v_dot2_f32_bf16 v21, v244, v244, v21
    v_dot2_f32_bf16 v20, v245, s87, v20
    v_dot2_f32_bf16 v21, v245, v245, v21
    buffer_load_dwordx4 v[44:47], v4, s[40:43], s50 offen
    s_waitcnt vmcnt(9)
    v_dot2_f32_bf16 v22, v172, s87, 0
    v_dot2_f32_bf16 v23, v172, v172, 0
    v_dot2_f32_bf16 v22, v173, s87, v22
    v_dot2_f32_bf16 v23, v173, v173, v23
    v_dot2_f32_bf16 v22, v174, s87, v22
    v_dot2_f32_bf16 v23, v174, v174, v23
    v_dot2_f32_bf16 v22, v175, s87, v22
    v_dot2_f32_bf16 v23, v175, v175, v23
    v_dot2_f32_bf16 v22, v192, s87, v22
    buffer_load_dwordx4 v[48:51], v5, s[40:43], s50 offen
    v_dot2_f32_bf16 v23, v192, v192, v23
    v_dot2_f32_bf16 v22, v193, s87, v22
    v_dot2_f32_bf16 v23, v193, v193, v23
    v_dot2_f32_bf16 v22, v194, s87, v22
    v_dot2_f32_bf16 v23, v194, v194, v23
    v_dot2_f32_bf16 v22, v195, s87, v22
    v_dot2_f32_bf16 v23, v195, v195, v23
    v_dot2_f32_bf16 v22, v212, s87, v22
    v_dot2_f32_bf16 v23, v212, v212, v23
    buffer_load_dwordx4 v[52:55], v6, s[40:43], s50 offen
    v_dot2_f32_bf16 v22, v213, s87, v22
    v_dot2_f32_bf16 v23, v213, v213, v23
    v_dot2_f32_bf16 v22, v214, s87, v22
    v_dot2_f32_bf16 v23, v214, v214, v23
    v_dot2_f32_bf16 v22, v215, s87, v22
    v_dot2_f32_bf16 v23, v215, v215, v23
    v_dot2_f32_bf16 v22, v232, s87, v22
    v_dot2_f32_bf16 v23, v232, v232, v23
    v_dot2_f32_bf16 v22, v233, s87, v22
    buffer_load_dwordx4 v[56:59], v7, s[40:43], s50 offen
    v_dot2_f32_bf16 v23, v233, v233, v23
    v_dot2_f32_bf16 v22, v234, s87, v22
    v_dot2_f32_bf16 v23, v234, v234, v23
    v_dot2_f32_bf16 v22, v235, s87, v22
    v_dot2_f32_bf16 v23, v235, v235, v23
    v_dot2_f32_bf16 v22, v246, s87, v22
    v_dot2_f32_bf16 v23, v246, v246, v23
    v_dot2_f32_bf16 v22, v247, s87, v22
    v_dot2_f32_bf16 v23, v247, v247, v23
    s_add_u32 m0, s52, 4096
    buffer_load_dwordx4 v[60:63], v8, s[40:43], s50 offen
    s_waitcnt vmcnt(8)
    v_dot2_f32_bf16 v24, v176, s87, 0
    v_dot2_f32_bf16 v25, v176, v176, 0
    v_dot2_f32_bf16 v24, v177, s87, v24
    v_dot2_f32_bf16 v25, v177, v177, v25
    v_dot2_f32_bf16 v24, v178, s87, v24
    v_dot2_f32_bf16 v25, v178, v178, v25
    v_dot2_f32_bf16 v24, v179, s87, v24
    v_dot2_f32_bf16 v25, v179, v179, v25
    v_dot2_f32_bf16 v24, v196, s87, v24
    buffer_load_dwordx4 v9, s[40:43], s50 offen lds
    v_dot2_f32_bf16 v25, v196, v196, v25
    v_dot2_f32_bf16 v24, v197, s87, v24
    v_dot2_f32_bf16 v25, v197, v197, v25
    v_dot2_f32_bf16 v24, v198, s87, v24
    v_dot2_f32_bf16 v25, v198, v198, v25
    v_dot2_f32_bf16 v24, v199, s87, v24
    v_dot2_f32_bf16 v25, v199, v199, v25
    v_dot2_f32_bf16 v24, v216, s87, v24
    v_dot2_f32_bf16 v25, v216, v216, v25
    s_mov_b32 s50, 294912
    buffer_load_dwordx4 v[64:67], v1, s[40:43], s50 offen
    v_dot2_f32_bf16 v24, v217, s87, v24
    v_dot2_f32_bf16 v25, v217, v217, v25
    v_dot2_f32_bf16 v24, v218, s87, v24
    v_dot2_f32_bf16 v25, v218, v218, v25
    v_dot2_f32_bf16 v24, v219, s87, v24
    v_dot2_f32_bf16 v25, v219, v219, v25
    v_dot2_f32_bf16 v24, v236, s87, v24
    v_dot2_f32_bf16 v25, v236, v236, v25
    v_dot2_f32_bf16 v24, v237, s87, v24
    buffer_load_dwordx4 v[68:71], v2, s[40:43], s50 offen
    v_dot2_f32_bf16 v25, v237, v237, v25
    v_dot2_f32_bf16 v24, v238, s87, v24
    v_dot2_f32_bf16 v25, v238, v238, v25
    v_dot2_f32_bf16 v24, v239, s87, v24
    v_dot2_f32_bf16 v25, v239, v239, v25
    v_dot2_f32_bf16 v24, v248, s87, v24
    v_dot2_f32_bf16 v25, v248, v248, v25
    v_dot2_f32_bf16 v24, v249, s87, v24
    v_dot2_f32_bf16 v25, v249, v249, v25
    buffer_load_dwordx4 v[72:75], v3, s[40:43], s50 offen
    s_nop 2
    v_add_f32_dpp v16, v16, v16 quad_perm:[1,0,3,2] row_mask:0xf bank_mask:0xf
    v_add_f32_dpp v17, v17, v17 quad_perm:[1,0,3,2] row_mask:0xf bank_mask:0xf
    v_add_f32_dpp v18, v18, v18 quad_perm:[1,0,3,2] row_mask:0xf bank_mask:0xf
    v_add_f32_dpp v19, v19, v19 quad_perm:[1,0,3,2] row_mask:0xf bank_mask:0xf
    v_add_f32_dpp v20, v20, v20 quad_perm:[1,0,3,2] row_mask:0xf bank_mask:0xf
    v_add_f32_dpp v21, v21, v21 quad_perm:[1,0,3,2] row_mask:0xf bank_mask:0xf
    v_add_f32_dpp v22, v22, v22 quad_perm:[1,0,3,2] row_mask:0xf bank_mask:0xf
    v_add_f32_dpp v23, v23, v23 quad_perm:[1,0,3,2] row_mask:0xf bank_mask:0xf
    v_add_f32_dpp v24, v24, v24 quad_perm:[1,0,3,2] row_mask:0xf bank_mask:0xf
    v_add_f32_dpp v25, v25, v25 quad_perm:[1,0,3,2] row_mask:0xf bank_mask:0xf
    v_add_f32_dpp v16, v16, v16 quad_perm:[2,3,0,1] row_mask:0xf bank_mask:0xf
    v_add_f32_dpp v17, v17, v17 quad_perm:[2,3,0,1] row_mask:0xf bank_mask:0xf
    v_add_f32_dpp v18, v18, v18 quad_perm:[2,3,0,1] row_mask:0xf bank_mask:0xf
    v_add_f32_dpp v19, v19, v19 quad_perm:[2,3,0,1] row_mask:0xf bank_mask:0xf
    v_add_f32_dpp v20, v20, v20 quad_perm:[2,3,0,1] row_mask:0xf bank_mask:0xf
    v_add_f32_dpp v21, v21, v21 quad_perm:[2,3,0,1] row_mask:0xf bank_mask:0xf
    v_add_f32_dpp v22, v22, v22 quad_perm:[2,3,0,1] row_mask:0xf bank_mask:0xf
    v_add_f32_dpp v23, v23, v23 quad_perm:[2,3,0,1] row_mask:0xf bank_mask:0xf
    v_add_f32_dpp v24, v24, v24 quad_perm:[2,3,0,1] row_mask:0xf bank_mask:0xf
    v_add_f32_dpp v25, v25, v25 quad_perm:[2,3,0,1] row_mask:0xf bank_mask:0xf
    s_mov_b32 s34, 0x11111111
    s_mov_b32 exec_lo, s34
    s_mov_b32 exec_hi, s34
    ds_write_b64 v27, v[16:17] offset:0
    ds_write_b64 v27, v[18:19] offset:512
    ds_write_b64 v27, v[20:21] offset:1024
    ds_write_b64 v27, v[22:23] offset:1536
    ds_write_b64 v27, v[24:25] offset:2048
    s_mov_b64 exec, -1
    buffer_load_dwordx4 v[76:79], v4, s[40:43], s50 offen
    buffer_load_dwordx4 v[80:83], v5, s[40:43], s50 offen
    v_and_b32 v250, 3, v13
    v_mul_u32_u24 v250, 504, v250
    v_add_u32 v250, v250, v29
    s_waitcnt lgkmcnt(0)
    s_barrier
    ds_read_b128 v[16:19], v250
    ds_read_b128 v[20:23], v250 offset:16
    ds_read_b64 v[24:25], v29 offset:2048
    buffer_load_dwordx4 v[84:87], v6, s[40:43], s50 offen
    s_mov_b32 s33, 0x3ae38e39
    s_mov_b32 s34, 0x3727c5ac
    s_mov_b32 s35, 3216550459
    s_waitcnt lgkmcnt(0)
    v_pk_add_f32 v[16:17], v[16:17], v[18:19]
    v_pk_add_f32 v[20:21], v[20:21], v[22:23]
    v_add_f32_dpp v24, v24, v24 quad_perm:[1,0,3,2] row_mask:0xf bank_mask:0xf
    v_add_f32_dpp v25, v25, v25 quad_perm:[1,0,3,2] row_mask:0xf bank_mask:0xf
    v_pk_add_f32 v[250:251], v[16:17], v[20:21]
    v_add_f32_dpp v24, v24, v24 quad_perm:[2,3,0,1] row_mask:0xf bank_mask:0xf
    v_add_f32_dpp v25, v25, v25 quad_perm:[2,3,0,1] row_mask:0xf bank_mask:0xf
    v_pk_mul_f32 v[250:251], v[250:251], s[32:33] op_sel:[0,1] op_sel_hi:[1,1]
    v_pk_mul_f32 v[24:25], v[24:25], s[32:33] op_sel:[0,1] op_sel_hi:[1,1]
    v_fma_f32 v251, -v250, v250, v251
    v_fma_f32 v25, -v24, v24, v25
    v_max_f32 v251, 0, v251
    v_max_f32 v25, 0, v25
    v_cvt_pk_bf16_f32 v251, v251, v250
    v_cvt_pk_bf16_f32 v25, v25, v24
    v_and_b32 v250, 0xffff0000, v251
    v_and_b32 v24, 0xffff0000, v25
    v_lshlrev_b32 v251, 16, v251
    v_lshlrev_b32 v25, 16, v25
    v_add_f32 v251, s34, v251
    v_add_f32 v25, s34, v25
    v_cvt_pk_bf16_f32 v251, v251, v251
    v_cvt_pk_bf16_f32 v25, v25, v25
    v_lshlrev_b32 v251, 16, v251
    v_lshlrev_b32 v25, 16, v25
    v_sqrt_f32 v251, v251
    v_sqrt_f32 v25, v25
    s_nop 0
    v_cvt_pk_bf16_f32 v251, v251, v251
    v_cvt_pk_bf16_f32 v25, v25, v25
    v_lshlrev_b32 v251, 16, v251
    v_lshlrev_b32 v25, 16, v25
    v_rcp_f32 v251, v251
    v_rcp_f32 v25, v25
    s_nop 0
    v_mul_f32 v251, s35, v251
    v_mul_f32 v25, s35, v25
    v_mul_f32 v250, v250, v251
    v_mul_f32 v24, v24, v25
    s_nop 1
    v_mov_b32_dpp v17, v251 quad_perm:[0,0,0,0] row_mask:0xf bank_mask:0xf
    v_mov_b32_dpp v16, v250 quad_perm:[0,0,0,0] row_mask:0xf bank_mask:0xf
    v_mov_b32_dpp v19, v251 quad_perm:[1,1,1,1] row_mask:0xf bank_mask:0xf
    v_mov_b32_dpp v18, v250 quad_perm:[1,1,1,1] row_mask:0xf bank_mask:0xf
    v_mov_b32_dpp v21, v251 quad_perm:[2,2,2,2] row_mask:0xf bank_mask:0xf
    v_mov_b32_dpp v20, v250 quad_perm:[2,2,2,2] row_mask:0xf bank_mask:0xf
    v_mov_b32_dpp v23, v251 quad_perm:[3,3,3,3] row_mask:0xf bank_mask:0xf
    v_mov_b32_dpp v22, v250 quad_perm:[3,3,3,3] row_mask:0xf bank_mask:0xf
    v_lshlrev_b32 v250, 16, v160
    v_lshlrev_b32 v252, 16, v161
    v_and_b32 v251, 0xffff0000, v160
    v_and_b32 v253, 0xffff0000, v161
    v_pk_fma_f32 v[250:251], v[250:251], v[16:17], v[16:17] op_sel:[0,1,0] op_sel_hi:[1,1,0] neg_lo:[0,0,1] neg_hi:[0,0,1]
    v_pk_fma_f32 v[252:253], v[252:253], v[16:17], v[16:17] op_sel:[0,1,0] op_sel_hi:[1,1,0] neg_lo:[0,0,1] neg_hi:[0,0,1]
    v_cvt_pk_bf16_f32 v160, v250, v251
    v_cvt_pk_bf16_f32 v161, v252, v253
    buffer_load_dwordx4 v[88:91], v7, s[40:43], s50 offen
    v_lshlrev_b32 v250, 16, v162
    v_lshlrev_b32 v252, 16, v163
    v_and_b32 v251, 0xffff0000, v162
    v_and_b32 v253, 0xffff0000, v163
    v_pk_fma_f32 v[250:251], v[250:251], v[16:17], v[16:17] op_sel:[0,1,0] op_sel_hi:[1,1,0] neg_lo:[0,0,1] neg_hi:[0,0,1]
    v_pk_fma_f32 v[252:253], v[252:253], v[16:17], v[16:17] op_sel:[0,1,0] op_sel_hi:[1,1,0] neg_lo:[0,0,1] neg_hi:[0,0,1]
    v_cvt_pk_bf16_f32 v162, v250, v251
    v_cvt_pk_bf16_f32 v163, v252, v253
    ds_write_b128 v26, v[160:163] offset:0
    s_add_u32 m0, s52, 8192
    buffer_load_dwordx4 v[92:95], v8, s[40:43], s50 offen
    v_lshlrev_b32 v250, 16, v164
    v_lshlrev_b32 v252, 16, v165
    v_and_b32 v251, 0xffff0000, v164
    v_and_b32 v253, 0xffff0000, v165
    v_pk_fma_f32 v[250:251], v[250:251], v[18:19], v[18:19] op_sel:[0,1,0] op_sel_hi:[1,1,0] neg_lo:[0,0,1] neg_hi:[0,0,1]
    v_pk_fma_f32 v[252:253], v[252:253], v[18:19], v[18:19] op_sel:[0,1,0] op_sel_hi:[1,1,0] neg_lo:[0,0,1] neg_hi:[0,0,1]
    v_cvt_pk_bf16_f32 v164, v250, v251
    v_cvt_pk_bf16_f32 v165, v252, v253
    v_lshlrev_b32 v250, 16, v166
    v_lshlrev_b32 v252, 16, v167
    v_and_b32 v251, 0xffff0000, v166
    v_and_b32 v253, 0xffff0000, v167
    v_pk_fma_f32 v[250:251], v[250:251], v[18:19], v[18:19] op_sel:[0,1,0] op_sel_hi:[1,1,0] neg_lo:[0,0,1] neg_hi:[0,0,1]
    v_pk_fma_f32 v[252:253], v[252:253], v[18:19], v[18:19] op_sel:[0,1,0] op_sel_hi:[1,1,0] neg_lo:[0,0,1] neg_hi:[0,0,1]
    v_cvt_pk_bf16_f32 v166, v250, v251
    v_cvt_pk_bf16_f32 v167, v252, v253
    ds_write_b128 v26, v[164:167] offset:1024
    buffer_load_dwordx4 v9, s[40:43], s50 offen lds
    v_lshlrev_b32 v250, 16, v168
    v_lshlrev_b32 v252, 16, v169
    v_and_b32 v251, 0xffff0000, v168
    v_and_b32 v253, 0xffff0000, v169
    v_pk_fma_f32 v[250:251], v[250:251], v[20:21], v[20:21] op_sel:[0,1,0] op_sel_hi:[1,1,0] neg_lo:[0,0,1] neg_hi:[0,0,1]
    v_pk_fma_f32 v[252:253], v[252:253], v[20:21], v[20:21] op_sel:[0,1,0] op_sel_hi:[1,1,0] neg_lo:[0,0,1] neg_hi:[0,0,1]
    v_cvt_pk_bf16_f32 v168, v250, v251
    v_cvt_pk_bf16_f32 v169, v252, v253
    s_mov_b32 s50, 589824
    buffer_load_dwordx4 v[96:99], v1, s[40:43], s50 offen
    v_lshlrev_b32 v250, 16, v170
    v_lshlrev_b32 v252, 16, v171
    v_and_b32 v251, 0xffff0000, v170
    v_and_b32 v253, 0xffff0000, v171
    v_pk_fma_f32 v[250:251], v[250:251], v[20:21], v[20:21] op_sel:[0,1,0] op_sel_hi:[1,1,0] neg_lo:[0,0,1] neg_hi:[0,0,1]
    v_pk_fma_f32 v[252:253], v[252:253], v[20:21], v[20:21] op_sel:[0,1,0] op_sel_hi:[1,1,0] neg_lo:[0,0,1] neg_hi:[0,0,1]
    v_cvt_pk_bf16_f32 v170, v250, v251
    v_cvt_pk_bf16_f32 v171, v252, v253
    ds_write_b128 v26, v[168:171] offset:2048
    v_lshlrev_b32 v250, 16, v172
    v_lshlrev_b32 v252, 16, v173
    v_and_b32 v251, 0xffff0000, v172
    v_and_b32 v253, 0xffff0000, v173
    v_pk_fma_f32 v[250:251], v[250:251], v[22:23], v[22:23] op_sel:[0,1,0] op_sel_hi:[1,1,0] neg_lo:[0,0,1] neg_hi:[0,0,1]
    v_pk_fma_f32 v[252:253], v[252:253], v[22:23], v[22:23] op_sel:[0,1,0] op_sel_hi:[1,1,0] neg_lo:[0,0,1] neg_hi:[0,0,1]
    v_cvt_pk_bf16_f32 v172, v250, v251
    v_cvt_pk_bf16_f32 v173, v252, v253
    buffer_load_dwordx4 v[100:103], v2, s[40:43], s50 offen
    v_lshlrev_b32 v250, 16, v174
    v_lshlrev_b32 v252, 16, v175
    v_and_b32 v251, 0xffff0000, v174
    v_and_b32 v253, 0xffff0000, v175
    v_pk_fma_f32 v[250:251], v[250:251], v[22:23], v[22:23] op_sel:[0,1,0] op_sel_hi:[1,1,0] neg_lo:[0,0,1] neg_hi:[0,0,1]
    v_pk_fma_f32 v[252:253], v[252:253], v[22:23], v[22:23] op_sel:[0,1,0] op_sel_hi:[1,1,0] neg_lo:[0,0,1] neg_hi:[0,0,1]
    v_cvt_pk_bf16_f32 v174, v250, v251
    v_cvt_pk_bf16_f32 v175, v252, v253
    ds_write_b128 v26, v[172:175] offset:3072
    buffer_load_dwordx4 v[104:107], v3, s[40:43], s50 offen
    v_lshlrev_b32 v250, 16, v176
    v_lshlrev_b32 v252, 16, v177
    v_and_b32 v251, 0xffff0000, v176
    v_and_b32 v253, 0xffff0000, v177
    v_pk_fma_f32 v[250:251], v[250:251], v[24:25], v[24:25] op_sel:[0,1,0] op_sel_hi:[1,1,0] neg_lo:[0,0,1] neg_hi:[0,0,1]
    v_pk_fma_f32 v[252:253], v[252:253], v[24:25], v[24:25] op_sel:[0,1,0] op_sel_hi:[1,1,0] neg_lo:[0,0,1] neg_hi:[0,0,1]
    v_cvt_pk_bf16_f32 v176, v250, v251
    v_cvt_pk_bf16_f32 v177, v252, v253
    v_lshlrev_b32 v250, 16, v178
    v_lshlrev_b32 v252, 16, v179
    v_and_b32 v251, 0xffff0000, v178
    v_and_b32 v253, 0xffff0000, v179
    v_pk_fma_f32 v[250:251], v[250:251], v[24:25], v[24:25] op_sel:[0,1,0] op_sel_hi:[1,1,0] neg_lo:[0,0,1] neg_hi:[0,0,1]
    v_pk_fma_f32 v[252:253], v[252:253], v[24:25], v[24:25] op_sel:[0,1,0] op_sel_hi:[1,1,0] neg_lo:[0,0,1] neg_hi:[0,0,1]
    v_cvt_pk_bf16_f32 v178, v250, v251
    v_cvt_pk_bf16_f32 v179, v252, v253
    ds_write_b128 v26, v[176:179] offset:4096
    buffer_load_dwordx4 v[108:111], v4, s[40:43], s50 offen
    v_lshlrev_b32 v250, 16, v180
    v_lshlrev_b32 v252, 16, v181
    v_and_b32 v251, 0xffff0000, v180
    v_and_b32 v253, 0xffff0000, v181
    v_pk_fma_f32 v[250:251], v[250:251], v[16:17], v[16:17] op_sel:[0,1,0] op_sel_hi:[1,1,0] neg_lo:[0,0,1] neg_hi:[0,0,1]
    v_pk_fma_f32 v[252:253], v[252:253], v[16:17], v[16:17] op_sel:[0,1,0] op_sel_hi:[1,1,0] neg_lo:[0,0,1] neg_hi:[0,0,1]
    v_cvt_pk_bf16_f32 v180, v250, v251
    v_cvt_pk_bf16_f32 v181, v252, v253
    buffer_load_dwordx4 v[112:115], v5, s[40:43], s50 offen
    v_lshlrev_b32 v250, 16, v182
    v_lshlrev_b32 v252, 16, v183
    v_and_b32 v251, 0xffff0000, v182
    v_and_b32 v253, 0xffff0000, v183
    v_pk_fma_f32 v[250:251], v[250:251], v[16:17], v[16:17] op_sel:[0,1,0] op_sel_hi:[1,1,0] neg_lo:[0,0,1] neg_hi:[0,0,1]
    v_pk_fma_f32 v[252:253], v[252:253], v[16:17], v[16:17] op_sel:[0,1,0] op_sel_hi:[1,1,0] neg_lo:[0,0,1] neg_hi:[0,0,1]
    v_cvt_pk_bf16_f32 v182, v250, v251
    v_cvt_pk_bf16_f32 v183, v252, v253
    ds_write_b128 v26, v[180:183] offset:20480
    v_lshlrev_b32 v250, 16, v184
    v_lshlrev_b32 v252, 16, v185
    v_and_b32 v251, 0xffff0000, v184
    v_and_b32 v253, 0xffff0000, v185
    v_pk_fma_f32 v[250:251], v[250:251], v[18:19], v[18:19] op_sel:[0,1,0] op_sel_hi:[1,1,0] neg_lo:[0,0,1] neg_hi:[0,0,1]
    v_pk_fma_f32 v[252:253], v[252:253], v[18:19], v[18:19] op_sel:[0,1,0] op_sel_hi:[1,1,0] neg_lo:[0,0,1] neg_hi:[0,0,1]
    v_cvt_pk_bf16_f32 v184, v250, v251
    v_cvt_pk_bf16_f32 v185, v252, v253
    buffer_load_dwordx4 v[116:119], v6, s[40:43], s50 offen
    v_lshlrev_b32 v250, 16, v186
    v_lshlrev_b32 v252, 16, v187
    v_and_b32 v251, 0xffff0000, v186
    v_and_b32 v253, 0xffff0000, v187
    v_pk_fma_f32 v[250:251], v[250:251], v[18:19], v[18:19] op_sel:[0,1,0] op_sel_hi:[1,1,0] neg_lo:[0,0,1] neg_hi:[0,0,1]
    v_pk_fma_f32 v[252:253], v[252:253], v[18:19], v[18:19] op_sel:[0,1,0] op_sel_hi:[1,1,0] neg_lo:[0,0,1] neg_hi:[0,0,1]
    v_cvt_pk_bf16_f32 v186, v250, v251
    v_cvt_pk_bf16_f32 v187, v252, v253
    ds_write_b128 v26, v[184:187] offset:21504
    buffer_load_dwordx4 v[120:123], v7, s[40:43], s50 offen
    v_lshlrev_b32 v250, 16, v188
    v_lshlrev_b32 v252, 16, v189
    v_and_b32 v251, 0xffff0000, v188
    v_and_b32 v253, 0xffff0000, v189
    v_pk_fma_f32 v[250:251], v[250:251], v[20:21], v[20:21] op_sel:[0,1,0] op_sel_hi:[1,1,0] neg_lo:[0,0,1] neg_hi:[0,0,1]
    v_pk_fma_f32 v[252:253], v[252:253], v[20:21], v[20:21] op_sel:[0,1,0] op_sel_hi:[1,1,0] neg_lo:[0,0,1] neg_hi:[0,0,1]
    v_cvt_pk_bf16_f32 v188, v250, v251
    v_cvt_pk_bf16_f32 v189, v252, v253
    v_lshlrev_b32 v250, 16, v190
    v_lshlrev_b32 v252, 16, v191
    v_and_b32 v251, 0xffff0000, v190
    v_and_b32 v253, 0xffff0000, v191
    v_pk_fma_f32 v[250:251], v[250:251], v[20:21], v[20:21] op_sel:[0,1,0] op_sel_hi:[1,1,0] neg_lo:[0,0,1] neg_hi:[0,0,1]
    v_pk_fma_f32 v[252:253], v[252:253], v[20:21], v[20:21] op_sel:[0,1,0] op_sel_hi:[1,1,0] neg_lo:[0,0,1] neg_hi:[0,0,1]
    v_cvt_pk_bf16_f32 v190, v250, v251
    v_cvt_pk_bf16_f32 v191, v252, v253
    ds_write_b128 v26, v[188:191] offset:22528
    s_add_u32 m0, s52, 12288
    buffer_load_dwordx4 v[124:127], v8, s[40:43], s50 offen
    v_lshlrev_b32 v250, 16, v192
    v_lshlrev_b32 v252, 16, v193
    v_and_b32 v251, 0xffff0000, v192
    v_and_b32 v253, 0xffff0000, v193
    v_pk_fma_f32 v[250:251], v[250:251], v[22:23], v[22:23] op_sel:[0,1,0] op_sel_hi:[1,1,0] neg_lo:[0,0,1] neg_hi:[0,0,1]
    v_pk_fma_f32 v[252:253], v[252:253], v[22:23], v[22:23] op_sel:[0,1,0] op_sel_hi:[1,1,0] neg_lo:[0,0,1] neg_hi:[0,0,1]
    v_cvt_pk_bf16_f32 v192, v250, v251
    v_cvt_pk_bf16_f32 v193, v252, v253
    buffer_load_dwordx4 v9, s[40:43], s50 offen lds
    v_lshlrev_b32 v250, 16, v194
    v_lshlrev_b32 v252, 16, v195
    v_and_b32 v251, 0xffff0000, v194
    v_and_b32 v253, 0xffff0000, v195
    v_pk_fma_f32 v[250:251], v[250:251], v[22:23], v[22:23] op_sel:[0,1,0] op_sel_hi:[1,1,0] neg_lo:[0,0,1] neg_hi:[0,0,1]
    v_pk_fma_f32 v[252:253], v[252:253], v[22:23], v[22:23] op_sel:[0,1,0] op_sel_hi:[1,1,0] neg_lo:[0,0,1] neg_hi:[0,0,1]
    v_cvt_pk_bf16_f32 v194, v250, v251
    v_cvt_pk_bf16_f32 v195, v252, v253
    ds_write_b128 v26, v[192:195] offset:23552
    v_lshlrev_b32 v250, 16, v196
    v_lshlrev_b32 v252, 16, v197
    v_and_b32 v251, 0xffff0000, v196
    v_and_b32 v253, 0xffff0000, v197
    v_pk_fma_f32 v[250:251], v[250:251], v[24:25], v[24:25] op_sel:[0,1,0] op_sel_hi:[1,1,0] neg_lo:[0,0,1] neg_hi:[0,0,1]
    v_pk_fma_f32 v[252:253], v[252:253], v[24:25], v[24:25] op_sel:[0,1,0] op_sel_hi:[1,1,0] neg_lo:[0,0,1] neg_hi:[0,0,1]
    v_cvt_pk_bf16_f32 v196, v250, v251
    v_cvt_pk_bf16_f32 v197, v252, v253
    s_mov_b32 s50, 884736
    buffer_load_dwordx4 v[128:131], v1, s[40:43], s50 offen
    v_lshlrev_b32 v250, 16, v198
    v_lshlrev_b32 v252, 16, v199
    v_and_b32 v251, 0xffff0000, v198
    v_and_b32 v253, 0xffff0000, v199
    v_pk_fma_f32 v[250:251], v[250:251], v[24:25], v[24:25] op_sel:[0,1,0] op_sel_hi:[1,1,0] neg_lo:[0,0,1] neg_hi:[0,0,1]
    v_pk_fma_f32 v[252:253], v[252:253], v[24:25], v[24:25] op_sel:[0,1,0] op_sel_hi:[1,1,0] neg_lo:[0,0,1] neg_hi:[0,0,1]
    v_cvt_pk_bf16_f32 v198, v250, v251
    v_cvt_pk_bf16_f32 v199, v252, v253
    ds_write_b128 v26, v[196:199] offset:24576
    buffer_load_dwordx4 v[132:135], v2, s[40:43], s50 offen
    v_lshlrev_b32 v250, 16, v200
    v_lshlrev_b32 v252, 16, v201
    v_and_b32 v251, 0xffff0000, v200
    v_and_b32 v253, 0xffff0000, v201
    v_pk_fma_f32 v[250:251], v[250:251], v[16:17], v[16:17] op_sel:[0,1,0] op_sel_hi:[1,1,0] neg_lo:[0,0,1] neg_hi:[0,0,1]
    v_pk_fma_f32 v[252:253], v[252:253], v[16:17], v[16:17] op_sel:[0,1,0] op_sel_hi:[1,1,0] neg_lo:[0,0,1] neg_hi:[0,0,1]
    v_cvt_pk_bf16_f32 v200, v250, v251
    v_cvt_pk_bf16_f32 v201, v252, v253
    v_lshlrev_b32 v250, 16, v202
    v_lshlrev_b32 v252, 16, v203
    v_and_b32 v251, 0xffff0000, v202
    v_and_b32 v253, 0xffff0000, v203
    v_pk_fma_f32 v[250:251], v[250:251], v[16:17], v[16:17] op_sel:[0,1,0] op_sel_hi:[1,1,0] neg_lo:[0,0,1] neg_hi:[0,0,1]
    v_pk_fma_f32 v[252:253], v[252:253], v[16:17], v[16:17] op_sel:[0,1,0] op_sel_hi:[1,1,0] neg_lo:[0,0,1] neg_hi:[0,0,1]
    v_cvt_pk_bf16_f32 v202, v250, v251
    v_cvt_pk_bf16_f32 v203, v252, v253
    ds_write_b128 v26, v[200:203] offset:40960
    buffer_load_dwordx4 v[136:139], v3, s[40:43], s50 offen
    v_lshlrev_b32 v250, 16, v204
    v_lshlrev_b32 v252, 16, v205
    v_and_b32 v251, 0xffff0000, v204
    v_and_b32 v253, 0xffff0000, v205
    v_pk_fma_f32 v[250:251], v[250:251], v[18:19], v[18:19] op_sel:[0,1,0] op_sel_hi:[1,1,0] neg_lo:[0,0,1] neg_hi:[0,0,1]
    v_pk_fma_f32 v[252:253], v[252:253], v[18:19], v[18:19] op_sel:[0,1,0] op_sel_hi:[1,1,0] neg_lo:[0,0,1] neg_hi:[0,0,1]
    v_cvt_pk_bf16_f32 v204, v250, v251
    v_cvt_pk_bf16_f32 v205, v252, v253
    buffer_load_dwordx4 v[140:143], v4, s[40:43], s50 offen
    v_lshlrev_b32 v250, 16, v206
    v_lshlrev_b32 v252, 16, v207
    v_and_b32 v251, 0xffff0000, v206
    v_and_b32 v253, 0xffff0000, v207
    v_pk_fma_f32 v[250:251], v[250:251], v[18:19], v[18:19] op_sel:[0,1,0] op_sel_hi:[1,1,0] neg_lo:[0,0,1] neg_hi:[0,0,1]
    v_pk_fma_f32 v[252:253], v[252:253], v[18:19], v[18:19] op_sel:[0,1,0] op_sel_hi:[1,1,0] neg_lo:[0,0,1] neg_hi:[0,0,1]
    v_cvt_pk_bf16_f32 v206, v250, v251
    v_cvt_pk_bf16_f32 v207, v252, v253
    ds_write_b128 v26, v[204:207] offset:41984
    v_lshlrev_b32 v250, 16, v208
    v_lshlrev_b32 v252, 16, v209
    v_and_b32 v251, 0xffff0000, v208
    v_and_b32 v253, 0xffff0000, v209
    v_pk_fma_f32 v[250:251], v[250:251], v[20:21], v[20:21] op_sel:[0,1,0] op_sel_hi:[1,1,0] neg_lo:[0,0,1] neg_hi:[0,0,1]
    v_pk_fma_f32 v[252:253], v[252:253], v[20:21], v[20:21] op_sel:[0,1,0] op_sel_hi:[1,1,0] neg_lo:[0,0,1] neg_hi:[0,0,1]
    v_cvt_pk_bf16_f32 v208, v250, v251
    v_cvt_pk_bf16_f32 v209, v252, v253
    buffer_load_dwordx4 v[144:147], v5, s[40:43], s50 offen
    v_lshlrev_b32 v250, 16, v210
    v_lshlrev_b32 v252, 16, v211
    v_and_b32 v251, 0xffff0000, v210
    v_and_b32 v253, 0xffff0000, v211
    v_pk_fma_f32 v[250:251], v[250:251], v[20:21], v[20:21] op_sel:[0,1,0] op_sel_hi:[1,1,0] neg_lo:[0,0,1] neg_hi:[0,0,1]
    v_pk_fma_f32 v[252:253], v[252:253], v[20:21], v[20:21] op_sel:[0,1,0] op_sel_hi:[1,1,0] neg_lo:[0,0,1] neg_hi:[0,0,1]
    v_cvt_pk_bf16_f32 v210, v250, v251
    v_cvt_pk_bf16_f32 v211, v252, v253
    ds_write_b128 v26, v[208:211] offset:43008
    buffer_load_dwordx4 v[148:151], v6, s[40:43], s50 offen
    v_lshlrev_b32 v250, 16, v212
    v_lshlrev_b32 v252, 16, v213
    v_and_b32 v251, 0xffff0000, v212
    v_and_b32 v253, 0xffff0000, v213
    v_pk_fma_f32 v[250:251], v[250:251], v[22:23], v[22:23] op_sel:[0,1,0] op_sel_hi:[1,1,0] neg_lo:[0,0,1] neg_hi:[0,0,1]
    v_pk_fma_f32 v[252:253], v[252:253], v[22:23], v[22:23] op_sel:[0,1,0] op_sel_hi:[1,1,0] neg_lo:[0,0,1] neg_hi:[0,0,1]
    v_cvt_pk_bf16_f32 v212, v250, v251
    v_cvt_pk_bf16_f32 v213, v252, v253
    v_lshlrev_b32 v250, 16, v214
    v_lshlrev_b32 v252, 16, v215
    v_and_b32 v251, 0xffff0000, v214
    v_and_b32 v253, 0xffff0000, v215
    v_pk_fma_f32 v[250:251], v[250:251], v[22:23], v[22:23] op_sel:[0,1,0] op_sel_hi:[1,1,0] neg_lo:[0,0,1] neg_hi:[0,0,1]
    v_pk_fma_f32 v[252:253], v[252:253], v[22:23], v[22:23] op_sel:[0,1,0] op_sel_hi:[1,1,0] neg_lo:[0,0,1] neg_hi:[0,0,1]
    v_cvt_pk_bf16_f32 v214, v250, v251
    v_cvt_pk_bf16_f32 v215, v252, v253
    ds_write_b128 v26, v[212:215] offset:44032
    buffer_load_dwordx4 v[152:155], v7, s[40:43], s50 offen
    v_lshlrev_b32 v250, 16, v216
    v_lshlrev_b32 v252, 16, v217
    v_and_b32 v251, 0xffff0000, v216
    v_and_b32 v253, 0xffff0000, v217
    v_pk_fma_f32 v[250:251], v[250:251], v[24:25], v[24:25] op_sel:[0,1,0] op_sel_hi:[1,1,0] neg_lo:[0,0,1] neg_hi:[0,0,1]
    v_pk_fma_f32 v[252:253], v[252:253], v[24:25], v[24:25] op_sel:[0,1,0] op_sel_hi:[1,1,0] neg_lo:[0,0,1] neg_hi:[0,0,1]
    v_cvt_pk_bf16_f32 v216, v250, v251
    v_cvt_pk_bf16_f32 v217, v252, v253
    s_add_u32 m0, s52, 16384
    buffer_load_dwordx4 v[156:159], v8, s[40:43], s50 offen
    v_lshlrev_b32 v250, 16, v218
    v_lshlrev_b32 v252, 16, v219
    v_and_b32 v251, 0xffff0000, v218
    v_and_b32 v253, 0xffff0000, v219
    v_pk_fma_f32 v[250:251], v[250:251], v[24:25], v[24:25] op_sel:[0,1,0] op_sel_hi:[1,1,0] neg_lo:[0,0,1] neg_hi:[0,0,1]
    v_pk_fma_f32 v[252:253], v[252:253], v[24:25], v[24:25] op_sel:[0,1,0] op_sel_hi:[1,1,0] neg_lo:[0,0,1] neg_hi:[0,0,1]
    v_cvt_pk_bf16_f32 v218, v250, v251
    v_cvt_pk_bf16_f32 v219, v252, v253
    ds_write_b128 v26, v[216:219] offset:45056
    v_lshlrev_b32 v250, 16, v220
    v_lshlrev_b32 v252, 16, v221
    v_and_b32 v251, 0xffff0000, v220
    v_and_b32 v253, 0xffff0000, v221
    v_pk_fma_f32 v[250:251], v[250:251], v[16:17], v[16:17] op_sel:[0,1,0] op_sel_hi:[1,1,0] neg_lo:[0,0,1] neg_hi:[0,0,1]
    v_pk_fma_f32 v[252:253], v[252:253], v[16:17], v[16:17] op_sel:[0,1,0] op_sel_hi:[1,1,0] neg_lo:[0,0,1] neg_hi:[0,0,1]
    v_cvt_pk_bf16_f32 v220, v250, v251
    v_cvt_pk_bf16_f32 v221, v252, v253
    buffer_load_dwordx4 v9, s[40:43], s50 offen lds
    v_lshlrev_b32 v250, 16, v222
    v_lshlrev_b32 v252, 16, v223
    v_and_b32 v251, 0xffff0000, v222
    v_and_b32 v253, 0xffff0000, v223
    v_pk_fma_f32 v[250:251], v[250:251], v[16:17], v[16:17] op_sel:[0,1,0] op_sel_hi:[1,1,0] neg_lo:[0,0,1] neg_hi:[0,0,1]
    v_pk_fma_f32 v[252:253], v[252:253], v[16:17], v[16:17] op_sel:[0,1,0] op_sel_hi:[1,1,0] neg_lo:[0,0,1] neg_hi:[0,0,1]
    v_cvt_pk_bf16_f32 v222, v250, v251
    v_cvt_pk_bf16_f32 v223, v252, v253
    ds_write_b128 v26, v[220:223] offset:61440
    s_mov_b32 s50, 1179648
    buffer_load_dwordx4 v[160:163], v1, s[40:43], s50 offen
    v_lshlrev_b32 v250, 16, v224
    v_lshlrev_b32 v252, 16, v225
    v_and_b32 v251, 0xffff0000, v224
    v_and_b32 v253, 0xffff0000, v225
    v_pk_fma_f32 v[250:251], v[250:251], v[18:19], v[18:19] op_sel:[0,1,0] op_sel_hi:[1,1,0] neg_lo:[0,0,1] neg_hi:[0,0,1]
    v_pk_fma_f32 v[252:253], v[252:253], v[18:19], v[18:19] op_sel:[0,1,0] op_sel_hi:[1,1,0] neg_lo:[0,0,1] neg_hi:[0,0,1]
    v_cvt_pk_bf16_f32 v224, v250, v251
    v_cvt_pk_bf16_f32 v225, v252, v253
    v_lshlrev_b32 v250, 16, v226
    v_lshlrev_b32 v252, 16, v227
    v_and_b32 v251, 0xffff0000, v226
    v_and_b32 v253, 0xffff0000, v227
    v_pk_fma_f32 v[250:251], v[250:251], v[18:19], v[18:19] op_sel:[0,1,0] op_sel_hi:[1,1,0] neg_lo:[0,0,1] neg_hi:[0,0,1]
    v_pk_fma_f32 v[252:253], v[252:253], v[18:19], v[18:19] op_sel:[0,1,0] op_sel_hi:[1,1,0] neg_lo:[0,0,1] neg_hi:[0,0,1]
    v_cvt_pk_bf16_f32 v226, v250, v251
    v_cvt_pk_bf16_f32 v227, v252, v253
    ds_write_b128 v26, v[224:227] offset:62464
    buffer_load_dwordx4 v[164:167], v2, s[40:43], s50 offen
    v_lshlrev_b32 v250, 16, v228
    v_lshlrev_b32 v252, 16, v229
    v_and_b32 v251, 0xffff0000, v228
    v_and_b32 v253, 0xffff0000, v229
    v_pk_fma_f32 v[250:251], v[250:251], v[20:21], v[20:21] op_sel:[0,1,0] op_sel_hi:[1,1,0] neg_lo:[0,0,1] neg_hi:[0,0,1]
    v_pk_fma_f32 v[252:253], v[252:253], v[20:21], v[20:21] op_sel:[0,1,0] op_sel_hi:[1,1,0] neg_lo:[0,0,1] neg_hi:[0,0,1]
    v_cvt_pk_bf16_f32 v228, v250, v251
    v_cvt_pk_bf16_f32 v229, v252, v253
    buffer_load_dwordx4 v[168:171], v3, s[40:43], s50 offen
    v_lshlrev_b32 v250, 16, v230
    v_lshlrev_b32 v252, 16, v231
    v_and_b32 v251, 0xffff0000, v230
    v_and_b32 v253, 0xffff0000, v231
    v_pk_fma_f32 v[250:251], v[250:251], v[20:21], v[20:21] op_sel:[0,1,0] op_sel_hi:[1,1,0] neg_lo:[0,0,1] neg_hi:[0,0,1]
    v_pk_fma_f32 v[252:253], v[252:253], v[20:21], v[20:21] op_sel:[0,1,0] op_sel_hi:[1,1,0] neg_lo:[0,0,1] neg_hi:[0,0,1]
    v_cvt_pk_bf16_f32 v230, v250, v251
    v_cvt_pk_bf16_f32 v231, v252, v253
    ds_write_b128 v26, v[228:231] offset:63488
    v_lshlrev_b32 v250, 16, v232
    v_lshlrev_b32 v252, 16, v233
    v_and_b32 v251, 0xffff0000, v232
    v_and_b32 v253, 0xffff0000, v233
    v_pk_fma_f32 v[250:251], v[250:251], v[22:23], v[22:23] op_sel:[0,1,0] op_sel_hi:[1,1,0] neg_lo:[0,0,1] neg_hi:[0,0,1]
    v_pk_fma_f32 v[252:253], v[252:253], v[22:23], v[22:23] op_sel:[0,1,0] op_sel_hi:[1,1,0] neg_lo:[0,0,1] neg_hi:[0,0,1]
    v_cvt_pk_bf16_f32 v232, v250, v251
    v_cvt_pk_bf16_f32 v233, v252, v253
    buffer_load_dwordx4 v[172:175], v4, s[40:43], s50 offen
    v_lshlrev_b32 v250, 16, v234
    v_lshlrev_b32 v252, 16, v235
    v_and_b32 v251, 0xffff0000, v234
    v_and_b32 v253, 0xffff0000, v235
    v_pk_fma_f32 v[250:251], v[250:251], v[22:23], v[22:23] op_sel:[0,1,0] op_sel_hi:[1,1,0] neg_lo:[0,0,1] neg_hi:[0,0,1]
    v_pk_fma_f32 v[252:253], v[252:253], v[22:23], v[22:23] op_sel:[0,1,0] op_sel_hi:[1,1,0] neg_lo:[0,0,1] neg_hi:[0,0,1]
    v_cvt_pk_bf16_f32 v234, v250, v251
    v_cvt_pk_bf16_f32 v235, v252, v253
    ds_write_b128 v26, v[232:235] offset:64512
    buffer_load_dwordx4 v[176:179], v5, s[40:43], s50 offen
    v_lshlrev_b32 v250, 16, v236
    v_lshlrev_b32 v252, 16, v237
    v_and_b32 v251, 0xffff0000, v236
    v_and_b32 v253, 0xffff0000, v237
    v_pk_fma_f32 v[250:251], v[250:251], v[24:25], v[24:25] op_sel:[0,1,0] op_sel_hi:[1,1,0] neg_lo:[0,0,1] neg_hi:[0,0,1]
    v_pk_fma_f32 v[252:253], v[252:253], v[24:25], v[24:25] op_sel:[0,1,0] op_sel_hi:[1,1,0] neg_lo:[0,0,1] neg_hi:[0,0,1]
    v_cvt_pk_bf16_f32 v236, v250, v251
    v_cvt_pk_bf16_f32 v237, v252, v253
    v_lshlrev_b32 v250, 16, v238
    v_lshlrev_b32 v252, 16, v239
    v_and_b32 v251, 0xffff0000, v238
    v_and_b32 v253, 0xffff0000, v239
    v_pk_fma_f32 v[250:251], v[250:251], v[24:25], v[24:25] op_sel:[0,1,0] op_sel_hi:[1,1,0] neg_lo:[0,0,1] neg_hi:[0,0,1]
    v_pk_fma_f32 v[252:253], v[252:253], v[24:25], v[24:25] op_sel:[0,1,0] op_sel_hi:[1,1,0] neg_lo:[0,0,1] neg_hi:[0,0,1]
    v_cvt_pk_bf16_f32 v238, v250, v251
    v_cvt_pk_bf16_f32 v239, v252, v253
    v_add_u32 v26, 1024, v26
    ds_write_b128 v26, v[236:239] offset:64512
    buffer_load_dwordx4 v[180:183], v6, s[40:43], s50 offen
    v_lshlrev_b32 v250, 16, v240
    v_lshlrev_b32 v252, 16, v241
    v_and_b32 v251, 0xffff0000, v240
    v_and_b32 v253, 0xffff0000, v241
    v_pk_fma_f32 v[250:251], v[250:251], v[16:17], v[16:17] op_sel:[0,1,0] op_sel_hi:[1,1,0] neg_lo:[0,0,1] neg_hi:[0,0,1]
    v_pk_fma_f32 v[252:253], v[252:253], v[16:17], v[16:17] op_sel:[0,1,0] op_sel_hi:[1,1,0] neg_lo:[0,0,1] neg_hi:[0,0,1]
    v_cvt_pk_bf16_f32 v240, v250, v251
    v_cvt_pk_bf16_f32 v241, v252, v253
    ds_write_b64 v28, v[240:241] offset:0
    buffer_load_dwordx4 v[184:187], v7, s[40:43], s50 offen
    v_lshlrev_b32 v250, 16, v242
    v_lshlrev_b32 v252, 16, v243
    v_and_b32 v251, 0xffff0000, v242
    v_and_b32 v253, 0xffff0000, v243
    v_pk_fma_f32 v[250:251], v[250:251], v[18:19], v[18:19] op_sel:[0,1,0] op_sel_hi:[1,1,0] neg_lo:[0,0,1] neg_hi:[0,0,1]
    v_pk_fma_f32 v[252:253], v[252:253], v[18:19], v[18:19] op_sel:[0,1,0] op_sel_hi:[1,1,0] neg_lo:[0,0,1] neg_hi:[0,0,1]
    v_cvt_pk_bf16_f32 v242, v250, v251
    v_cvt_pk_bf16_f32 v243, v252, v253
    ds_write_b64 v28, v[242:243] offset:1024
    v_lshlrev_b32 v250, 16, v244
    v_lshlrev_b32 v252, 16, v245
    v_and_b32 v251, 0xffff0000, v244
    v_and_b32 v253, 0xffff0000, v245
    v_pk_fma_f32 v[250:251], v[250:251], v[20:21], v[20:21] op_sel:[0,1,0] op_sel_hi:[1,1,0] neg_lo:[0,0,1] neg_hi:[0,0,1]
    v_pk_fma_f32 v[252:253], v[252:253], v[20:21], v[20:21] op_sel:[0,1,0] op_sel_hi:[1,1,0] neg_lo:[0,0,1] neg_hi:[0,0,1]
    v_cvt_pk_bf16_f32 v244, v250, v251
    v_cvt_pk_bf16_f32 v245, v252, v253
    ds_write_b64 v28, v[244:245] offset:2048
    s_add_u32 m0, s52, 20480
    buffer_load_dwordx4 v[188:191], v8, s[40:43], s50 offen
    v_lshlrev_b32 v250, 16, v246
    v_lshlrev_b32 v252, 16, v247
    v_and_b32 v251, 0xffff0000, v246
    v_and_b32 v253, 0xffff0000, v247
    v_pk_fma_f32 v[250:251], v[250:251], v[22:23], v[22:23] op_sel:[0,1,0] op_sel_hi:[1,1,0] neg_lo:[0,0,1] neg_hi:[0,0,1]
    v_pk_fma_f32 v[252:253], v[252:253], v[22:23], v[22:23] op_sel:[0,1,0] op_sel_hi:[1,1,0] neg_lo:[0,0,1] neg_hi:[0,0,1]
    v_cvt_pk_bf16_f32 v246, v250, v251
    v_cvt_pk_bf16_f32 v247, v252, v253
    ds_write_b64 v28, v[246:247] offset:3072
    buffer_load_dwordx4 v9, s[40:43], s50 offen lds
    v_lshlrev_b32 v250, 16, v248
    v_lshlrev_b32 v252, 16, v249
    v_and_b32 v251, 0xffff0000, v248
    v_and_b32 v253, 0xffff0000, v249
    v_pk_fma_f32 v[250:251], v[250:251], v[24:25], v[24:25] op_sel:[0,1,0] op_sel_hi:[1,1,0] neg_lo:[0,0,1] neg_hi:[0,0,1]
    v_pk_fma_f32 v[252:253], v[252:253], v[24:25], v[24:25] op_sel:[0,1,0] op_sel_hi:[1,1,0] neg_lo:[0,0,1] neg_hi:[0,0,1]
    v_cvt_pk_bf16_f32 v248, v250, v251
    v_cvt_pk_bf16_f32 v249, v252, v253
    ds_write_b64 v28, v[248:249] offset:4096
    v_add_u32 v20, s90, v0
    v_xor_b32 v21, 48, v20
    v_add_u32 v22, s91, v0
    v_xor_b32 v23, 48, v22
    v_add_u32 v24, s92, v0
    v_xor_b32 v25, 48, v24
    s_lshl_b32 s33, s31, 11
    s_add_u32 s33, s33, 33554432
    s_or_b32 s34, s32, s30
    s_cmp_eq_u32 s34, 0
    s_cselect_b32 s33, s33, 0x40000000
    v_lshlrev_b32 v27, 5, v13
    v_mov_b32 v28, 0
    v_mov_b32 v29, 0
    s_waitcnt lgkmcnt(0)
    s_barrier
    ds_read_b128 a[180:183], v10 offset:0
    ds_read_b128 a[184:187], v10 offset:1024
    ds_read_b128 a[188:191], v10 offset:2048
    ds_read_b128 a[192:195], v10 offset:3072
    ds_read_b128 a[196:199], v10 offset:4096
    ds_read_b64_tr_b16 v[192:193], v20
    ds_read_b64_tr_b16 v[194:195], v21 offset:256
    ds_read_b64_tr_b16 v[196:197], v22
    ds_read_b64_tr_b16 v[198:199], v23 offset:256
    ds_read_b64_tr_b16 v[200:201], v24
    ds_read_b64_tr_b16 v[202:203], v25 offset:256
    buffer_store_dwordx2 v[28:29], v27, s[44:47], s33 offen sc0 sc1
    s_waitcnt vmcnt(37)
    s_barrier
    v_perm_b32 v16, v36, v32, s48
    v_perm_b32 v17, v44, v40, s48
    v_perm_b32 v18, v52, v48, s48
    v_perm_b32 v19, v60, v56, s48
    s_mov_b32 s53, 0
    s_mov_b32 s51, 294912
    s_waitcnt lgkmcnt(0)
    buffer_store_dwordx4 v[192:195], v30, s[56:59], s60 offen sc0 sc1
    buffer_store_dwordx4 v[196:199], v30, s[56:59], s61 offen sc0 sc1
    buffer_store_dwordx4 v[200:203], v30, s[56:59], s62 offen sc0 sc1
    v_accvgpr_read_b32 v250, a244
    v_accvgpr_read_b32 v252, a245
    v_add_u32 v251, 4096, v250
    buffer_load_dwordx4 v[224:227], v250, s[4:7], s86 offen
    buffer_load_dwordx4 v[228:231], v251, s[4:7], s86 offen
    buffer_load_dwordx4 v[232:235], v252, s[4:7], s86 offen
    s_mov_b32 s50, 1474560
    .p2alignl 3, 0xbf800000
L_gemm_zero:
    v_mfma_f32_16x16x32_bf16 a[0:3], a[180:183], v[16:19], 0
    v_perm_b32 v20, v36, v32, s49
    v_perm_b32 v21, v44, v40, s49
    v_mfma_f32_16x16x32_bf16 a[4:7], a[184:187], v[16:19], 0
    v_perm_b32 v22, v52, v48, s49
    v_perm_b32 v23, v60, v56, s49
    v_mfma_f32_16x16x32_bf16 a[8:11], a[188:191], v[16:19], 0
    ds_read_b64_tr_b16 v[24:25], v11 offset:0
    v_mfma_f32_16x16x32_bf16 a[12:15], a[192:195], v[16:19], 0
    ds_read_b64_tr_b16 v[26:27], v11 offset:2048
    v_mfma_f32_16x16x32_bf16 a[16:19], a[196:199], v[16:19], 0
    buffer_load_dwordx4 v[192:195], v1, s[40:43], s50 offen
    v_mfma_f32_16x16x32_bf16 a[20:23], a[180:183], v[20:23], 0
    v_perm_b32 v16, v37, v33, s48
    v_perm_b32 v17, v45, v41, s48
    v_mfma_f32_16x16x32_bf16 a[24:27], a[184:187], v[20:23], 0
    v_perm_b32 v18, v53, v49, s48
    v_perm_b32 v19, v61, v57, s48
    v_mfma_f32_16x16x32_bf16 a[28:31], a[188:191], v[20:23], 0
    ds_read_b128 a[200:203], v10 offset:5120
    v_mfma_f32_16x16x32_bf16 a[32:35], a[192:195], v[20:23], 0
    ds_read_b128 a[204:207], v10 offset:6144
    v_mfma_f32_16x16x32_bf16 a[36:39], a[196:199], v[20:23], 0
    buffer_load_dwordx4 v[196:199], v2, s[40:43], s50 offen
    v_mfma_f32_16x16x32_bf16 a[40:43], a[180:183], v[16:19], 0
    v_perm_b32 v20, v37, v33, s49
    v_perm_b32 v21, v45, v41, s49
    v_mfma_f32_16x16x32_bf16 a[44:47], a[184:187], v[16:19], 0
    v_perm_b32 v22, v53, v49, s49
    v_perm_b32 v23, v61, v57, s49
    v_mfma_f32_16x16x32_bf16 a[48:51], a[188:191], v[16:19], 0
    ds_read_b128 a[208:211], v10 offset:7168
    v_mfma_f32_16x16x32_bf16 a[52:55], a[192:195], v[16:19], 0
    ds_read_b128 a[212:215], v10 offset:8192
    v_mfma_f32_16x16x32_bf16 a[56:59], a[196:199], v[16:19], 0
    buffer_load_dwordx4 v[200:203], v3, s[40:43], s50 offen
    v_mfma_f32_16x16x32_bf16 a[60:63], a[180:183], v[20:23], 0
    v_perm_b32 v16, v38, v34, s48
    v_perm_b32 v17, v46, v42, s48
    v_mfma_f32_16x16x32_bf16 a[64:67], a[184:187], v[20:23], 0
    v_perm_b32 v18, v54, v50, s48
    v_perm_b32 v19, v62, v58, s48
    v_mfma_f32_16x16x32_bf16 a[68:71], a[188:191], v[20:23], 0
    ds_read_b128 a[216:219], v10 offset:9216
    v_mfma_f32_16x16x32_bf16 a[72:75], a[192:195], v[20:23], 0
    s_add_u32 s55, s50, s51
    v_mfma_f32_16x16x32_bf16 a[76:79], a[196:199], v[20:23], 0
    buffer_load_dwordx4 v[204:207], v4, s[40:43], s50 offen
    v_mfma_f32_16x16x32_bf16 a[80:83], a[180:183], v[16:19], 0
    v_perm_b32 v20, v38, v34, s49
    v_mfma_f32_16x16x32_bf16 a[84:87], a[184:187], v[16:19], 0
    v_perm_b32 v21, v46, v42, s49
    v_mfma_f32_16x16x32_bf16 a[88:91], a[188:191], v[16:19], 0
    v_perm_b32 v22, v54, v50, s49
    v_mfma_f32_16x16x32_bf16 a[92:95], a[192:195], v[16:19], 0
    v_perm_b32 v23, v62, v58, s49
    v_mfma_f32_16x16x32_bf16 a[96:99], a[196:199], v[16:19], 0
    buffer_load_dwordx4 v[208:211], v5, s[40:43], s50 offen
    v_mfma_f32_16x16x32_bf16 a[100:103], a[180:183], v[20:23], 0
    v_perm_b32 v16, v39, v35, s48
    v_mfma_f32_16x16x32_bf16 a[104:107], a[184:187], v[20:23], 0
    v_perm_b32 v17, v47, v43, s48
    v_mfma_f32_16x16x32_bf16 a[108:111], a[188:191], v[20:23], 0
    v_perm_b32 v18, v55, v51, s48
    v_mfma_f32_16x16x32_bf16 a[112:115], a[192:195], v[20:23], 0
    v_perm_b32 v19, v63, v59, s48
    v_mfma_f32_16x16x32_bf16 a[116:119], a[196:199], v[20:23], 0
    buffer_load_dwordx4 v[212:215], v6, s[40:43], s50 offen
    v_mfma_f32_16x16x32_bf16 a[120:123], a[180:183], v[16:19], 0
    v_perm_b32 v20, v39, v35, s49
    v_mfma_f32_16x16x32_bf16 a[124:127], a[184:187], v[16:19], 0
    v_perm_b32 v21, v47, v43, s49
    v_mfma_f32_16x16x32_bf16 a[128:131], a[188:191], v[16:19], 0
    v_perm_b32 v22, v55, v51, s49
    v_mfma_f32_16x16x32_bf16 a[132:135], a[192:195], v[16:19], 0
    v_perm_b32 v23, v63, v59, s49
    v_mfma_f32_16x16x32_bf16 a[136:139], a[196:199], v[16:19], 0
    buffer_load_dwordx4 v[216:219], v7, s[40:43], s50 offen
    v_mfma_f32_16x16x32_bf16 a[140:143], a[180:183], v[20:23], 0
    v_mfma_f32_16x16x32_bf16 a[144:147], a[184:187], v[20:23], 0
    v_mfma_f32_16x16x32_bf16 a[148:151], a[188:191], v[20:23], 0
    s_add_u32 m0, s52, 24576
    v_mfma_f32_16x16x32_bf16 a[152:155], a[192:195], v[20:23], 0
    s_waitcnt vmcnt(25) lgkmcnt(0)
    s_barrier
    v_mfma_f32_16x16x32_bf16 a[156:159], a[196:199], v[20:23], 0
    buffer_load_dwordx4 v[220:223], v8, s[40:43], s50 offen
    v_mfma_f32_16x16x32_bf16 a[160:163], v[24:27], a[180:183], 0
    v_perm_b32 v16, v68, v64, s48
    v_mfma_f32_16x16x32_bf16 a[164:167], v[24:27], a[184:187], 0
    v_perm_b32 v17, v76, v72, s48
    v_mfma_f32_16x16x32_bf16 a[168:171], v[24:27], a[188:191], 0
    v_perm_b32 v18, v84, v80, s48
    v_mfma_f32_16x16x32_bf16 a[172:175], v[24:27], a[192:195], 0
    v_perm_b32 v19, v92, v88, s48
    v_mfma_f32_16x16x32_bf16 a[176:179], v[24:27], a[196:199], 0
    buffer_load_dwordx4 v9, s[40:43], s50 offen lds
    s_branch L_gemm_p1
    .p2alignl 6, 0xbf800000
L_gemm_loop:
    v_mfma_f32_16x16x32_bf16 a[0:3], a[180:183], v[16:19], a[0:3]
    v_perm_b32 v20, v36, v32, s49
    v_perm_b32 v21, v44, v40, s49
    v_mfma_f32_16x16x32_bf16 a[4:7], a[184:187], v[16:19], a[4:7]
    v_perm_b32 v22, v52, v48, s49
    v_perm_b32 v23, v60, v56, s49
    v_mfma_f32_16x16x32_bf16 a[8:11], a[188:191], v[16:19], a[8:11]
    ds_read_b64_tr_b16 v[24:25], v11 offset:0
    v_mfma_f32_16x16x32_bf16 a[12:15], a[192:195], v[16:19], a[12:15]
    ds_read_b64_tr_b16 v[26:27], v11 offset:2048
    v_mfma_f32_16x16x32_bf16 a[16:19], a[196:199], v[16:19], a[16:19]
    buffer_load_dwordx4 v[192:195], v1, s[40:43], s50 offen
    v_mfma_f32_16x16x32_bf16 a[20:23], a[180:183], v[20:23], a[20:23]
    v_perm_b32 v16, v37, v33, s48
    v_perm_b32 v17, v45, v41, s48
    v_mfma_f32_16x16x32_bf16 a[24:27], a[184:187], v[20:23], a[24:27]
    v_perm_b32 v18, v53, v49, s48
    v_perm_b32 v19, v61, v57, s48
    v_mfma_f32_16x16x32_bf16 a[28:31], a[188:191], v[20:23], a[28:31]
    ds_read_b128 a[200:203], v10 offset:5120
    v_mfma_f32_16x16x32_bf16 a[32:35], a[192:195], v[20:23], a[32:35]
    ds_read_b128 a[204:207], v10 offset:6144
    v_mfma_f32_16x16x32_bf16 a[36:39], a[196:199], v[20:23], a[36:39]
    buffer_load_dwordx4 v[196:199], v2, s[40:43], s50 offen
    v_mfma_f32_16x16x32_bf16 a[40:43], a[180:183], v[16:19], a[40:43]
    v_perm_b32 v20, v37, v33, s49
    v_perm_b32 v21, v45, v41, s49
    v_mfma_f32_16x16x32_bf16 a[44:47], a[184:187], v[16:19], a[44:47]
    v_perm_b32 v22, v53, v49, s49
    v_perm_b32 v23, v61, v57, s49
    v_mfma_f32_16x16x32_bf16 a[48:51], a[188:191], v[16:19], a[48:51]
    ds_read_b128 a[208:211], v10 offset:7168
    v_mfma_f32_16x16x32_bf16 a[52:55], a[192:195], v[16:19], a[52:55]
    ds_read_b128 a[212:215], v10 offset:8192
    v_mfma_f32_16x16x32_bf16 a[56:59], a[196:199], v[16:19], a[56:59]
    buffer_load_dwordx4 v[200:203], v3, s[40:43], s50 offen
    v_mfma_f32_16x16x32_bf16 a[60:63], a[180:183], v[20:23], a[60:63]
    v_perm_b32 v16, v38, v34, s48
    v_perm_b32 v17, v46, v42, s48
    v_mfma_f32_16x16x32_bf16 a[64:67], a[184:187], v[20:23], a[64:67]
    v_perm_b32 v18, v54, v50, s48
    v_perm_b32 v19, v62, v58, s48
    v_mfma_f32_16x16x32_bf16 a[68:71], a[188:191], v[20:23], a[68:71]
    ds_read_b128 a[216:219], v10 offset:9216
    v_mfma_f32_16x16x32_bf16 a[72:75], a[192:195], v[20:23], a[72:75]
    s_add_u32 s55, s50, s51
    v_mfma_f32_16x16x32_bf16 a[76:79], a[196:199], v[20:23], a[76:79]
    buffer_load_dwordx4 v[204:207], v4, s[40:43], s50 offen
    v_mfma_f32_16x16x32_bf16 a[80:83], a[180:183], v[16:19], a[80:83]
    v_perm_b32 v20, v38, v34, s49
    v_mfma_f32_16x16x32_bf16 a[84:87], a[184:187], v[16:19], a[84:87]
    v_perm_b32 v21, v46, v42, s49
    v_mfma_f32_16x16x32_bf16 a[88:91], a[188:191], v[16:19], a[88:91]
    v_perm_b32 v22, v54, v50, s49
    v_mfma_f32_16x16x32_bf16 a[92:95], a[192:195], v[16:19], a[92:95]
    v_perm_b32 v23, v62, v58, s49
    v_mfma_f32_16x16x32_bf16 a[96:99], a[196:199], v[16:19], a[96:99]
    buffer_load_dwordx4 v[208:211], v5, s[40:43], s50 offen
    v_mfma_f32_16x16x32_bf16 a[100:103], a[180:183], v[20:23], a[100:103]
    v_perm_b32 v16, v39, v35, s48
    v_mfma_f32_16x16x32_bf16 a[104:107], a[184:187], v[20:23], a[104:107]
    v_perm_b32 v17, v47, v43, s48
    v_mfma_f32_16x16x32_bf16 a[108:111], a[188:191], v[20:23], a[108:111]
    v_perm_b32 v18, v55, v51, s48
    v_mfma_f32_16x16x32_bf16 a[112:115], a[192:195], v[20:23], a[112:115]
    v_perm_b32 v19, v63, v59, s48
    v_mfma_f32_16x16x32_bf16 a[116:119], a[196:199], v[20:23], a[116:119]
    buffer_load_dwordx4 v[212:215], v6, s[40:43], s50 offen
    v_mfma_f32_16x16x32_bf16 a[120:123], a[180:183], v[16:19], a[120:123]
    v_perm_b32 v20, v39, v35, s49
    v_mfma_f32_16x16x32_bf16 a[124:127], a[184:187], v[16:19], a[124:127]
    v_perm_b32 v21, v47, v43, s49
    v_mfma_f32_16x16x32_bf16 a[128:131], a[188:191], v[16:19], a[128:131]
    v_perm_b32 v22, v55, v51, s49
    v_mfma_f32_16x16x32_bf16 a[132:135], a[192:195], v[16:19], a[132:135]
    v_perm_b32 v23, v63, v59, s49
    v_mfma_f32_16x16x32_bf16 a[136:139], a[196:199], v[16:19], a[136:139]
    buffer_load_dwordx4 v[216:219], v7, s[40:43], s50 offen
    v_mfma_f32_16x16x32_bf16 a[140:143], a[180:183], v[20:23], a[140:143]
    v_mfma_f32_16x16x32_bf16 a[144:147], a[184:187], v[20:23], a[144:147]
    v_mfma_f32_16x16x32_bf16 a[148:151], a[188:191], v[20:23], a[148:151]
    s_add_u32 m0, s52, 24576
    v_mfma_f32_16x16x32_bf16 a[152:155], a[192:195], v[20:23], a[152:155]
    s_waitcnt vmcnt(25) lgkmcnt(0)
    s_barrier
    v_mfma_f32_16x16x32_bf16 a[156:159], a[196:199], v[20:23], a[156:159]
    buffer_load_dwordx4 v[220:223], v8, s[40:43], s50 offen
    v_mfma_f32_16x16x32_bf16 a[160:163], v[24:27], a[180:183], a[160:163]
    v_perm_b32 v16, v68, v64, s48
    v_mfma_f32_16x16x32_bf16 a[164:167], v[24:27], a[184:187], a[164:167]
    v_perm_b32 v17, v76, v72, s48
    v_mfma_f32_16x16x32_bf16 a[168:171], v[24:27], a[188:191], a[168:171]
    v_perm_b32 v18, v84, v80, s48
    v_mfma_f32_16x16x32_bf16 a[172:175], v[24:27], a[192:195], a[172:175]
    v_perm_b32 v19, v92, v88, s48
    v_mfma_f32_16x16x32_bf16 a[176:179], v[24:27], a[196:199], a[176:179]
    buffer_load_dwordx4 v9, s[40:43], s50 offen lds
L_gemm_p1:
    s_cmp_eq_u32 s53, 2
    s_cbranch_scc1 L_switch
L_sw_back:
    v_mfma_f32_16x16x32_bf16 a[0:3], a[200:203], v[16:19], a[0:3]
    v_perm_b32 v20, v68, v64, s49
    v_perm_b32 v21, v76, v72, s49
    v_mfma_f32_16x16x32_bf16 a[4:7], a[204:207], v[16:19], a[4:7]
    v_perm_b32 v22, v84, v80, s49
    v_perm_b32 v23, v92, v88, s49
    v_mfma_f32_16x16x32_bf16 a[8:11], a[208:211], v[16:19], a[8:11]
    ds_read_b64_tr_b16 v[24:25], v11 offset:4096
    v_mfma_f32_16x16x32_bf16 a[12:15], a[212:215], v[16:19], a[12:15]
    ds_read_b64_tr_b16 v[26:27], v11 offset:6144
    v_mfma_f32_16x16x32_bf16 a[16:19], a[216:219], v[16:19], a[16:19]
    buffer_load_dwordx4 v[32:35], v1, s[40:43], s55 offen
    v_mfma_f32_16x16x32_bf16 a[20:23], a[200:203], v[20:23], a[20:23]
    v_perm_b32 v16, v69, v65, s48
    v_perm_b32 v17, v77, v73, s48
    v_mfma_f32_16x16x32_bf16 a[24:27], a[204:207], v[20:23], a[24:27]
    v_perm_b32 v18, v85, v81, s48
    v_perm_b32 v19, v93, v89, s48
    v_mfma_f32_16x16x32_bf16 a[28:31], a[208:211], v[20:23], a[28:31]
    ds_read_b128 a[180:183], v10 offset:10240
    v_mfma_f32_16x16x32_bf16 a[32:35], a[212:215], v[20:23], a[32:35]
    ds_read_b128 a[184:187], v10 offset:11264
    v_mfma_f32_16x16x32_bf16 a[36:39], a[216:219], v[20:23], a[36:39]
    buffer_load_dwordx4 v[36:39], v2, s[40:43], s55 offen
    v_mfma_f32_16x16x32_bf16 a[40:43], a[200:203], v[16:19], a[40:43]
    v_perm_b32 v20, v69, v65, s49
    v_perm_b32 v21, v77, v73, s49
    v_mfma_f32_16x16x32_bf16 a[44:47], a[204:207], v[16:19], a[44:47]
    v_perm_b32 v22, v85, v81, s49
    v_perm_b32 v23, v93, v89, s49
    v_mfma_f32_16x16x32_bf16 a[48:51], a[208:211], v[16:19], a[48:51]
    ds_read_b128 a[188:191], v10 offset:12288
    v_mfma_f32_16x16x32_bf16 a[52:55], a[212:215], v[16:19], a[52:55]
    ds_read_b128 a[192:195], v10 offset:13312
    v_mfma_f32_16x16x32_bf16 a[56:59], a[216:219], v[16:19], a[56:59]
    buffer_load_dwordx4 v[40:43], v3, s[40:43], s55 offen
    v_mfma_f32_16x16x32_bf16 a[60:63], a[200:203], v[20:23], a[60:63]
    v_perm_b32 v16, v70, v66, s48
    v_perm_b32 v17, v78, v74, s48
    v_mfma_f32_16x16x32_bf16 a[64:67], a[204:207], v[20:23], a[64:67]
    v_perm_b32 v18, v86, v82, s48
    v_perm_b32 v19, v94, v90, s48
    v_mfma_f32_16x16x32_bf16 a[68:71], a[208:211], v[20:23], a[68:71]
    ds_read_b128 a[196:199], v10 offset:14336
    v_mfma_f32_16x16x32_bf16 a[72:75], a[212:215], v[20:23], a[72:75]
    s_add_u32 s50, s55, s51
    v_mfma_f32_16x16x32_bf16 a[76:79], a[216:219], v[20:23], a[76:79]
    buffer_load_dwordx4 v[44:47], v4, s[40:43], s55 offen
    v_mfma_f32_16x16x32_bf16 a[80:83], a[200:203], v[16:19], a[80:83]
    v_perm_b32 v20, v70, v66, s49
    v_mfma_f32_16x16x32_bf16 a[84:87], a[204:207], v[16:19], a[84:87]
    v_perm_b32 v21, v78, v74, s49
    v_mfma_f32_16x16x32_bf16 a[88:91], a[208:211], v[16:19], a[88:91]
    v_perm_b32 v22, v86, v82, s49
    v_mfma_f32_16x16x32_bf16 a[92:95], a[212:215], v[16:19], a[92:95]
    v_perm_b32 v23, v94, v90, s49
    v_mfma_f32_16x16x32_bf16 a[96:99], a[216:219], v[16:19], a[96:99]
    buffer_load_dwordx4 v[48:51], v5, s[40:43], s55 offen
    v_mfma_f32_16x16x32_bf16 a[100:103], a[200:203], v[20:23], a[100:103]
    v_perm_b32 v16, v71, v67, s48
    v_mfma_f32_16x16x32_bf16 a[104:107], a[204:207], v[20:23], a[104:107]
    v_perm_b32 v17, v79, v75, s48
    v_mfma_f32_16x16x32_bf16 a[108:111], a[208:211], v[20:23], a[108:111]
    v_perm_b32 v18, v87, v83, s48
    v_mfma_f32_16x16x32_bf16 a[112:115], a[212:215], v[20:23], a[112:115]
    v_perm_b32 v19, v95, v91, s48
    v_mfma_f32_16x16x32_bf16 a[116:119], a[216:219], v[20:23], a[116:119]
    buffer_load_dwordx4 v[52:55], v6, s[40:43], s55 offen
    v_mfma_f32_16x16x32_bf16 a[120:123], a[200:203], v[16:19], a[120:123]
    v_perm_b32 v20, v71, v67, s49
    v_mfma_f32_16x16x32_bf16 a[124:127], a[204:207], v[16:19], a[124:127]
    v_perm_b32 v21, v79, v75, s49
    v_mfma_f32_16x16x32_bf16 a[128:131], a[208:211], v[16:19], a[128:131]
    v_perm_b32 v22, v87, v83, s49
    v_mfma_f32_16x16x32_bf16 a[132:135], a[212:215], v[16:19], a[132:135]
    v_perm_b32 v23, v95, v91, s49
    v_mfma_f32_16x16x32_bf16 a[136:139], a[216:219], v[16:19], a[136:139]
    buffer_load_dwordx4 v[56:59], v7, s[40:43], s55 offen
    v_mfma_f32_16x16x32_bf16 a[140:143], a[200:203], v[20:23], a[140:143]
    v_mfma_f32_16x16x32_bf16 a[144:147], a[204:207], v[20:23], a[144:147]
    v_mfma_f32_16x16x32_bf16 a[148:151], a[208:211], v[20:23], a[148:151]
    s_add_u32 m0, s52, 4096
    v_mfma_f32_16x16x32_bf16 a[152:155], a[212:215], v[20:23], a[152:155]
    s_waitcnt vmcnt(34) lgkmcnt(0)
    v_mfma_f32_16x16x32_bf16 a[156:159], a[216:219], v[20:23], a[156:159]
    buffer_load_dwordx4 v[60:63], v8, s[40:43], s55 offen
    v_mfma_f32_16x16x32_bf16 a[160:163], v[24:27], a[200:203], a[160:163]
    v_perm_b32 v16, v100, v96, s48
    v_mfma_f32_16x16x32_bf16 a[164:167], v[24:27], a[204:207], a[164:167]
    v_perm_b32 v17, v108, v104, s48
    v_mfma_f32_16x16x32_bf16 a[168:171], v[24:27], a[208:211], a[168:171]
    v_perm_b32 v18, v116, v112, s48
    v_mfma_f32_16x16x32_bf16 a[172:175], v[24:27], a[212:215], a[172:175]
    v_perm_b32 v19, v124, v120, s48
    v_mfma_f32_16x16x32_bf16 a[176:179], v[24:27], a[216:219], a[176:179]
    buffer_load_dwordx4 v9, s[40:43], s55 offen lds
    s_cmp_eq_u32 s53, 0
    s_cbranch_scc1 L_signal
L_sig_back:
    v_mfma_f32_16x16x32_bf16 a[0:3], a[180:183], v[16:19], a[0:3]
    v_perm_b32 v20, v100, v96, s49
    v_perm_b32 v21, v108, v104, s49
    v_mfma_f32_16x16x32_bf16 a[4:7], a[184:187], v[16:19], a[4:7]
    v_perm_b32 v22, v116, v112, s49
    v_perm_b32 v23, v124, v120, s49
    v_mfma_f32_16x16x32_bf16 a[8:11], a[188:191], v[16:19], a[8:11]
    ds_read_b64_tr_b16 v[24:25], v11 offset:8192
    v_mfma_f32_16x16x32_bf16 a[12:15], a[192:195], v[16:19], a[12:15]
    ds_read_b64_tr_b16 v[26:27], v11 offset:10240
    v_mfma_f32_16x16x32_bf16 a[16:19], a[196:199], v[16:19], a[16:19]
    buffer_load_dwordx4 v[64:67], v1, s[40:43], s50 offen
    v_mfma_f32_16x16x32_bf16 a[20:23], a[180:183], v[20:23], a[20:23]
    v_perm_b32 v16, v101, v97, s48
    v_perm_b32 v17, v109, v105, s48
    v_mfma_f32_16x16x32_bf16 a[24:27], a[184:187], v[20:23], a[24:27]
    v_perm_b32 v18, v117, v113, s48
    v_perm_b32 v19, v125, v121, s48
    v_mfma_f32_16x16x32_bf16 a[28:31], a[188:191], v[20:23], a[28:31]
    ds_read_b128 a[200:203], v10 offset:15360
    v_mfma_f32_16x16x32_bf16 a[32:35], a[192:195], v[20:23], a[32:35]
    ds_read_b128 a[204:207], v10 offset:16384
    v_mfma_f32_16x16x32_bf16 a[36:39], a[196:199], v[20:23], a[36:39]
    buffer_load_dwordx4 v[68:71], v2, s[40:43], s50 offen
    v_mfma_f32_16x16x32_bf16 a[40:43], a[180:183], v[16:19], a[40:43]
    v_perm_b32 v20, v101, v97, s49
    v_perm_b32 v21, v109, v105, s49
    v_mfma_f32_16x16x32_bf16 a[44:47], a[184:187], v[16:19], a[44:47]
    v_perm_b32 v22, v117, v113, s49
    v_perm_b32 v23, v125, v121, s49
    v_mfma_f32_16x16x32_bf16 a[48:51], a[188:191], v[16:19], a[48:51]
    ds_read_b128 a[208:211], v10 offset:17408
    v_mfma_f32_16x16x32_bf16 a[52:55], a[192:195], v[16:19], a[52:55]
    ds_read_b128 a[212:215], v10 offset:18432
    v_mfma_f32_16x16x32_bf16 a[56:59], a[196:199], v[16:19], a[56:59]
    buffer_load_dwordx4 v[72:75], v3, s[40:43], s50 offen
    v_mfma_f32_16x16x32_bf16 a[60:63], a[180:183], v[20:23], a[60:63]
    v_perm_b32 v16, v102, v98, s48
    v_perm_b32 v17, v110, v106, s48
    v_mfma_f32_16x16x32_bf16 a[64:67], a[184:187], v[20:23], a[64:67]
    v_perm_b32 v18, v118, v114, s48
    v_perm_b32 v19, v126, v122, s48
    v_mfma_f32_16x16x32_bf16 a[68:71], a[188:191], v[20:23], a[68:71]
    ds_read_b128 a[216:219], v10 offset:19456
    v_mfma_f32_16x16x32_bf16 a[72:75], a[192:195], v[20:23], a[72:75]
    s_add_u32 s55, s50, s51
    v_mfma_f32_16x16x32_bf16 a[76:79], a[196:199], v[20:23], a[76:79]
    buffer_load_dwordx4 v[76:79], v4, s[40:43], s50 offen
    v_mfma_f32_16x16x32_bf16 a[80:83], a[180:183], v[16:19], a[80:83]
    v_perm_b32 v20, v102, v98, s49
    v_mfma_f32_16x16x32_bf16 a[84:87], a[184:187], v[16:19], a[84:87]
    v_perm_b32 v21, v110, v106, s49
    v_mfma_f32_16x16x32_bf16 a[88:91], a[188:191], v[16:19], a[88:91]
    v_perm_b32 v22, v118, v114, s49
    v_mfma_f32_16x16x32_bf16 a[92:95], a[192:195], v[16:19], a[92:95]
    v_perm_b32 v23, v126, v122, s49
    v_mfma_f32_16x16x32_bf16 a[96:99], a[196:199], v[16:19], a[96:99]
    buffer_load_dwordx4 v[80:83], v5, s[40:43], s50 offen
    v_mfma_f32_16x16x32_bf16 a[100:103], a[180:183], v[20:23], a[100:103]
    v_perm_b32 v16, v103, v99, s48
    v_mfma_f32_16x16x32_bf16 a[104:107], a[184:187], v[20:23], a[104:107]
    v_perm_b32 v17, v111, v107, s48
    v_mfma_f32_16x16x32_bf16 a[108:111], a[188:191], v[20:23], a[108:111]
    v_perm_b32 v18, v119, v115, s48
    v_mfma_f32_16x16x32_bf16 a[112:115], a[192:195], v[20:23], a[112:115]
    v_perm_b32 v19, v127, v123, s48
    v_mfma_f32_16x16x32_bf16 a[116:119], a[196:199], v[20:23], a[116:119]
    buffer_load_dwordx4 v[84:87], v6, s[40:43], s50 offen
    v_mfma_f32_16x16x32_bf16 a[120:123], a[180:183], v[16:19], a[120:123]
    v_perm_b32 v20, v103, v99, s49
    v_mfma_f32_16x16x32_bf16 a[124:127], a[184:187], v[16:19], a[124:127]
    v_perm_b32 v21, v111, v107, s49
    v_mfma_f32_16x16x32_bf16 a[128:131], a[188:191], v[16:19], a[128:131]
    v_perm_b32 v22, v119, v115, s49
    v_mfma_f32_16x16x32_bf16 a[132:135], a[192:195], v[16:19], a[132:135]
    v_perm_b32 v23, v127, v123, s49
    v_mfma_f32_16x16x32_bf16 a[136:139], a[196:199], v[16:19], a[136:139]
    buffer_load_dwordx4 v[88:91], v7, s[40:43], s50 offen
    v_mfma_f32_16x16x32_bf16 a[140:143], a[180:183], v[20:23], a[140:143]
    v_mfma_f32_16x16x32_bf16 a[144:147], a[184:187], v[20:23], a[144:147]
    v_mfma_f32_16x16x32_bf16 a[148:151], a[188:191], v[20:23], a[148:151]
    s_add_u32 m0, s52, 8192
    v_mfma_f32_16x16x32_bf16 a[152:155], a[192:195], v[20:23], a[152:155]
    s_waitcnt vmcnt(25) lgkmcnt(0)
    s_barrier
    v_mfma_f32_16x16x32_bf16 a[156:159], a[196:199], v[20:23], a[156:159]
    buffer_load_dwordx4 v[92:95], v8, s[40:43], s50 offen
    v_mfma_f32_16x16x32_bf16 a[160:163], v[24:27], a[180:183], a[160:163]
    v_perm_b32 v16, v132, v128, s48
    v_mfma_f32_16x16x32_bf16 a[164:167], v[24:27], a[184:187], a[164:167]
    v_perm_b32 v17, v140, v136, s48
    v_mfma_f32_16x16x32_bf16 a[168:171], v[24:27], a[188:191], a[168:171]
    v_perm_b32 v18, v148, v144, s48
    v_mfma_f32_16x16x32_bf16 a[172:175], v[24:27], a[192:195], a[172:175]
    v_perm_b32 v19, v156, v152, s48
    v_mfma_f32_16x16x32_bf16 a[176:179], v[24:27], a[196:199], a[176:179]
    buffer_load_dwordx4 v9, s[40:43], s50 offen lds
    v_mfma_f32_16x16x32_bf16 a[0:3], a[200:203], v[16:19], a[0:3]
    v_perm_b32 v20, v132, v128, s49
    v_perm_b32 v21, v140, v136, s49
    v_mfma_f32_16x16x32_bf16 a[4:7], a[204:207], v[16:19], a[4:7]
    v_perm_b32 v22, v148, v144, s49
    v_perm_b32 v23, v156, v152, s49
    v_mfma_f32_16x16x32_bf16 a[8:11], a[208:211], v[16:19], a[8:11]
    ds_read_b64_tr_b16 v[24:25], v11 offset:12288
    v_mfma_f32_16x16x32_bf16 a[12:15], a[212:215], v[16:19], a[12:15]
    ds_read_b64_tr_b16 v[26:27], v11 offset:14336
    v_mfma_f32_16x16x32_bf16 a[16:19], a[216:219], v[16:19], a[16:19]
    buffer_load_dwordx4 v[96:99], v1, s[40:43], s55 offen
    v_mfma_f32_16x16x32_bf16 a[20:23], a[200:203], v[20:23], a[20:23]
    v_perm_b32 v16, v133, v129, s48
    v_perm_b32 v17, v141, v137, s48
    v_mfma_f32_16x16x32_bf16 a[24:27], a[204:207], v[20:23], a[24:27]
    v_perm_b32 v18, v149, v145, s48
    v_perm_b32 v19, v157, v153, s48
    v_mfma_f32_16x16x32_bf16 a[28:31], a[208:211], v[20:23], a[28:31]
    ds_read_b128 a[180:183], v10 offset:20480
    v_mfma_f32_16x16x32_bf16 a[32:35], a[212:215], v[20:23], a[32:35]
    ds_read_b128 a[184:187], v10 offset:21504
    v_mfma_f32_16x16x32_bf16 a[36:39], a[216:219], v[20:23], a[36:39]
    buffer_load_dwordx4 v[100:103], v2, s[40:43], s55 offen
    v_mfma_f32_16x16x32_bf16 a[40:43], a[200:203], v[16:19], a[40:43]
    v_perm_b32 v20, v133, v129, s49
    v_perm_b32 v21, v141, v137, s49
    v_mfma_f32_16x16x32_bf16 a[44:47], a[204:207], v[16:19], a[44:47]
    v_perm_b32 v22, v149, v145, s49
    v_perm_b32 v23, v157, v153, s49
    v_mfma_f32_16x16x32_bf16 a[48:51], a[208:211], v[16:19], a[48:51]
    ds_read_b128 a[188:191], v10 offset:22528
    v_mfma_f32_16x16x32_bf16 a[52:55], a[212:215], v[16:19], a[52:55]
    ds_read_b128 a[192:195], v10 offset:23552
    v_mfma_f32_16x16x32_bf16 a[56:59], a[216:219], v[16:19], a[56:59]
    buffer_load_dwordx4 v[104:107], v3, s[40:43], s55 offen
    v_mfma_f32_16x16x32_bf16 a[60:63], a[200:203], v[20:23], a[60:63]
    v_perm_b32 v16, v134, v130, s48
    v_perm_b32 v17, v142, v138, s48
    v_mfma_f32_16x16x32_bf16 a[64:67], a[204:207], v[20:23], a[64:67]
    v_perm_b32 v18, v150, v146, s48
    v_perm_b32 v19, v158, v154, s48
    v_mfma_f32_16x16x32_bf16 a[68:71], a[208:211], v[20:23], a[68:71]
    ds_read_b128 a[196:199], v10 offset:24576
    v_mfma_f32_16x16x32_bf16 a[72:75], a[212:215], v[20:23], a[72:75]
    s_add_u32 s50, s55, s51
    v_mfma_f32_16x16x32_bf16 a[76:79], a[216:219], v[20:23], a[76:79]
    buffer_load_dwordx4 v[108:111], v4, s[40:43], s55 offen
    v_mfma_f32_16x16x32_bf16 a[80:83], a[200:203], v[16:19], a[80:83]
    v_perm_b32 v20, v134, v130, s49
    v_mfma_f32_16x16x32_bf16 a[84:87], a[204:207], v[16:19], a[84:87]
    v_perm_b32 v21, v142, v138, s49
    v_mfma_f32_16x16x32_bf16 a[88:91], a[208:211], v[16:19], a[88:91]
    v_perm_b32 v22, v150, v146, s49
    v_mfma_f32_16x16x32_bf16 a[92:95], a[212:215], v[16:19], a[92:95]
    v_perm_b32 v23, v158, v154, s49
    v_mfma_f32_16x16x32_bf16 a[96:99], a[216:219], v[16:19], a[96:99]
    buffer_load_dwordx4 v[112:115], v5, s[40:43], s55 offen
    v_mfma_f32_16x16x32_bf16 a[100:103], a[200:203], v[20:23], a[100:103]
    v_perm_b32 v16, v135, v131, s48
    v_mfma_f32_16x16x32_bf16 a[104:107], a[204:207], v[20:23], a[104:107]
    v_perm_b32 v17, v143, v139, s48
    v_mfma_f32_16x16x32_bf16 a[108:111], a[208:211], v[20:23], a[108:111]
    v_perm_b32 v18, v151, v147, s48
    v_mfma_f32_16x16x32_bf16 a[112:115], a[212:215], v[20:23], a[112:115]
    v_perm_b32 v19, v159, v155, s48
    v_mfma_f32_16x16x32_bf16 a[116:119], a[216:219], v[20:23], a[116:119]
    buffer_load_dwordx4 v[116:119], v6, s[40:43], s55 offen
    v_mfma_f32_16x16x32_bf16 a[120:123], a[200:203], v[16:19], a[120:123]
    v_perm_b32 v20, v135, v131, s49
    v_mfma_f32_16x16x32_bf16 a[124:127], a[204:207], v[16:19], a[124:127]
    v_perm_b32 v21, v143, v139, s49
    v_mfma_f32_16x16x32_bf16 a[128:131], a[208:211], v[16:19], a[128:131]
    v_perm_b32 v22, v151, v147, s49
    v_mfma_f32_16x16x32_bf16 a[132:135], a[212:215], v[16:19], a[132:135]
    v_perm_b32 v23, v159, v155, s49
    v_mfma_f32_16x16x32_bf16 a[136:139], a[216:219], v[16:19], a[136:139]
    buffer_load_dwordx4 v[120:123], v7, s[40:43], s55 offen
    v_mfma_f32_16x16x32_bf16 a[140:143], a[200:203], v[20:23], a[140:143]
    v_mfma_f32_16x16x32_bf16 a[144:147], a[204:207], v[20:23], a[144:147]
    v_mfma_f32_16x16x32_bf16 a[148:151], a[208:211], v[20:23], a[148:151]
    s_add_u32 m0, s52, 12288
    v_mfma_f32_16x16x32_bf16 a[152:155], a[212:215], v[20:23], a[152:155]
    s_waitcnt vmcnt(34) lgkmcnt(0)
    v_mfma_f32_16x16x32_bf16 a[156:159], a[216:219], v[20:23], a[156:159]
    buffer_load_dwordx4 v[124:127], v8, s[40:43], s55 offen
    v_mfma_f32_16x16x32_bf16 a[160:163], v[24:27], a[200:203], a[160:163]
    v_perm_b32 v16, v164, v160, s48
    v_mfma_f32_16x16x32_bf16 a[164:167], v[24:27], a[204:207], a[164:167]
    v_perm_b32 v17, v172, v168, s48
    v_mfma_f32_16x16x32_bf16 a[168:171], v[24:27], a[208:211], a[168:171]
    v_perm_b32 v18, v180, v176, s48
    v_mfma_f32_16x16x32_bf16 a[172:175], v[24:27], a[212:215], a[172:175]
    v_perm_b32 v19, v188, v184, s48
    v_mfma_f32_16x16x32_bf16 a[176:179], v[24:27], a[216:219], a[176:179]
    buffer_load_dwordx4 v9, s[40:43], s55 offen lds
    v_mfma_f32_16x16x32_bf16 a[0:3], a[180:183], v[16:19], a[0:3]
    v_perm_b32 v20, v164, v160, s49
    v_perm_b32 v21, v172, v168, s49
    v_mfma_f32_16x16x32_bf16 a[4:7], a[184:187], v[16:19], a[4:7]
    v_perm_b32 v22, v180, v176, s49
    v_perm_b32 v23, v188, v184, s49
    v_mfma_f32_16x16x32_bf16 a[8:11], a[188:191], v[16:19], a[8:11]
    ds_read_b64_tr_b16 v[24:25], v11 offset:16384
    v_mfma_f32_16x16x32_bf16 a[12:15], a[192:195], v[16:19], a[12:15]
    ds_read_b64_tr_b16 v[26:27], v11 offset:18432
    v_mfma_f32_16x16x32_bf16 a[16:19], a[196:199], v[16:19], a[16:19]
    buffer_load_dwordx4 v[128:131], v1, s[40:43], s50 offen
    v_mfma_f32_16x16x32_bf16 a[20:23], a[180:183], v[20:23], a[20:23]
    v_perm_b32 v16, v165, v161, s48
    v_perm_b32 v17, v173, v169, s48
    v_mfma_f32_16x16x32_bf16 a[24:27], a[184:187], v[20:23], a[24:27]
    v_perm_b32 v18, v181, v177, s48
    v_perm_b32 v19, v189, v185, s48
    v_mfma_f32_16x16x32_bf16 a[28:31], a[188:191], v[20:23], a[28:31]
    ds_read_b128 a[200:203], v10 offset:25600
    v_mfma_f32_16x16x32_bf16 a[32:35], a[192:195], v[20:23], a[32:35]
    ds_read_b128 a[204:207], v10 offset:26624
    v_mfma_f32_16x16x32_bf16 a[36:39], a[196:199], v[20:23], a[36:39]
    buffer_load_dwordx4 v[132:135], v2, s[40:43], s50 offen
    v_mfma_f32_16x16x32_bf16 a[40:43], a[180:183], v[16:19], a[40:43]
    v_perm_b32 v20, v165, v161, s49
    v_perm_b32 v21, v173, v169, s49
    v_mfma_f32_16x16x32_bf16 a[44:47], a[184:187], v[16:19], a[44:47]
    v_perm_b32 v22, v181, v177, s49
    v_perm_b32 v23, v189, v185, s49
    v_mfma_f32_16x16x32_bf16 a[48:51], a[188:191], v[16:19], a[48:51]
    ds_read_b128 a[208:211], v10 offset:27648
    v_mfma_f32_16x16x32_bf16 a[52:55], a[192:195], v[16:19], a[52:55]
    ds_read_b128 a[212:215], v10 offset:28672
    v_mfma_f32_16x16x32_bf16 a[56:59], a[196:199], v[16:19], a[56:59]
    buffer_load_dwordx4 v[136:139], v3, s[40:43], s50 offen
    v_mfma_f32_16x16x32_bf16 a[60:63], a[180:183], v[20:23], a[60:63]
    v_perm_b32 v16, v166, v162, s48
    v_perm_b32 v17, v174, v170, s48
    v_mfma_f32_16x16x32_bf16 a[64:67], a[184:187], v[20:23], a[64:67]
    v_perm_b32 v18, v182, v178, s48
    v_perm_b32 v19, v190, v186, s48
    v_mfma_f32_16x16x32_bf16 a[68:71], a[188:191], v[20:23], a[68:71]
    ds_read_b128 a[216:219], v10 offset:29696
    v_mfma_f32_16x16x32_bf16 a[72:75], a[192:195], v[20:23], a[72:75]
    s_add_u32 s55, s50, s51
    v_mfma_f32_16x16x32_bf16 a[76:79], a[196:199], v[20:23], a[76:79]
    buffer_load_dwordx4 v[140:143], v4, s[40:43], s50 offen
    v_mfma_f32_16x16x32_bf16 a[80:83], a[180:183], v[16:19], a[80:83]
    v_perm_b32 v20, v166, v162, s49
    v_mfma_f32_16x16x32_bf16 a[84:87], a[184:187], v[16:19], a[84:87]
    v_perm_b32 v21, v174, v170, s49
    v_mfma_f32_16x16x32_bf16 a[88:91], a[188:191], v[16:19], a[88:91]
    v_perm_b32 v22, v182, v178, s49
    v_mfma_f32_16x16x32_bf16 a[92:95], a[192:195], v[16:19], a[92:95]
    v_perm_b32 v23, v190, v186, s49
    v_mfma_f32_16x16x32_bf16 a[96:99], a[196:199], v[16:19], a[96:99]
    buffer_load_dwordx4 v[144:147], v5, s[40:43], s50 offen
    v_mfma_f32_16x16x32_bf16 a[100:103], a[180:183], v[20:23], a[100:103]
    v_perm_b32 v16, v167, v163, s48
    v_mfma_f32_16x16x32_bf16 a[104:107], a[184:187], v[20:23], a[104:107]
    v_perm_b32 v17, v175, v171, s48
    v_mfma_f32_16x16x32_bf16 a[108:111], a[188:191], v[20:23], a[108:111]
    v_perm_b32 v18, v183, v179, s48
    v_mfma_f32_16x16x32_bf16 a[112:115], a[192:195], v[20:23], a[112:115]
    v_perm_b32 v19, v191, v187, s48
    v_mfma_f32_16x16x32_bf16 a[116:119], a[196:199], v[20:23], a[116:119]
    buffer_load_dwordx4 v[148:151], v6, s[40:43], s50 offen
    v_mfma_f32_16x16x32_bf16 a[120:123], a[180:183], v[16:19], a[120:123]
    v_perm_b32 v20, v167, v163, s49
    v_mfma_f32_16x16x32_bf16 a[124:127], a[184:187], v[16:19], a[124:127]
    v_perm_b32 v21, v175, v171, s49
    v_mfma_f32_16x16x32_bf16 a[128:131], a[188:191], v[16:19], a[128:131]
    v_perm_b32 v22, v183, v179, s49
    v_mfma_f32_16x16x32_bf16 a[132:135], a[192:195], v[16:19], a[132:135]
    v_perm_b32 v23, v191, v187, s49
    v_mfma_f32_16x16x32_bf16 a[136:139], a[196:199], v[16:19], a[136:139]
    buffer_load_dwordx4 v[152:155], v7, s[40:43], s50 offen
    v_mfma_f32_16x16x32_bf16 a[140:143], a[180:183], v[20:23], a[140:143]
    v_mfma_f32_16x16x32_bf16 a[144:147], a[184:187], v[20:23], a[144:147]
    v_mfma_f32_16x16x32_bf16 a[148:151], a[188:191], v[20:23], a[148:151]
    s_add_u32 m0, s52, 16384
    v_mfma_f32_16x16x32_bf16 a[152:155], a[192:195], v[20:23], a[152:155]
    s_waitcnt vmcnt(25) lgkmcnt(0)
    s_barrier
    v_mfma_f32_16x16x32_bf16 a[156:159], a[196:199], v[20:23], a[156:159]
    buffer_load_dwordx4 v[156:159], v8, s[40:43], s50 offen
    v_mfma_f32_16x16x32_bf16 a[160:163], v[24:27], a[180:183], a[160:163]
    v_perm_b32 v16, v196, v192, s48
    v_mfma_f32_16x16x32_bf16 a[164:167], v[24:27], a[184:187], a[164:167]
    v_perm_b32 v17, v204, v200, s48
    v_mfma_f32_16x16x32_bf16 a[168:171], v[24:27], a[188:191], a[168:171]
    v_perm_b32 v18, v212, v208, s48
    v_mfma_f32_16x16x32_bf16 a[172:175], v[24:27], a[192:195], a[172:175]
    v_perm_b32 v19, v220, v216, s48
    v_mfma_f32_16x16x32_bf16 a[176:179], v[24:27], a[196:199], a[176:179]
    buffer_load_dwordx4 v9, s[40:43], s50 offen lds
    v_mfma_f32_16x16x32_bf16 a[0:3], a[200:203], v[16:19], a[0:3]
    v_perm_b32 v20, v196, v192, s49
    v_perm_b32 v21, v204, v200, s49
    v_mfma_f32_16x16x32_bf16 a[4:7], a[204:207], v[16:19], a[4:7]
    v_perm_b32 v22, v212, v208, s49
    v_perm_b32 v23, v220, v216, s49
    v_mfma_f32_16x16x32_bf16 a[8:11], a[208:211], v[16:19], a[8:11]
    ds_read_b64_tr_b16 v[24:25], v11 offset:20480
    v_mfma_f32_16x16x32_bf16 a[12:15], a[212:215], v[16:19], a[12:15]
    ds_read_b64_tr_b16 v[26:27], v11 offset:22528
    v_mfma_f32_16x16x32_bf16 a[16:19], a[216:219], v[16:19], a[16:19]
    buffer_load_dwordx4 v[160:163], v1, s[40:43], s55 offen
    v_mfma_f32_16x16x32_bf16 a[20:23], a[200:203], v[20:23], a[20:23]
    v_perm_b32 v16, v197, v193, s48
    v_perm_b32 v17, v205, v201, s48
    v_mfma_f32_16x16x32_bf16 a[24:27], a[204:207], v[20:23], a[24:27]
    v_perm_b32 v18, v213, v209, s48
    v_perm_b32 v19, v221, v217, s48
    v_mfma_f32_16x16x32_bf16 a[28:31], a[208:211], v[20:23], a[28:31]
    ds_read_b128 a[180:183], v10 offset:30720
    v_mfma_f32_16x16x32_bf16 a[32:35], a[212:215], v[20:23], a[32:35]
    ds_read_b128 a[184:187], v10 offset:31744
    v_mfma_f32_16x16x32_bf16 a[36:39], a[216:219], v[20:23], a[36:39]
    buffer_load_dwordx4 v[164:167], v2, s[40:43], s55 offen
    v_mfma_f32_16x16x32_bf16 a[40:43], a[200:203], v[16:19], a[40:43]
    v_perm_b32 v20, v197, v193, s49
    v_perm_b32 v21, v205, v201, s49
    v_mfma_f32_16x16x32_bf16 a[44:47], a[204:207], v[16:19], a[44:47]
    v_perm_b32 v22, v213, v209, s49
    v_perm_b32 v23, v221, v217, s49
    v_mfma_f32_16x16x32_bf16 a[48:51], a[208:211], v[16:19], a[48:51]
    ds_read_b128 a[188:191], v10 offset:32768
    v_mfma_f32_16x16x32_bf16 a[52:55], a[212:215], v[16:19], a[52:55]
    ds_read_b128 a[192:195], v10 offset:33792
    v_mfma_f32_16x16x32_bf16 a[56:59], a[216:219], v[16:19], a[56:59]
    buffer_load_dwordx4 v[168:171], v3, s[40:43], s55 offen
    v_mfma_f32_16x16x32_bf16 a[60:63], a[200:203], v[20:23], a[60:63]
    v_perm_b32 v16, v198, v194, s48
    v_perm_b32 v17, v206, v202, s48
    v_mfma_f32_16x16x32_bf16 a[64:67], a[204:207], v[20:23], a[64:67]
    v_perm_b32 v18, v214, v210, s48
    v_perm_b32 v19, v222, v218, s48
    v_mfma_f32_16x16x32_bf16 a[68:71], a[208:211], v[20:23], a[68:71]
    ds_read_b128 a[196:199], v10 offset:34816
    v_mfma_f32_16x16x32_bf16 a[72:75], a[212:215], v[20:23], a[72:75]
    s_add_u32 s50, s55, s51
    v_mfma_f32_16x16x32_bf16 a[76:79], a[216:219], v[20:23], a[76:79]
    buffer_load_dwordx4 v[172:175], v4, s[40:43], s55 offen
    v_mfma_f32_16x16x32_bf16 a[80:83], a[200:203], v[16:19], a[80:83]
    v_perm_b32 v20, v198, v194, s49
    v_mfma_f32_16x16x32_bf16 a[84:87], a[204:207], v[16:19], a[84:87]
    v_perm_b32 v21, v206, v202, s49
    v_mfma_f32_16x16x32_bf16 a[88:91], a[208:211], v[16:19], a[88:91]
    v_perm_b32 v22, v214, v210, s49
    v_mfma_f32_16x16x32_bf16 a[92:95], a[212:215], v[16:19], a[92:95]
    v_perm_b32 v23, v222, v218, s49
    v_mfma_f32_16x16x32_bf16 a[96:99], a[216:219], v[16:19], a[96:99]
    buffer_load_dwordx4 v[176:179], v5, s[40:43], s55 offen
    v_mfma_f32_16x16x32_bf16 a[100:103], a[200:203], v[20:23], a[100:103]
    v_perm_b32 v16, v199, v195, s48
    v_mfma_f32_16x16x32_bf16 a[104:107], a[204:207], v[20:23], a[104:107]
    v_perm_b32 v17, v207, v203, s48
    v_mfma_f32_16x16x32_bf16 a[108:111], a[208:211], v[20:23], a[108:111]
    v_perm_b32 v18, v215, v211, s48
    v_mfma_f32_16x16x32_bf16 a[112:115], a[212:215], v[20:23], a[112:115]
    v_perm_b32 v19, v223, v219, s48
    v_mfma_f32_16x16x32_bf16 a[116:119], a[216:219], v[20:23], a[116:119]
    buffer_load_dwordx4 v[180:183], v6, s[40:43], s55 offen
    v_mfma_f32_16x16x32_bf16 a[120:123], a[200:203], v[16:19], a[120:123]
    v_perm_b32 v20, v199, v195, s49
    v_mfma_f32_16x16x32_bf16 a[124:127], a[204:207], v[16:19], a[124:127]
    v_perm_b32 v21, v207, v203, s49
    v_mfma_f32_16x16x32_bf16 a[128:131], a[208:211], v[16:19], a[128:131]
    v_perm_b32 v22, v215, v211, s49
    v_mfma_f32_16x16x32_bf16 a[132:135], a[212:215], v[16:19], a[132:135]
    v_perm_b32 v23, v223, v219, s49
    v_mfma_f32_16x16x32_bf16 a[136:139], a[216:219], v[16:19], a[136:139]
    buffer_load_dwordx4 v[184:187], v7, s[40:43], s55 offen
    v_mfma_f32_16x16x32_bf16 a[140:143], a[200:203], v[20:23], a[140:143]
    v_add_u32 v10, 30720, v10
    v_mfma_f32_16x16x32_bf16 a[144:147], a[204:207], v[20:23], a[144:147]
    s_add_u32 s53, s53, 1
    v_mfma_f32_16x16x32_bf16 a[148:151], a[208:211], v[20:23], a[148:151]
    s_add_u32 m0, s52, 20480
    v_mfma_f32_16x16x32_bf16 a[152:155], a[212:215], v[20:23], a[152:155]
    s_waitcnt vmcnt(34) lgkmcnt(0)
    v_mfma_f32_16x16x32_bf16 a[156:159], a[216:219], v[20:23], a[156:159]
    buffer_load_dwordx4 v[188:191], v8, s[40:43], s55 offen
    v_mfma_f32_16x16x32_bf16 a[160:163], v[24:27], a[200:203], a[160:163]
    v_perm_b32 v16, v36, v32, s48
    v_mfma_f32_16x16x32_bf16 a[164:167], v[24:27], a[204:207], a[164:167]
    v_perm_b32 v17, v44, v40, s48
    v_mfma_f32_16x16x32_bf16 a[168:171], v[24:27], a[208:211], a[168:171]
    v_perm_b32 v18, v52, v48, s48
    v_mfma_f32_16x16x32_bf16 a[172:175], v[24:27], a[212:215], a[172:175]
    v_perm_b32 v19, v60, v56, s48
    v_mfma_f32_16x16x32_bf16 a[176:179], v[24:27], a[216:219], a[176:179]
    s_bitcmp1_b32 22, s53
    buffer_load_dwordx4 v9, s[40:43], s55 offen lds
    s_cbranch_scc1 L_gemm_loop
    s_cmp_eq_u32 s53, 3
    s_cbranch_scc1 L_silu
L_tail:
    v_mfma_f32_16x16x32_bf16 a[0:3], a[180:183], v[16:19], a[0:3]
    v_perm_b32 v20, v36, v32, s49
    v_perm_b32 v21, v44, v40, s49
    v_mfma_f32_16x16x32_bf16 a[4:7], a[184:187], v[16:19], a[4:7]
    v_perm_b32 v22, v52, v48, s49
    v_perm_b32 v23, v60, v56, s49
    v_mfma_f32_16x16x32_bf16 a[8:11], a[188:191], v[16:19], a[8:11]
    ds_read_b64_tr_b16 v[24:25], v11 offset:0
    v_mfma_f32_16x16x32_bf16 a[12:15], a[192:195], v[16:19], a[12:15]
    ds_read_b64_tr_b16 v[26:27], v11 offset:2048
    v_mfma_f32_16x16x32_bf16 a[16:19], a[196:199], v[16:19], a[16:19]
    buffer_load_dwordx4 v[192:195], v1, s[40:43], s50 offen
    v_mfma_f32_16x16x32_bf16 a[20:23], a[180:183], v[20:23], a[20:23]
    v_perm_b32 v16, v37, v33, s48
    v_perm_b32 v17, v45, v41, s48
    v_mfma_f32_16x16x32_bf16 a[24:27], a[184:187], v[20:23], a[24:27]
    v_perm_b32 v18, v53, v49, s48
    v_perm_b32 v19, v61, v57, s48
    v_mfma_f32_16x16x32_bf16 a[28:31], a[188:191], v[20:23], a[28:31]
    ds_read_b128 a[200:203], v10 offset:5120
    v_mfma_f32_16x16x32_bf16 a[32:35], a[192:195], v[20:23], a[32:35]
    ds_read_b128 a[204:207], v10 offset:6144
    v_mfma_f32_16x16x32_bf16 a[36:39], a[196:199], v[20:23], a[36:39]
    buffer_load_dwordx4 v[196:199], v2, s[40:43], s50 offen
    v_mfma_f32_16x16x32_bf16 a[40:43], a[180:183], v[16:19], a[40:43]
    v_perm_b32 v20, v37, v33, s49
    v_perm_b32 v21, v45, v41, s49
    v_mfma_f32_16x16x32_bf16 a[44:47], a[184:187], v[16:19], a[44:47]
    v_perm_b32 v22, v53, v49, s49
    v_perm_b32 v23, v61, v57, s49
    v_mfma_f32_16x16x32_bf16 a[48:51], a[188:191], v[16:19], a[48:51]
    ds_read_b128 a[208:211], v10 offset:10240
    v_mfma_f32_16x16x32_bf16 a[52:55], a[192:195], v[16:19], a[52:55]
    ds_read_b128 a[212:215], v10 offset:11264
    v_mfma_f32_16x16x32_bf16 a[56:59], a[196:199], v[16:19], a[56:59]
    buffer_load_dwordx4 v[200:203], v3, s[40:43], s50 offen
    v_mfma_f32_16x16x32_bf16 a[60:63], a[180:183], v[20:23], a[60:63]
    v_perm_b32 v16, v38, v34, s48
    v_perm_b32 v17, v46, v42, s48
    v_mfma_f32_16x16x32_bf16 a[64:67], a[184:187], v[20:23], a[64:67]
    v_perm_b32 v18, v54, v50, s48
    v_perm_b32 v19, v62, v58, s48
    v_mfma_f32_16x16x32_bf16 a[68:71], a[188:191], v[20:23], a[68:71]
    ds_read_b128 a[216:219], v10 offset:15360
    v_mfma_f32_16x16x32_bf16 a[72:75], a[192:195], v[20:23], a[72:75]
    v_accvgpr_read_b32 v28, a246
    v_accvgpr_read_b32 v29, a247
    v_mfma_f32_16x16x32_bf16 a[76:79], a[196:199], v[20:23], a[76:79]
    buffer_load_dwordx4 v[204:207], v4, s[40:43], s50 offen
    v_mfma_f32_16x16x32_bf16 a[80:83], a[180:183], v[16:19], a[80:83]
    v_perm_b32 v20, v38, v34, s49
    v_accvgpr_read_b32 v30, a248
    v_mfma_f32_16x16x32_bf16 a[84:87], a[184:187], v[16:19], a[84:87]
    v_perm_b32 v21, v46, v42, s49
    v_accvgpr_read_b32 v31, a249
    v_mfma_f32_16x16x32_bf16 a[88:91], a[188:191], v[16:19], a[88:91]
    v_perm_b32 v22, v54, v50, s49
    v_accvgpr_read_b32 v250, a244
    v_mfma_f32_16x16x32_bf16 a[92:95], a[192:195], v[16:19], a[92:95]
    v_perm_b32 v23, v62, v58, s49
    v_accvgpr_read_b32 v252, a245
    v_mfma_f32_16x16x32_bf16 a[96:99], a[196:199], v[16:19], a[96:99]
    buffer_load_dwordx4 v[208:211], v5, s[40:43], s50 offen
    v_mfma_f32_16x16x32_bf16 a[100:103], a[180:183], v[20:23], a[100:103]
    v_perm_b32 v16, v39, v35, s48
    v_add_u32 v251, 4096, v250
    v_mfma_f32_16x16x32_bf16 a[104:107], a[184:187], v[20:23], a[104:107]
    v_perm_b32 v17, v47, v43, s48
    v_mov_b32 v253, 128
    v_mfma_f32_16x16x32_bf16 a[108:111], a[188:191], v[20:23], a[108:111]
    v_perm_b32 v18, v55, v51, s48
    v_and_b32 v1, 7, v13
    v_mfma_f32_16x16x32_bf16 a[112:115], a[192:195], v[20:23], a[112:115]
    v_perm_b32 v19, v63, v59, s48
    v_lshlrev_b32 v1, 7, v1
    v_mfma_f32_16x16x32_bf16 a[116:119], a[196:199], v[20:23], a[116:119]
    buffer_load_dwordx4 v[212:215], v6, s[40:43], s50 offen
    v_mfma_f32_16x16x32_bf16 a[120:123], a[180:183], v[16:19], a[120:123]
    v_perm_b32 v20, v39, v35, s49
    s_mov_b32 s76, s97
    v_mfma_f32_16x16x32_bf16 a[124:127], a[184:187], v[16:19], a[124:127]
    v_perm_b32 v21, v47, v43, s49
    s_mov_b32 s96, 4194304
    v_mfma_f32_16x16x32_bf16 a[128:131], a[188:191], v[16:19], a[128:131]
    v_perm_b32 v22, v55, v51, s49
    s_add_u32 s77, s97, 18432
    v_mfma_f32_16x16x32_bf16 a[132:135], a[192:195], v[16:19], a[132:135]
    v_perm_b32 v23, v63, v59, s49
    s_add_u32 s78, s97, 36864
    v_mfma_f32_16x16x32_bf16 a[136:139], a[196:199], v[16:19], a[136:139]
    buffer_load_dwordx4 v[216:219], v7, s[40:43], s50 offen
    v_mfma_f32_16x16x32_bf16 a[140:143], a[180:183], v[20:23], a[140:143]
    s_add_u32 s79, s97, 55296
    s_add_u32 s80, s97, 73728
    v_mfma_f32_16x16x32_bf16 a[144:147], a[184:187], v[20:23], a[144:147]
    v_mfma_f32_16x16x32_bf16 a[148:151], a[188:191], v[20:23], a[148:151]
    s_add_u32 m0, s52, 24576
    v_mfma_f32_16x16x32_bf16 a[152:155], a[192:195], v[20:23], a[152:155]
    s_waitcnt vmcnt(25) lgkmcnt(0)
    s_barrier
    v_mfma_f32_16x16x32_bf16 a[156:159], a[196:199], v[20:23], a[156:159]
    buffer_load_dwordx4 v[220:223], v8, s[40:43], s50 offen
    v_mfma_f32_16x16x32_bf16 a[160:163], v[24:27], a[180:183], a[160:163]
    v_perm_b32 v32, v68, v64, s48
    v_perm_b32 v33, v76, v72, s48
    v_mfma_f32_16x16x32_bf16 a[164:167], v[24:27], a[184:187], a[164:167]
    v_perm_b32 v34, v84, v80, s48
    v_perm_b32 v35, v92, v88, s48
    v_mfma_f32_16x16x32_bf16 a[168:171], v[24:27], a[188:191], a[168:171]
    v_perm_b32 v36, v68, v64, s49
    v_perm_b32 v37, v76, v72, s49
    v_mfma_f32_16x16x32_bf16 a[172:175], v[24:27], a[192:195], a[172:175]
    v_perm_b32 v38, v84, v80, s49
    v_perm_b32 v39, v92, v88, s49
    v_mfma_f32_16x16x32_bf16 a[176:179], v[24:27], a[196:199], a[176:179]
    buffer_load_dwordx4 v9, s[40:43], s50 offen lds
    s_cmp_lg_u32 s84, 0
    s_cbranch_scc1 L_tail_wt
    global_load_dword v249, v1, s[100:101] offset:256 sc1
    v_mfma_f32_16x16x32_bf16 a[0:3], a[200:203], v[32:35], a[0:3]
    ds_read_b64_tr_b16 a[220:221], v11 offset:4096
    v_mfma_f32_16x16x32_bf16 a[4:7], a[204:207], v[32:35], a[4:7]
    v_perm_b32 v40, v69, v65, s48
    v_perm_b32 v41, v77, v73, s48
    v_mfma_f32_16x16x32_bf16 a[20:23], a[200:203], v[36:39], a[20:23]
    v_perm_b32 v42, v85, v81, s48
    v_perm_b32 v43, v93, v89, s48
    v_mfma_f32_16x16x32_bf16 a[24:27], a[204:207], v[36:39], a[24:27]
    v_perm_b32 v44, v69, v65, s49
    v_perm_b32 v45, v77, v73, s49
    v_mfma_f32_16x16x32_bf16 a[40:43], a[200:203], v[40:43], a[40:43]
    v_perm_b32 v46, v85, v81, s49
    v_perm_b32 v47, v93, v89, s49
    v_mfma_f32_16x16x32_bf16 a[44:47], a[204:207], v[40:43], a[44:47]
    v_perm_b32 v48, v70, v66, s48
    v_perm_b32 v49, v78, v74, s48
    v_mfma_f32_16x16x32_bf16 a[60:63], a[200:203], v[44:47], a[60:63]
    v_perm_b32 v50, v86, v82, s48
    v_perm_b32 v51, v94, v90, s48
    v_mfma_f32_16x16x32_bf16 a[64:67], a[204:207], v[44:47], a[64:67]
    v_perm_b32 v52, v70, v66, s49
    v_perm_b32 v53, v78, v74, s49
    v_mfma_f32_16x16x32_bf16 a[80:83], a[200:203], v[48:51], a[80:83]
    v_perm_b32 v54, v86, v82, s49
    v_perm_b32 v55, v94, v90, s49
    ds_read_b64_tr_b16 a[222:223], v11 offset:6144
    v_mfma_f32_16x16x32_bf16 a[84:87], a[204:207], v[48:51], a[84:87]
    v_perm_b32 v56, v71, v67, s48
    v_perm_b32 v57, v79, v75, s48
    v_mfma_f32_16x16x32_bf16 a[100:103], a[200:203], v[52:55], a[100:103]
    v_perm_b32 v58, v87, v83, s48
    v_perm_b32 v59, v95, v91, s48
    v_mfma_f32_16x16x32_bf16 a[104:107], a[204:207], v[52:55], a[104:107]
    v_perm_b32 v60, v71, v67, s49
    v_perm_b32 v61, v79, v75, s49
    v_mfma_f32_16x16x32_bf16 a[120:123], a[200:203], v[56:59], a[120:123]
    v_perm_b32 v62, v87, v83, s49
    v_perm_b32 v63, v95, v91, s49
    v_mfma_f32_16x16x32_bf16 a[124:127], a[204:207], v[56:59], a[124:127]
    buffer_load_dword v249, v236, s[44:47], s99 offen sc1
    v_mfma_f32_16x16x32_bf16 a[140:143], a[200:203], v[60:63], a[140:143]
    ds_read_b128 a[240:243], v10 offset:16384
    v_mfma_f32_16x16x32_bf16 a[144:147], a[204:207], v[60:63], a[144:147]
    s_waitcnt vmcnt(29)
    s_barrier
    v_perm_b32 v64, v100, v96, s48
    v_perm_b32 v65, v108, v104, s48
    s_waitcnt lgkmcnt(1)
    v_mfma_f32_16x16x32_bf16 a[160:163], a[220:223], a[200:203], a[160:163]
    v_perm_b32 v66, v116, v112, s48
    v_perm_b32 v67, v124, v120, s48
    v_mfma_f32_16x16x32_bf16 a[164:167], a[220:223], a[204:207], a[164:167]
    v_perm_b32 v68, v100, v96, s49
    v_perm_b32 v69, v108, v104, s49
    v_mfma_f32_16x16x32_bf16 a[0:3], a[208:211], v[64:67], a[0:3]
    v_perm_b32 v70, v116, v112, s49
    v_perm_b32 v71, v124, v120, s49
    v_mfma_f32_16x16x32_bf16 a[4:7], a[212:215], v[64:67], a[4:7]
    v_perm_b32 v72, v101, v97, s48
    v_perm_b32 v73, v109, v105, s48
    v_mfma_f32_16x16x32_bf16 a[20:23], a[208:211], v[68:71], a[20:23]
    v_perm_b32 v74, v117, v113, s48
    v_perm_b32 v75, v125, v121, s48
    v_mfma_f32_16x16x32_bf16 a[24:27], a[212:215], v[68:71], a[24:27]
    v_perm_b32 v76, v101, v97, s49
    v_perm_b32 v77, v109, v105, s49
    v_mfma_f32_16x16x32_bf16 a[40:43], a[208:211], v[72:75], a[40:43]
    v_perm_b32 v78, v117, v113, s49
    v_perm_b32 v79, v125, v121, s49
    v_mfma_f32_16x16x32_bf16 a[44:47], a[212:215], v[72:75], a[44:47]
    v_perm_b32 v80, v102, v98, s48
    v_perm_b32 v81, v110, v106, s48
    v_mfma_f32_16x16x32_bf16 a[60:63], a[208:211], v[76:79], a[60:63]
    v_perm_b32 v82, v118, v114, s48
    v_perm_b32 v83, v126, v122, s48
    v_mfma_f32_16x16x32_bf16 a[64:67], a[212:215], v[76:79], a[64:67]
    v_perm_b32 v84, v102, v98, s49
    v_perm_b32 v85, v110, v106, s49
    v_mfma_f32_16x16x32_bf16 a[80:83], a[208:211], v[80:83], a[80:83]
    v_perm_b32 v86, v118, v114, s49
    v_perm_b32 v87, v126, v122, s49
    ds_read_b64_tr_b16 a[224:225], v11 offset:8192
    v_mfma_f32_16x16x32_bf16 a[84:87], a[212:215], v[80:83], a[84:87]
    v_perm_b32 v88, v103, v99, s48
    v_perm_b32 v89, v111, v107, s48
    ds_read_b64_tr_b16 a[226:227], v11 offset:10240
    v_mfma_f32_16x16x32_bf16 a[100:103], a[208:211], v[84:87], a[100:103]
    v_perm_b32 v90, v119, v115, s48
    v_perm_b32 v91, v127, v123, s48
    v_mfma_f32_16x16x32_bf16 a[104:107], a[212:215], v[84:87], a[104:107]
    v_perm_b32 v92, v103, v99, s49
    v_perm_b32 v93, v111, v107, s49
    v_mfma_f32_16x16x32_bf16 a[120:123], a[208:211], v[88:91], a[120:123]
    v_perm_b32 v94, v119, v115, s49
    v_perm_b32 v95, v127, v123, s49
    v_mfma_f32_16x16x32_bf16 a[124:127], a[212:215], v[88:91], a[124:127]
    ds_read_b128 a[244:247], v10 offset:20480
    v_mfma_f32_16x16x32_bf16 a[140:143], a[208:211], v[92:95], a[140:143]
    ds_read_b128 a[248:251], v10 offset:21504
    v_mfma_f32_16x16x32_bf16 a[144:147], a[212:215], v[92:95], a[144:147]
    s_waitcnt vmcnt(20)
    s_barrier
    v_perm_b32 v96, v132, v128, s48
    v_perm_b32 v97, v140, v136, s48
    s_waitcnt lgkmcnt(2)
    v_mfma_f32_16x16x32_bf16 a[160:163], a[224:227], a[208:211], a[160:163]
    v_perm_b32 v98, v148, v144, s48
    v_perm_b32 v99, v156, v152, s48
    v_mfma_f32_16x16x32_bf16 a[164:167], a[224:227], a[212:215], a[164:167]
    v_perm_b32 v100, v132, v128, s49
    v_perm_b32 v101, v140, v136, s49
    v_mfma_f32_16x16x32_bf16 a[0:3], a[216:219], v[96:99], a[0:3]
    v_perm_b32 v102, v148, v144, s49
    v_perm_b32 v103, v156, v152, s49
    s_waitcnt lgkmcnt(4)
    v_mfma_f32_16x16x32_bf16 a[4:7], a[240:243], v[96:99], a[4:7]
    v_perm_b32 v104, v133, v129, s48
    v_perm_b32 v105, v141, v137, s48
    v_mfma_f32_16x16x32_bf16 a[20:23], a[216:219], v[100:103], a[20:23]
    v_perm_b32 v106, v149, v145, s48
    v_perm_b32 v107, v157, v153, s48
    v_mfma_f32_16x16x32_bf16 a[24:27], a[240:243], v[100:103], a[24:27]
    v_perm_b32 v108, v133, v129, s49
    v_perm_b32 v109, v141, v137, s49
    v_mfma_f32_16x16x32_bf16 a[40:43], a[216:219], v[104:107], a[40:43]
    v_perm_b32 v110, v149, v145, s49
    v_perm_b32 v111, v157, v153, s49
    v_mfma_f32_16x16x32_bf16 a[44:47], a[240:243], v[104:107], a[44:47]
    v_perm_b32 v112, v134, v130, s48
    v_perm_b32 v113, v142, v138, s48
    v_mfma_f32_16x16x32_bf16 a[60:63], a[216:219], v[108:111], a[60:63]
    v_perm_b32 v114, v150, v146, s48
    v_perm_b32 v115, v158, v154, s48
    v_mfma_f32_16x16x32_bf16 a[64:67], a[240:243], v[108:111], a[64:67]
    v_perm_b32 v116, v134, v130, s49
    v_perm_b32 v117, v142, v138, s49
    v_mfma_f32_16x16x32_bf16 a[80:83], a[216:219], v[112:115], a[80:83]
    v_perm_b32 v118, v150, v146, s49
    v_perm_b32 v119, v158, v154, s49
    ds_read_b64_tr_b16 a[228:229], v11 offset:12288
    v_mfma_f32_16x16x32_bf16 a[84:87], a[240:243], v[112:115], a[84:87]
    v_perm_b32 v120, v135, v131, s48
    v_perm_b32 v121, v143, v139, s48
    ds_read_b64_tr_b16 a[230:231], v11 offset:14336
    v_mfma_f32_16x16x32_bf16 a[100:103], a[216:219], v[116:119], a[100:103]
    v_perm_b32 v122, v151, v147, s48
    v_perm_b32 v123, v159, v155, s48
    v_mfma_f32_16x16x32_bf16 a[104:107], a[240:243], v[116:119], a[104:107]
    v_perm_b32 v124, v135, v131, s49
    v_perm_b32 v125, v143, v139, s49
    v_mfma_f32_16x16x32_bf16 a[120:123], a[216:219], v[120:123], a[120:123]
    v_perm_b32 v126, v151, v147, s49
    v_perm_b32 v127, v159, v155, s49
    v_mfma_f32_16x16x32_bf16 a[124:127], a[240:243], v[120:123], a[124:127]
    ds_read_b128 a[252:255], v10 offset:25600
    v_mfma_f32_16x16x32_bf16 a[140:143], a[216:219], v[124:127], a[140:143]
    ds_read_b128 a[180:183], v10 offset:26624
    v_mfma_f32_16x16x32_bf16 a[144:147], a[240:243], v[124:127], a[144:147]
    s_waitcnt vmcnt(11)
    s_barrier
    v_perm_b32 v128, v164, v160, s48
    v_perm_b32 v129, v172, v168, s48
    s_waitcnt lgkmcnt(2)
    v_mfma_f32_16x16x32_bf16 a[160:163], a[228:231], a[216:219], a[160:163]
    v_perm_b32 v130, v180, v176, s48
    v_perm_b32 v131, v188, v184, s48
    v_mfma_f32_16x16x32_bf16 a[164:167], a[228:231], a[240:243], a[164:167]
    v_perm_b32 v132, v164, v160, s49
    v_perm_b32 v133, v172, v168, s49
    s_waitcnt lgkmcnt(5)
    v_mfma_f32_16x16x32_bf16 a[0:3], a[244:247], v[128:131], a[0:3]
    v_perm_b32 v134, v180, v176, s49
    v_perm_b32 v135, v188, v184, s49
    s_waitcnt lgkmcnt(4)
    v_mfma_f32_16x16x32_bf16 a[4:7], a[248:251], v[128:131], a[4:7]
    v_perm_b32 v136, v165, v161, s48
    v_perm_b32 v137, v173, v169, s48
    v_mfma_f32_16x16x32_bf16 a[20:23], a[244:247], v[132:135], a[20:23]
    v_perm_b32 v138, v181, v177, s48
    v_perm_b32 v139, v189, v185, s48
    v_mfma_f32_16x16x32_bf16 a[24:27], a[248:251], v[132:135], a[24:27]
    v_perm_b32 v140, v165, v161, s49
    v_perm_b32 v141, v173, v169, s49
    v_mfma_f32_16x16x32_bf16 a[40:43], a[244:247], v[136:139], a[40:43]
    v_perm_b32 v142, v181, v177, s49
    v_perm_b32 v143, v189, v185, s49
    v_mfma_f32_16x16x32_bf16 a[44:47], a[248:251], v[136:139], a[44:47]
    v_perm_b32 v144, v166, v162, s48
    v_perm_b32 v145, v174, v170, s48
    v_mfma_f32_16x16x32_bf16 a[60:63], a[244:247], v[140:143], a[60:63]
    v_perm_b32 v146, v182, v178, s48
    v_perm_b32 v147, v190, v186, s48
    v_mfma_f32_16x16x32_bf16 a[64:67], a[248:251], v[140:143], a[64:67]
    v_perm_b32 v148, v166, v162, s49
    v_perm_b32 v149, v174, v170, s49
    v_mfma_f32_16x16x32_bf16 a[80:83], a[244:247], v[144:147], a[80:83]
    v_perm_b32 v150, v182, v178, s49
    v_perm_b32 v151, v190, v186, s49
    ds_read_b64_tr_b16 a[232:233], v11 offset:16384
    v_mfma_f32_16x16x32_bf16 a[84:87], a[248:251], v[144:147], a[84:87]
    v_perm_b32 v152, v167, v163, s48
    v_perm_b32 v153, v175, v171, s48
    ds_read_b64_tr_b16 a[234:235], v11 offset:18432
    v_mfma_f32_16x16x32_bf16 a[100:103], a[244:247], v[148:151], a[100:103]
    v_perm_b32 v154, v183, v179, s48
    v_perm_b32 v155, v191, v187, s48
    v_mfma_f32_16x16x32_bf16 a[104:107], a[248:251], v[148:151], a[104:107]
    v_perm_b32 v156, v167, v163, s49
    v_perm_b32 v157, v175, v171, s49
    v_mfma_f32_16x16x32_bf16 a[120:123], a[244:247], v[152:155], a[120:123]
    v_perm_b32 v158, v183, v179, s49
    v_perm_b32 v159, v191, v187, s49
    v_mfma_f32_16x16x32_bf16 a[124:127], a[248:251], v[152:155], a[124:127]
    ds_read_b128 a[184:187], v10 offset:7168
    v_mfma_f32_16x16x32_bf16 a[140:143], a[244:247], v[156:159], a[140:143]
    ds_read_b128 a[188:191], v10 offset:12288
    v_mfma_f32_16x16x32_bf16 a[144:147], a[248:251], v[156:159], a[144:147]
    s_waitcnt vmcnt(2)
    s_barrier
    v_perm_b32 v160, v196, v192, s48
    v_perm_b32 v161, v204, v200, s48
    s_waitcnt lgkmcnt(2)
    v_mfma_f32_16x16x32_bf16 a[160:163], a[232:235], a[244:247], a[160:163]
    v_perm_b32 v162, v212, v208, s48
    v_perm_b32 v163, v220, v216, s48
    v_mfma_f32_16x16x32_bf16 a[164:167], a[232:235], a[248:251], a[164:167]
    v_perm_b32 v164, v196, v192, s49
    v_perm_b32 v165, v204, v200, s49
    s_waitcnt lgkmcnt(5)
    v_mfma_f32_16x16x32_bf16 a[0:3], a[252:255], v[160:163], a[0:3]
    v_perm_b32 v166, v212, v208, s49
    v_perm_b32 v167, v220, v216, s49
    s_waitcnt lgkmcnt(4)
    v_mfma_f32_16x16x32_bf16 a[4:7], a[180:183], v[160:163], a[4:7]
    v_perm_b32 v168, v197, v193, s48
    v_perm_b32 v169, v205, v201, s48
    v_mfma_f32_16x16x32_bf16 a[20:23], a[252:255], v[164:167], a[20:23]
    v_perm_b32 v170, v213, v209, s48
    v_perm_b32 v171, v221, v217, s48
    v_mfma_f32_16x16x32_bf16 a[24:27], a[180:183], v[164:167], a[24:27]
    v_perm_b32 v172, v197, v193, s49
    v_perm_b32 v173, v205, v201, s49
    v_mfma_f32_16x16x32_bf16 a[40:43], a[252:255], v[168:171], a[40:43]
    v_perm_b32 v174, v213, v209, s49
    v_perm_b32 v175, v221, v217, s49
    v_mfma_f32_16x16x32_bf16 a[44:47], a[180:183], v[168:171], a[44:47]
    v_perm_b32 v176, v198, v194, s48
    v_perm_b32 v177, v206, v202, s48
    v_mfma_f32_16x16x32_bf16 a[60:63], a[252:255], v[172:175], a[60:63]
    v_perm_b32 v178, v214, v210, s48
    v_perm_b32 v179, v222, v218, s48
    v_mfma_f32_16x16x32_bf16 a[64:67], a[180:183], v[172:175], a[64:67]
    v_perm_b32 v180, v198, v194, s49
    v_perm_b32 v181, v206, v202, s49
    v_mfma_f32_16x16x32_bf16 a[80:83], a[252:255], v[176:179], a[80:83]
    v_perm_b32 v182, v214, v210, s49
    v_perm_b32 v183, v222, v218, s49
    ds_read_b64_tr_b16 a[236:237], v11 offset:20480
    v_mfma_f32_16x16x32_bf16 a[84:87], a[180:183], v[176:179], a[84:87]
    v_perm_b32 v184, v199, v195, s48
    v_perm_b32 v185, v207, v203, s48
    ds_read_b64_tr_b16 a[238:239], v11 offset:22528
    v_mfma_f32_16x16x32_bf16 a[100:103], a[252:255], v[180:183], a[100:103]
    v_perm_b32 v186, v215, v211, s48
    v_perm_b32 v187, v223, v219, s48
    v_mfma_f32_16x16x32_bf16 a[104:107], a[180:183], v[180:183], a[104:107]
    v_perm_b32 v188, v199, v195, s49
    v_perm_b32 v189, v207, v203, s49
    v_mfma_f32_16x16x32_bf16 a[120:123], a[252:255], v[184:187], a[120:123]
    v_perm_b32 v190, v215, v211, s49
    v_perm_b32 v191, v223, v219, s49
    v_mfma_f32_16x16x32_bf16 a[124:127], a[180:183], v[184:187], a[124:127]
    ds_read_b128 a[192:195], v10 offset:17408
    v_mfma_f32_16x16x32_bf16 a[140:143], a[252:255], v[188:191], a[140:143]
    ds_read_b128 a[196:199], v10 offset:22528
    v_mfma_f32_16x16x32_bf16 a[144:147], a[180:183], v[188:191], a[144:147]
    ds_read_b128 a[200:203], v10 offset:27648
    s_waitcnt lgkmcnt(3)
    v_mfma_f32_16x16x32_bf16 a[160:163], a[236:239], a[252:255], a[160:163]
    v_mfma_f32_16x16x32_bf16 a[164:167], a[236:239], a[180:183], a[164:167]
    s_waitcnt lgkmcnt(6)
    v_mfma_f32_16x16x32_bf16 a[8:11], a[184:187], v[32:35], a[8:11]
    v_mfma_f32_16x16x32_bf16 a[28:31], a[184:187], v[36:39], a[28:31]
    v_mfma_f32_16x16x32_bf16 a[48:51], a[184:187], v[40:43], a[48:51]
    v_mfma_f32_16x16x32_bf16 a[68:71], a[184:187], v[44:47], a[68:71]
    v_mfma_f32_16x16x32_bf16 a[88:91], a[184:187], v[48:51], a[88:91]
    v_accvgpr_read_b32 v240, a0
    v_accvgpr_read_b32 v241, a20
    v_mfma_f32_16x16x32_bf16 a[108:111], a[184:187], v[52:55], a[108:111]
    ds_read_b128 a[204:207], v10 offset:8192
    v_mfma_f32_16x16x32_bf16 a[128:131], a[184:187], v[56:59], a[128:131]
    v_accvgpr_read_b32 v242, a40
    v_accvgpr_read_b32 v243, a60
    v_mfma_f32_16x16x32_bf16 a[148:151], a[184:187], v[60:63], a[148:151]
    v_accvgpr_read_b32 v244, a80
    v_accvgpr_read_b32 v245, a100
    v_mfma_f32_16x16x32_bf16 a[168:171], a[220:223], a[184:187], a[168:171]
    v_accvgpr_read_b32 v246, a120
    v_accvgpr_read_b32 v247, a140
    s_waitcnt lgkmcnt(6)
    v_mfma_f32_16x16x32_bf16 a[8:11], a[188:191], v[64:67], a[8:11]
    v_cvt_pk_bf16_f32 v16, v240, v241
    v_cvt_pk_bf16_f32 v17, v242, v243
    v_mfma_f32_16x16x32_bf16 a[28:31], a[188:191], v[68:71], a[28:31]
    v_cvt_pk_bf16_f32 v18, v244, v245
    v_cvt_pk_bf16_f32 v19, v246, v247
    v_mfma_f32_16x16x32_bf16 a[48:51], a[188:191], v[72:75], a[48:51]
    buffer_store_dwordx4 v[16:19], v28, s[44:47], s76 offen offset:0
    v_mfma_f32_16x16x32_bf16 a[68:71], a[188:191], v[76:79], a[68:71]
    v_accvgpr_read_b32 v240, a1
    v_accvgpr_read_b32 v241, a21
    v_mfma_f32_16x16x32_bf16 a[88:91], a[188:191], v[80:83], a[88:91]
    v_accvgpr_read_b32 v242, a41
    v_accvgpr_read_b32 v243, a61
    v_mfma_f32_16x16x32_bf16 a[108:111], a[188:191], v[84:87], a[108:111]
    ds_read_b128 a[208:211], v10 offset:13312
    v_mfma_f32_16x16x32_bf16 a[128:131], a[188:191], v[88:91], a[128:131]
    v_accvgpr_read_b32 v244, a81
    v_accvgpr_read_b32 v245, a101
    v_mfma_f32_16x16x32_bf16 a[148:151], a[188:191], v[92:95], a[148:151]
    v_accvgpr_read_b32 v246, a121
    v_accvgpr_read_b32 v247, a141
    v_mfma_f32_16x16x32_bf16 a[168:171], a[224:227], a[188:191], a[168:171]
    v_cvt_pk_bf16_f32 v20, v240, v241
    v_cvt_pk_bf16_f32 v21, v242, v243
    s_waitcnt lgkmcnt(4)
    v_mfma_f32_16x16x32_bf16 a[8:11], a[192:195], v[96:99], a[8:11]
    v_cvt_pk_bf16_f32 v22, v244, v245
    v_cvt_pk_bf16_f32 v23, v246, v247
    v_mfma_f32_16x16x32_bf16 a[28:31], a[192:195], v[100:103], a[28:31]
    buffer_store_dwordx4 v[20:23], v28, s[44:47], s76 offen offset:1152
    v_mfma_f32_16x16x32_bf16 a[48:51], a[192:195], v[104:107], a[48:51]
    v_accvgpr_read_b32 v240, a2
    v_accvgpr_read_b32 v241, a22
    v_mfma_f32_16x16x32_bf16 a[68:71], a[192:195], v[108:111], a[68:71]
    v_accvgpr_read_b32 v242, a42
    v_accvgpr_read_b32 v243, a62
    v_mfma_f32_16x16x32_bf16 a[88:91], a[192:195], v[112:115], a[88:91]
    v_accvgpr_read_b32 v244, a82
    v_accvgpr_read_b32 v245, a102
    v_mfma_f32_16x16x32_bf16 a[108:111], a[192:195], v[116:119], a[108:111]
    ds_read_b128 a[212:215], v10 offset:18432
    v_mfma_f32_16x16x32_bf16 a[128:131], a[192:195], v[120:123], a[128:131]
    v_accvgpr_read_b32 v246, a122
    v_accvgpr_read_b32 v247, a142
    v_mfma_f32_16x16x32_bf16 a[148:151], a[192:195], v[124:127], a[148:151]
    v_cvt_pk_bf16_f32 v24, v240, v241
    v_cvt_pk_bf16_f32 v25, v242, v243
    v_mfma_f32_16x16x32_bf16 a[168:171], a[228:231], a[192:195], a[168:171]
    v_cvt_pk_bf16_f32 v26, v244, v245
    v_cvt_pk_bf16_f32 v27, v246, v247
    s_waitcnt lgkmcnt(4)
    v_mfma_f32_16x16x32_bf16 a[8:11], a[196:199], v[128:131], a[8:11]
    buffer_store_dwordx4 v[24:27], v28, s[44:47], s76 offen offset:2304
    v_mfma_f32_16x16x32_bf16 a[28:31], a[196:199], v[132:135], a[28:31]
    v_accvgpr_read_b32 v240, a3
    v_accvgpr_read_b32 v241, a23
    v_mfma_f32_16x16x32_bf16 a[48:51], a[196:199], v[136:139], a[48:51]
    v_accvgpr_read_b32 v242, a43
    v_accvgpr_read_b32 v243, a63
    v_mfma_f32_16x16x32_bf16 a[68:71], a[196:199], v[140:143], a[68:71]
    buffer_load_dword v249, v30, s[44:47], s96 offen offset:0 sc1
    v_mfma_f32_16x16x32_bf16 a[88:91], a[196:199], v[144:147], a[88:91]
    v_accvgpr_read_b32 v244, a83
    v_accvgpr_read_b32 v245, a103
    v_mfma_f32_16x16x32_bf16 a[108:111], a[196:199], v[148:151], a[108:111]
    ds_read_b128 a[216:219], v10 offset:23552
    v_mfma_f32_16x16x32_bf16 a[128:131], a[196:199], v[152:155], a[128:131]
    buffer_load_dword v249, v30, s[44:47], s96 offen offset:128 sc1
    v_mfma_f32_16x16x32_bf16 a[148:151], a[196:199], v[156:159], a[148:151]
    v_accvgpr_read_b32 v246, a123
    v_accvgpr_read_b32 v247, a143
    v_mfma_f32_16x16x32_bf16 a[168:171], a[232:235], a[196:199], a[168:171]
    v_cvt_pk_bf16_f32 v16, v240, v241
    v_cvt_pk_bf16_f32 v17, v242, v243
    s_waitcnt lgkmcnt(4)
    v_mfma_f32_16x16x32_bf16 a[8:11], a[200:203], v[160:163], a[8:11]
    buffer_load_dword v249, v30, s[44:47], s96 offen offset:256 sc1
    v_mfma_f32_16x16x32_bf16 a[28:31], a[200:203], v[164:167], a[28:31]
    v_cvt_pk_bf16_f32 v18, v244, v245
    v_cvt_pk_bf16_f32 v19, v246, v247
    v_mfma_f32_16x16x32_bf16 a[48:51], a[200:203], v[168:171], a[48:51]
    buffer_store_dwordx4 v[16:19], v28, s[44:47], s76 offen offset:3456
    v_mfma_f32_16x16x32_bf16 a[68:71], a[200:203], v[172:175], a[68:71]
    v_accvgpr_read_b32 v240, a160
    v_accvgpr_read_b32 v241, a161
    v_mfma_f32_16x16x32_bf16 a[88:91], a[200:203], v[176:179], a[88:91]
    v_accvgpr_read_b32 v242, a162
    v_accvgpr_read_b32 v243, a163
    v_mfma_f32_16x16x32_bf16 a[108:111], a[200:203], v[180:183], a[108:111]
    ds_read_b128 a[240:243], v10 offset:28672
    v_mfma_f32_16x16x32_bf16 a[128:131], a[200:203], v[184:187], a[128:131]
    v_cvt_pk_bf16_f32 v20, v240, v241
    v_cvt_pk_bf16_f32 v21, v242, v243
    v_mfma_f32_16x16x32_bf16 a[148:151], a[200:203], v[188:191], a[148:151]
    buffer_store_dwordx2 v[20:21], v29, s[44:47], s76 offen
    v_mfma_f32_16x16x32_bf16 a[168:171], a[236:239], a[200:203], a[168:171]
    v_accvgpr_read_b32 v240, a4
    v_accvgpr_read_b32 v241, a24
    s_waitcnt lgkmcnt(4)
    v_mfma_f32_16x16x32_bf16 a[12:15], a[204:207], v[32:35], a[12:15]
    v_accvgpr_read_b32 v242, a44
    v_accvgpr_read_b32 v243, a64
    v_mfma_f32_16x16x32_bf16 a[32:35], a[204:207], v[36:39], a[32:35]
    v_accvgpr_read_b32 v244, a84
    v_accvgpr_read_b32 v245, a104
    v_mfma_f32_16x16x32_bf16 a[52:55], a[204:207], v[40:43], a[52:55]
    v_accvgpr_read_b32 v246, a124
    v_accvgpr_read_b32 v247, a144
    v_mfma_f32_16x16x32_bf16 a[72:75], a[204:207], v[44:47], a[72:75]
    v_cvt_pk_bf16_f32 v24, v240, v241
    v_cvt_pk_bf16_f32 v25, v242, v243
    v_mfma_f32_16x16x32_bf16 a[92:95], a[204:207], v[48:51], a[92:95]
    v_cvt_pk_bf16_f32 v26, v244, v245
    v_cvt_pk_bf16_f32 v27, v246, v247
    v_mfma_f32_16x16x32_bf16 a[112:115], a[204:207], v[52:55], a[112:115]
    ds_read_b128 a[244:247], v10 offset:9216
    v_mfma_f32_16x16x32_bf16 a[132:135], a[204:207], v[56:59], a[132:135]
    buffer_store_dwordx4 v[24:27], v28, s[44:47], s77 offen offset:0
    v_mfma_f32_16x16x32_bf16 a[152:155], a[204:207], v[60:63], a[152:155]
    v_accvgpr_read_b32 v240, a5
    v_accvgpr_read_b32 v241, a25
    v_mfma_f32_16x16x32_bf16 a[172:175], a[220:223], a[204:207], a[172:175]
    v_accvgpr_read_b32 v242, a45
    v_accvgpr_read_b32 v243, a65
    s_waitcnt lgkmcnt(4)
    v_mfma_f32_16x16x32_bf16 a[12:15], a[208:211], v[64:67], a[12:15]
    v_accvgpr_read_b32 v244, a85
    v_accvgpr_read_b32 v245, a105
    v_mfma_f32_16x16x32_bf16 a[32:35], a[208:211], v[68:71], a[32:35]
    v_accvgpr_read_b32 v246, a125
    v_accvgpr_read_b32 v247, a145
    v_mfma_f32_16x16x32_bf16 a[52:55], a[208:211], v[72:75], a[52:55]
    v_cvt_pk_bf16_f32 v16, v240, v241
    v_cvt_pk_bf16_f32 v17, v242, v243
    v_mfma_f32_16x16x32_bf16 a[72:75], a[208:211], v[76:79], a[72:75]
    v_cvt_pk_bf16_f32 v18, v244, v245
    v_cvt_pk_bf16_f32 v19, v246, v247
    v_mfma_f32_16x16x32_bf16 a[92:95], a[208:211], v[80:83], a[92:95]
    buffer_store_dwordx4 v[16:19], v28, s[44:47], s77 offen offset:1152
    v_mfma_f32_16x16x32_bf16 a[112:115], a[208:211], v[84:87], a[112:115]
    ds_read_b128 a[248:251], v10 offset:14336
    v_mfma_f32_16x16x32_bf16 a[132:135], a[208:211], v[88:91], a[132:135]
    v_accvgpr_read_b32 v240, a6
    v_accvgpr_read_b32 v241, a26
    v_mfma_f32_16x16x32_bf16 a[152:155], a[208:211], v[92:95], a[152:155]
    v_accvgpr_read_b32 v242, a46
    v_accvgpr_read_b32 v243, a66
    v_mfma_f32_16x16x32_bf16 a[172:175], a[224:227], a[208:211], a[172:175]
    v_accvgpr_read_b32 v244, a86
    v_accvgpr_read_b32 v245, a106
    s_waitcnt lgkmcnt(4)
    v_mfma_f32_16x16x32_bf16 a[12:15], a[212:215], v[96:99], a[12:15]
    v_accvgpr_read_b32 v246, a126
    v_accvgpr_read_b32 v247, a146
    v_mfma_f32_16x16x32_bf16 a[32:35], a[212:215], v[100:103], a[32:35]
    v_cvt_pk_bf16_f32 v20, v240, v241
    v_cvt_pk_bf16_f32 v21, v242, v243
    v_mfma_f32_16x16x32_bf16 a[52:55], a[212:215], v[104:107], a[52:55]
    v_cvt_pk_bf16_f32 v22, v244, v245
    v_cvt_pk_bf16_f32 v23, v246, v247
    v_mfma_f32_16x16x32_bf16 a[72:75], a[212:215], v[108:111], a[72:75]
    buffer_store_dwordx4 v[20:23], v28, s[44:47], s77 offen offset:2304
    v_mfma_f32_16x16x32_bf16 a[92:95], a[212:215], v[112:115], a[92:95]
    v_accvgpr_read_b32 v240, a7
    v_accvgpr_read_b32 v241, a27
    v_mfma_f32_16x16x32_bf16 a[112:115], a[212:215], v[116:119], a[112:115]
    ds_read_b128 a[252:255], v10 offset:19456
    v_mfma_f32_16x16x32_bf16 a[132:135], a[212:215], v[120:123], a[132:135]
    v_accvgpr_read_b32 v242, a47
    v_accvgpr_read_b32 v243, a67
    v_mfma_f32_16x16x32_bf16 a[152:155], a[212:215], v[124:127], a[152:155]
    v_accvgpr_read_b32 v244, a87
    v_accvgpr_read_b32 v245, a107
    v_mfma_f32_16x16x32_bf16 a[172:175], a[228:231], a[212:215], a[172:175]
    v_accvgpr_read_b32 v246, a127
    v_accvgpr_read_b32 v247, a147
    s_waitcnt lgkmcnt(4)
    v_mfma_f32_16x16x32_bf16 a[12:15], a[216:219], v[128:131], a[12:15]
    v_cvt_pk_bf16_f32 v24, v240, v241
    v_cvt_pk_bf16_f32 v25, v242, v243
    v_mfma_f32_16x16x32_bf16 a[32:35], a[216:219], v[132:135], a[32:35]
    v_cvt_pk_bf16_f32 v26, v244, v245
    v_cvt_pk_bf16_f32 v27, v246, v247
    v_mfma_f32_16x16x32_bf16 a[52:55], a[216:219], v[136:139], a[52:55]
    buffer_store_dwordx4 v[24:27], v28, s[44:47], s77 offen offset:3456
    v_mfma_f32_16x16x32_bf16 a[72:75], a[216:219], v[140:143], a[72:75]
    v_accvgpr_read_b32 v240, a164
    v_accvgpr_read_b32 v241, a165
    v_mfma_f32_16x16x32_bf16 a[92:95], a[216:219], v[144:147], a[92:95]
    v_accvgpr_read_b32 v242, a166
    v_accvgpr_read_b32 v243, a167
    v_mfma_f32_16x16x32_bf16 a[112:115], a[216:219], v[148:151], a[112:115]
    ds_read_b128 a[180:183], v10 offset:24576
    v_mfma_f32_16x16x32_bf16 a[132:135], a[216:219], v[152:155], a[132:135]
    v_cvt_pk_bf16_f32 v16, v240, v241
    v_cvt_pk_bf16_f32 v17, v242, v243
    v_mfma_f32_16x16x32_bf16 a[152:155], a[216:219], v[156:159], a[152:155]
    buffer_store_dwordx2 v[16:17], v29, s[44:47], s77 offen
    v_mfma_f32_16x16x32_bf16 a[172:175], a[232:235], a[216:219], a[172:175]
    v_accvgpr_read_b32 v240, a8
    v_accvgpr_read_b32 v241, a28
    s_waitcnt lgkmcnt(4)
    v_mfma_f32_16x16x32_bf16 a[12:15], a[240:243], v[160:163], a[12:15]
    v_accvgpr_read_b32 v242, a48
    v_accvgpr_read_b32 v243, a68
    v_mfma_f32_16x16x32_bf16 a[32:35], a[240:243], v[164:167], a[32:35]
    v_accvgpr_read_b32 v244, a88
    v_accvgpr_read_b32 v245, a108
    v_mfma_f32_16x16x32_bf16 a[52:55], a[240:243], v[168:171], a[52:55]
    v_accvgpr_read_b32 v246, a128
    v_accvgpr_read_b32 v247, a148
    v_mfma_f32_16x16x32_bf16 a[72:75], a[240:243], v[172:175], a[72:75]
    v_cvt_pk_bf16_f32 v20, v240, v241
    v_cvt_pk_bf16_f32 v21, v242, v243
    v_mfma_f32_16x16x32_bf16 a[92:95], a[240:243], v[176:179], a[92:95]
    v_cvt_pk_bf16_f32 v22, v244, v245
    v_cvt_pk_bf16_f32 v23, v246, v247
    v_mfma_f32_16x16x32_bf16 a[112:115], a[240:243], v[180:183], a[112:115]
    ds_read_b128 a[184:187], v10 offset:29696
    v_mfma_f32_16x16x32_bf16 a[132:135], a[240:243], v[184:187], a[132:135]
    buffer_store_dwordx4 v[20:23], v28, s[44:47], s78 offen offset:0
    v_mfma_f32_16x16x32_bf16 a[152:155], a[240:243], v[188:191], a[152:155]
    v_accvgpr_read_b32 v240, a9
    v_accvgpr_read_b32 v241, a29
    v_mfma_f32_16x16x32_bf16 a[172:175], a[236:239], a[240:243], a[172:175]
    v_accvgpr_read_b32 v242, a49
    v_accvgpr_read_b32 v243, a69
    s_waitcnt lgkmcnt(4)
    v_mfma_f32_16x16x32_bf16 a[16:19], a[244:247], v[32:35], a[16:19]
    v_accvgpr_read_b32 v244, a89
    v_accvgpr_read_b32 v245, a109
    v_mfma_f32_16x16x32_bf16 a[36:39], a[244:247], v[36:39], a[36:39]
    v_accvgpr_read_b32 v246, a129
    v_accvgpr_read_b32 v247, a149
    v_mfma_f32_16x16x32_bf16 a[56:59], a[244:247], v[40:43], a[56:59]
    v_cvt_pk_bf16_f32 v24, v240, v241
    v_cvt_pk_bf16_f32 v25, v242, v243
    v_mfma_f32_16x16x32_bf16 a[76:79], a[244:247], v[44:47], a[76:79]
    v_cvt_pk_bf16_f32 v26, v244, v245
    v_cvt_pk_bf16_f32 v27, v246, v247
    v_mfma_f32_16x16x32_bf16 a[96:99], a[244:247], v[48:51], a[96:99]
    buffer_store_dwordx4 v[24:27], v28, s[44:47], s78 offen offset:1152
    v_mfma_f32_16x16x32_bf16 a[116:119], a[244:247], v[52:55], a[116:119]
    v_accvgpr_read_b32 v240, a10
    v_accvgpr_read_b32 v241, a30
    v_mfma_f32_16x16x32_bf16 a[136:139], a[244:247], v[56:59], a[136:139]
    v_accvgpr_read_b32 v242, a50
    v_accvgpr_read_b32 v243, a70
    v_mfma_f32_16x16x32_bf16 a[156:159], a[244:247], v[60:63], a[156:159]
    v_accvgpr_read_b32 v244, a90
    v_accvgpr_read_b32 v245, a110
    v_mfma_f32_16x16x32_bf16 a[176:179], a[220:223], a[244:247], a[176:179]
    v_accvgpr_read_b32 v246, a130
    v_accvgpr_read_b32 v247, a150
    s_waitcnt lgkmcnt(3)
    v_mfma_f32_16x16x32_bf16 a[16:19], a[248:251], v[64:67], a[16:19]
    v_cvt_pk_bf16_f32 v16, v240, v241
    v_cvt_pk_bf16_f32 v17, v242, v243
    v_mfma_f32_16x16x32_bf16 a[36:39], a[248:251], v[68:71], a[36:39]
    v_cvt_pk_bf16_f32 v18, v244, v245
    v_cvt_pk_bf16_f32 v19, v246, v247
    v_mfma_f32_16x16x32_bf16 a[56:59], a[248:251], v[72:75], a[56:59]
    buffer_store_dwordx4 v[16:19], v28, s[44:47], s78 offen offset:2304
    v_mfma_f32_16x16x32_bf16 a[76:79], a[248:251], v[76:79], a[76:79]
    v_accvgpr_read_b32 v240, a11
    v_accvgpr_read_b32 v241, a31
    v_mfma_f32_16x16x32_bf16 a[96:99], a[248:251], v[80:83], a[96:99]
    v_accvgpr_read_b32 v242, a51
    v_accvgpr_read_b32 v243, a71
    v_mfma_f32_16x16x32_bf16 a[116:119], a[248:251], v[84:87], a[116:119]
    v_accvgpr_read_b32 v244, a91
    v_accvgpr_read_b32 v245, a111
    v_mfma_f32_16x16x32_bf16 a[136:139], a[248:251], v[88:91], a[136:139]
    v_accvgpr_read_b32 v246, a131
    v_accvgpr_read_b32 v247, a151
    v_mfma_f32_16x16x32_bf16 a[156:159], a[248:251], v[92:95], a[156:159]
    v_cvt_pk_bf16_f32 v20, v240, v241
    v_cvt_pk_bf16_f32 v21, v242, v243
    v_mfma_f32_16x16x32_bf16 a[176:179], a[224:227], a[248:251], a[176:179]
    v_cvt_pk_bf16_f32 v22, v244, v245
    v_cvt_pk_bf16_f32 v23, v246, v247
    s_waitcnt lgkmcnt(2)
    v_mfma_f32_16x16x32_bf16 a[16:19], a[252:255], v[96:99], a[16:19]
    buffer_store_dwordx4 v[20:23], v28, s[44:47], s78 offen offset:3456
    v_mfma_f32_16x16x32_bf16 a[36:39], a[252:255], v[100:103], a[36:39]
    v_accvgpr_read_b32 v240, a168
    v_accvgpr_read_b32 v241, a169
    v_mfma_f32_16x16x32_bf16 a[56:59], a[252:255], v[104:107], a[56:59]
    v_accvgpr_read_b32 v242, a170
    v_accvgpr_read_b32 v243, a171
    v_mfma_f32_16x16x32_bf16 a[76:79], a[252:255], v[108:111], a[76:79]
    v_cvt_pk_bf16_f32 v24, v240, v241
    v_cvt_pk_bf16_f32 v25, v242, v243
    v_mfma_f32_16x16x32_bf16 a[96:99], a[252:255], v[112:115], a[96:99]
    buffer_store_dwordx2 v[24:25], v29, s[44:47], s78 offen
    v_mfma_f32_16x16x32_bf16 a[116:119], a[252:255], v[116:119], a[116:119]
    v_accvgpr_read_b32 v240, a12
    v_accvgpr_read_b32 v241, a32
    v_mfma_f32_16x16x32_bf16 a[136:139], a[252:255], v[120:123], a[136:139]
    v_accvgpr_read_b32 v242, a52
    v_accvgpr_read_b32 v243, a72
    v_mfma_f32_16x16x32_bf16 a[156:159], a[252:255], v[124:127], a[156:159]
    v_accvgpr_read_b32 v244, a92
    v_accvgpr_read_b32 v245, a112
    v_mfma_f32_16x16x32_bf16 a[176:179], a[228:231], a[252:255], a[176:179]
    v_accvgpr_read_b32 v246, a132
    v_accvgpr_read_b32 v247, a152
    s_waitcnt lgkmcnt(1)
    v_mfma_f32_16x16x32_bf16 a[16:19], a[180:183], v[128:131], a[16:19]
    v_cvt_pk_bf16_f32 v16, v240, v241
    v_cvt_pk_bf16_f32 v17, v242, v243
    v_mfma_f32_16x16x32_bf16 a[36:39], a[180:183], v[132:135], a[36:39]
    v_cvt_pk_bf16_f32 v18, v244, v245
    v_cvt_pk_bf16_f32 v19, v246, v247
    v_mfma_f32_16x16x32_bf16 a[56:59], a[180:183], v[136:139], a[56:59]
    buffer_store_dwordx4 v[16:19], v28, s[44:47], s79 offen offset:0
    v_mfma_f32_16x16x32_bf16 a[76:79], a[180:183], v[140:143], a[76:79]
    v_accvgpr_read_b32 v240, a13
    v_accvgpr_read_b32 v241, a33
    v_mfma_f32_16x16x32_bf16 a[96:99], a[180:183], v[144:147], a[96:99]
    v_accvgpr_read_b32 v242, a53
    v_accvgpr_read_b32 v243, a73
    v_mfma_f32_16x16x32_bf16 a[116:119], a[180:183], v[148:151], a[116:119]
    v_accvgpr_read_b32 v244, a93
    v_accvgpr_read_b32 v245, a113
    v_mfma_f32_16x16x32_bf16 a[136:139], a[180:183], v[152:155], a[136:139]
    v_accvgpr_read_b32 v246, a133
    v_accvgpr_read_b32 v247, a153
    v_mfma_f32_16x16x32_bf16 a[156:159], a[180:183], v[156:159], a[156:159]
    v_cvt_pk_bf16_f32 v20, v240, v241
    v_cvt_pk_bf16_f32 v21, v242, v243
    v_mfma_f32_16x16x32_bf16 a[176:179], a[232:235], a[180:183], a[176:179]
    v_cvt_pk_bf16_f32 v22, v244, v245
    v_cvt_pk_bf16_f32 v23, v246, v247
    s_waitcnt lgkmcnt(0)
    v_mfma_f32_16x16x32_bf16 a[16:19], a[184:187], v[160:163], a[16:19]
    buffer_store_dwordx4 v[20:23], v28, s[44:47], s79 offen offset:1152
    v_mfma_f32_16x16x32_bf16 a[36:39], a[184:187], v[164:167], a[36:39]
    v_accvgpr_read_b32 v240, a14
    v_accvgpr_read_b32 v241, a34
    v_mfma_f32_16x16x32_bf16 a[56:59], a[184:187], v[168:171], a[56:59]
    v_accvgpr_read_b32 v242, a54
    v_accvgpr_read_b32 v243, a74
    v_mfma_f32_16x16x32_bf16 a[76:79], a[184:187], v[172:175], a[76:79]
    v_accvgpr_read_b32 v244, a94
    v_accvgpr_read_b32 v245, a114
    v_mfma_f32_16x16x32_bf16 a[96:99], a[184:187], v[176:179], a[96:99]
    v_accvgpr_read_b32 v246, a134
    v_accvgpr_read_b32 v247, a154
    v_mfma_f32_16x16x32_bf16 a[116:119], a[184:187], v[180:183], a[116:119]
    v_cvt_pk_bf16_f32 v24, v240, v241
    v_cvt_pk_bf16_f32 v25, v242, v243
    v_mfma_f32_16x16x32_bf16 a[136:139], a[184:187], v[184:187], a[136:139]
    v_cvt_pk_bf16_f32 v26, v244, v245
    v_cvt_pk_bf16_f32 v27, v246, v247
    v_mfma_f32_16x16x32_bf16 a[156:159], a[184:187], v[188:191], a[156:159]
    buffer_store_dwordx4 v[24:27], v28, s[44:47], s79 offen offset:2304
    v_mfma_f32_16x16x32_bf16 a[176:179], a[236:239], a[184:187], a[176:179]
    v_accvgpr_read_b32 v240, a15
    v_accvgpr_read_b32 v241, a35
    s_nop 7
    v_accvgpr_read_b32 v242, a55
    v_accvgpr_read_b32 v243, a75
    v_accvgpr_read_b32 v244, a95
    v_accvgpr_read_b32 v245, a115
    v_accvgpr_read_b32 v246, a135
    v_accvgpr_read_b32 v247, a155
    v_cvt_pk_bf16_f32 v16, v240, v241
    v_cvt_pk_bf16_f32 v17, v242, v243
    v_cvt_pk_bf16_f32 v18, v244, v245
    v_cvt_pk_bf16_f32 v19, v246, v247
    buffer_store_dwordx4 v[16:19], v28, s[44:47], s79 offen offset:3456
    v_accvgpr_read_b32 v240, a172
    v_accvgpr_read_b32 v241, a173
    v_accvgpr_read_b32 v242, a174
    v_accvgpr_read_b32 v243, a175
    v_cvt_pk_bf16_f32 v20, v240, v241
    v_cvt_pk_bf16_f32 v21, v242, v243
    buffer_store_dwordx2 v[20:21], v29, s[44:47], s79 offen
    v_accvgpr_read_b32 v240, a16
    v_accvgpr_read_b32 v241, a36
    v_accvgpr_read_b32 v242, a56
    v_accvgpr_read_b32 v243, a76
    v_accvgpr_read_b32 v244, a96
    v_accvgpr_read_b32 v245, a116
    v_accvgpr_read_b32 v246, a136
    v_accvgpr_read_b32 v247, a156
    v_cvt_pk_bf16_f32 v24, v240, v241
    v_cvt_pk_bf16_f32 v25, v242, v243
    v_cvt_pk_bf16_f32 v26, v244, v245
    v_cvt_pk_bf16_f32 v27, v246, v247
    buffer_store_dwordx4 v[24:27], v28, s[44:47], s80 offen offset:0
    v_accvgpr_read_b32 v240, a17
    v_accvgpr_read_b32 v241, a37
    v_accvgpr_read_b32 v242, a57
    v_accvgpr_read_b32 v243, a77
    v_accvgpr_read_b32 v244, a97
    v_accvgpr_read_b32 v245, a117
    v_accvgpr_read_b32 v246, a137
    v_accvgpr_read_b32 v247, a157
    v_cvt_pk_bf16_f32 v16, v240, v241
    v_cvt_pk_bf16_f32 v17, v242, v243
    v_cvt_pk_bf16_f32 v18, v244, v245
    v_cvt_pk_bf16_f32 v19, v246, v247
    buffer_store_dwordx4 v[16:19], v28, s[44:47], s80 offen offset:1152
    v_accvgpr_read_b32 v240, a18
    v_accvgpr_read_b32 v241, a38
    v_accvgpr_read_b32 v242, a58
    v_accvgpr_read_b32 v243, a78
    v_accvgpr_read_b32 v244, a98
    v_accvgpr_read_b32 v245, a118
    v_accvgpr_read_b32 v246, a138
    v_accvgpr_read_b32 v247, a158
    v_cvt_pk_bf16_f32 v20, v240, v241
    v_cvt_pk_bf16_f32 v21, v242, v243
    v_cvt_pk_bf16_f32 v22, v244, v245
    v_cvt_pk_bf16_f32 v23, v246, v247
    buffer_store_dwordx4 v[20:23], v28, s[44:47], s80 offen offset:2304
    v_accvgpr_read_b32 v240, a19
    v_accvgpr_read_b32 v241, a39
    v_accvgpr_read_b32 v242, a59
    v_accvgpr_read_b32 v243, a79
    v_accvgpr_read_b32 v244, a99
    v_accvgpr_read_b32 v245, a119
    v_accvgpr_read_b32 v246, a139
    v_accvgpr_read_b32 v247, a159
    v_cvt_pk_bf16_f32 v24, v240, v241
    v_cvt_pk_bf16_f32 v25, v242, v243
    v_cvt_pk_bf16_f32 v26, v244, v245
    v_cvt_pk_bf16_f32 v27, v246, v247
    buffer_store_dwordx4 v[24:27], v28, s[44:47], s80 offen offset:3456
    v_accvgpr_read_b32 v240, a176
    v_accvgpr_read_b32 v241, a177
    v_accvgpr_read_b32 v242, a178
    v_accvgpr_read_b32 v243, a179
    v_cvt_pk_bf16_f32 v16, v240, v241
    v_cvt_pk_bf16_f32 v17, v242, v243
    buffer_store_dwordx2 v[16:17], v29, s[44:47], s80 offen
L_final:
    global_load_dword v253, v253, s[100:101] sc1
    v_mov_b32 v16, s32
    v_lshlrev_b32 v16, 7, v16
    v_mov_b32 v17, 1
    v_lshlrev_b32 v19, 7, v13
    v_add_u32 v12, 122880, v250
    s_mov_b32 s60, s24
    s_and_b32 s61, s25, 0xffff
    s_mov_b32 s62, 2359296
    s_mov_b32 s63, 0x20000
    s_mul_i32 s62, s83, 1152
    s_waitcnt vmcnt(0)
    s_barrier
    v_readfirstlane_b32 s87, v253
    s_cmp_lg_u32 s30, 0
    s_cbranch_scc1 L_sync_issued
    s_mov_b64 exec, 1
    s_cmp_eq_u32 s84, 0
    s_cbranch_scc0 L_flag_wt
    global_store_dword v16, v17, s[100:101] offset:256
L_flag_done:
    s_mov_b64 exec, -1
L_sync_issued:
    s_cmp_eq_u32 s87, 48
    s_cbranch_scc0 L_a4_poll
L_a4_go:
    s_mov_b32 s35, 4194304
    buffer_load_dwordx4 v[192:195], v30, s[44:47], s35 offen offset:0 sc1
    buffer_load_dwordx4 v[196:199], v30, s[44:47], s35 offen offset:128 sc1
    buffer_load_dwordx4 v[200:203], v30, s[44:47], s35 offen offset:256 sc1
    s_mul_i32 s33, s31, 80
    s_mul_i32 s34, s32, 10
    s_add_u32 s33, s33, s34
    s_mul_i32 s68, s33, 1152
    s_add_u32 s68, s68, 8388608
    s_add_u32 s69, s68, 2396160
    s_add_u32 s70, s68, 4792320
    s_add_u32 s71, s68, 7188480
    s_add_u32 s72, s68, 9584640
    s_add_u32 s73, s68, 11980800
    s_add_u32 s74, s68, 14376960
    s_add_u32 s75, s68, 16773120
    s_mov_b32 s33, 0x00003f80
    s_mov_b32 s34, 0x3f800000
    s_mov_b32 s94, 3207688728
    s_mov_b32 s95, 3207688728
    s_waitcnt vmcnt(0)
    ds_write2_b64 v31, v[192:193], v[194:195] offset0:0 offset1:144
    ds_write2_b64 v31, v[196:197], v[198:199] offset0:1 offset1:145
    ds_write2_b64 v31, v[200:201], v[202:203] offset0:2 offset1:146
    s_waitcnt lgkmcnt(0)
    s_cmp_lg_u32 s30, 0
    s_cbranch_scc1 L_sync_done
    s_mov_b32 s35, 0
    s_mov_b64 exec, 0xff
L_sync_poll:
    global_load_dword v17, v19, s[100:101] offset:256 sc1
    s_add_u32 s35, s35, 1
    s_waitcnt vmcnt(0)
    v_cmp_eq_u32 vcc, 1, v17
    s_nop 1
    s_cmp_eq_u32 vcc_lo, 0xff
    s_cbranch_scc1 L_sync_got
    s_sleep 0
    s_cmp_eq_u32 s84, 0
    s_cbranch_scc1 L_sync_short
    s_sleep 8
L_sync_short:
    s_cmp_lt_u32 s35, 0x4000
    s_cbranch_scc1 L_sync_poll
L_sync_got:
    s_mov_b64 exec, -1
L_sync_done:
    s_barrier
    buffer_load_dwordx4 v[32:35], v250, s[44:47], s68 offen sc1
    buffer_load_dwordx4 v[36:39], v250, s[44:47], s69 offen sc1
    buffer_load_dwordx4 v[40:43], v250, s[44:47], s70 offen sc1
    buffer_load_dwordx4 v[44:47], v250, s[44:47], s71 offen sc1
    ds_read_b128 v[140:143], v12 offset:0
    ds_read_b128 v[144:147], v12 offset:4096
    ds_read_b128 v[148:151], v12 offset:8192
    buffer_load_dwordx4 v[48:51], v250, s[44:47], s72 offen sc1
    buffer_load_dwordx4 v[52:55], v250, s[44:47], s73 offen sc1
    buffer_load_dwordx4 v[56:59], v250, s[44:47], s74 offen sc1
    buffer_load_dwordx4 v[60:63], v250, s[44:47], s75 offen sc1
    buffer_load_dwordx4 v[64:67], v251, s[44:47], s68 offen sc1
    buffer_load_dwordx4 v[68:71], v251, s[44:47], s69 offen sc1
    buffer_load_dwordx4 v[72:75], v251, s[44:47], s70 offen sc1
    buffer_load_dwordx4 v[76:79], v251, s[44:47], s71 offen sc1
    buffer_load_dwordx4 v[80:83], v251, s[44:47], s72 offen sc1
    buffer_load_dwordx4 v[84:87], v251, s[44:47], s73 offen sc1
    buffer_load_dwordx4 v[88:91], v251, s[44:47], s74 offen sc1
    buffer_load_dwordx4 v[92:95], v251, s[44:47], s75 offen sc1
    buffer_load_dwordx4 v[96:99], v252, s[44:47], s68 offen sc1
    buffer_load_dwordx4 v[100:103], v252, s[44:47], s69 offen sc1
    buffer_load_dwordx4 v[104:107], v252, s[44:47], s70 offen sc1
    buffer_load_dwordx4 v[108:111], v252, s[44:47], s71 offen sc1
    buffer_load_dwordx4 v[112:115], v252, s[44:47], s72 offen sc1
    buffer_load_dwordx4 v[116:119], v252, s[44:47], s73 offen sc1
    buffer_load_dwordx4 v[120:123], v252, s[44:47], s74 offen sc1
    buffer_load_dwordx4 v[124:127], v252, s[44:47], s75 offen sc1
    s_waitcnt lgkmcnt(0)
    v_lshlrev_b32 v160, 16, v224
    v_lshlrev_b32 v162, 16, v225
    v_lshlrev_b32 v164, 16, v226
    v_lshlrev_b32 v166, 16, v227
    v_and_b32 v161, 0xffff0000, v224
    v_and_b32 v163, 0xffff0000, v225
    v_and_b32 v165, 0xffff0000, v226
    v_and_b32 v167, 0xffff0000, v227
    v_dot2_f32_bf16 v160, v140, s33, v160
    v_dot2_f32_bf16 v162, v141, s33, v162
    v_dot2_f32_bf16 v164, v142, s33, v164
    v_dot2_f32_bf16 v166, v143, s33, v166
    v_dot2_f32_bf16 v161, v140, s34, v161
    v_dot2_f32_bf16 v163, v141, s34, v163
    v_dot2_f32_bf16 v165, v142, s34, v165
    v_dot2_f32_bf16 v167, v143, s34, v167
    v_cvt_pk_bf16_f32 v224, v160, v161
    v_cvt_pk_bf16_f32 v225, v162, v163
    v_cvt_pk_bf16_f32 v226, v164, v165
    v_cvt_pk_bf16_f32 v227, v166, v167
    v_lshlrev_b32 v160, 16, v228
    v_lshlrev_b32 v162, 16, v229
    v_lshlrev_b32 v164, 16, v230
    v_lshlrev_b32 v166, 16, v231
    v_and_b32 v161, 0xffff0000, v228
    v_and_b32 v163, 0xffff0000, v229
    v_and_b32 v165, 0xffff0000, v230
    v_and_b32 v167, 0xffff0000, v231
    v_dot2_f32_bf16 v160, v144, s33, v160
    v_dot2_f32_bf16 v162, v145, s33, v162
    v_dot2_f32_bf16 v164, v146, s33, v164
    v_dot2_f32_bf16 v166, v147, s33, v166
    v_dot2_f32_bf16 v161, v144, s34, v161
    v_dot2_f32_bf16 v163, v145, s34, v163
    v_dot2_f32_bf16 v165, v146, s34, v165
    v_dot2_f32_bf16 v167, v147, s34, v167
    v_cvt_pk_bf16_f32 v228, v160, v161
    v_cvt_pk_bf16_f32 v229, v162, v163
    v_cvt_pk_bf16_f32 v230, v164, v165
    v_cvt_pk_bf16_f32 v231, v166, v167
    v_lshlrev_b32 v160, 16, v232
    v_lshlrev_b32 v162, 16, v233
    v_lshlrev_b32 v164, 16, v234
    v_lshlrev_b32 v166, 16, v235
    v_and_b32 v161, 0xffff0000, v232
    v_and_b32 v163, 0xffff0000, v233
    v_and_b32 v165, 0xffff0000, v234
    v_and_b32 v167, 0xffff0000, v235
    v_dot2_f32_bf16 v160, v148, s33, v160
    v_dot2_f32_bf16 v162, v149, s33, v162
    v_dot2_f32_bf16 v164, v150, s33, v164
    v_dot2_f32_bf16 v166, v151, s33, v166
    v_dot2_f32_bf16 v161, v148, s34, v161
    v_dot2_f32_bf16 v163, v149, s34, v163
    v_dot2_f32_bf16 v165, v150, s34, v165
    v_dot2_f32_bf16 v167, v151, s34, v167
    v_cvt_pk_bf16_f32 v232, v160, v161
    v_cvt_pk_bf16_f32 v233, v162, v163
    v_cvt_pk_bf16_f32 v234, v164, v165
    v_cvt_pk_bf16_f32 v235, v166, v167
    s_waitcnt vmcnt(23)
    v_dot2_f32_bf16 v152, v32, s33, 0
    v_dot2_f32_bf16 v153, v32, s34, 0
    v_dot2_f32_bf16 v154, v33, s33, 0
    v_dot2_f32_bf16 v155, v33, s34, 0
    v_dot2_f32_bf16 v156, v34, s33, 0
    v_dot2_f32_bf16 v157, v34, s34, 0
    v_dot2_f32_bf16 v158, v35, s33, 0
    v_dot2_f32_bf16 v159, v35, s34, 0
    s_waitcnt vmcnt(22)
    v_dot2_f32_bf16 v152, v36, s33, v152
    v_dot2_f32_bf16 v153, v36, s34, v153
    v_dot2_f32_bf16 v154, v37, s33, v154
    v_dot2_f32_bf16 v155, v37, s34, v155
    v_dot2_f32_bf16 v156, v38, s33, v156
    v_dot2_f32_bf16 v157, v38, s34, v157
    v_dot2_f32_bf16 v158, v39, s33, v158
    v_dot2_f32_bf16 v159, v39, s34, v159
    s_waitcnt vmcnt(21)
    v_dot2_f32_bf16 v152, v40, s33, v152
    v_dot2_f32_bf16 v153, v40, s34, v153
    v_dot2_f32_bf16 v154, v41, s33, v154
    v_dot2_f32_bf16 v155, v41, s34, v155
    v_dot2_f32_bf16 v156, v42, s33, v156
    v_dot2_f32_bf16 v157, v42, s34, v157
    v_dot2_f32_bf16 v158, v43, s33, v158
    v_dot2_f32_bf16 v159, v43, s34, v159
    s_waitcnt vmcnt(20)
    v_dot2_f32_bf16 v152, v44, s33, v152
    v_dot2_f32_bf16 v153, v44, s34, v153
    v_dot2_f32_bf16 v154, v45, s33, v154
    v_dot2_f32_bf16 v155, v45, s34, v155
    v_dot2_f32_bf16 v156, v46, s33, v156
    v_dot2_f32_bf16 v157, v46, s34, v157
    v_dot2_f32_bf16 v158, v47, s33, v158
    v_dot2_f32_bf16 v159, v47, s34, v159
    s_waitcnt vmcnt(19)
    v_dot2_f32_bf16 v152, v48, s33, v152
    v_dot2_f32_bf16 v153, v48, s34, v153
    v_dot2_f32_bf16 v154, v49, s33, v154
    v_dot2_f32_bf16 v155, v49, s34, v155
    v_dot2_f32_bf16 v156, v50, s33, v156
    v_dot2_f32_bf16 v157, v50, s34, v157
    v_dot2_f32_bf16 v158, v51, s33, v158
    v_dot2_f32_bf16 v159, v51, s34, v159
    s_waitcnt vmcnt(18)
    v_dot2_f32_bf16 v152, v52, s33, v152
    v_dot2_f32_bf16 v153, v52, s34, v153
    v_dot2_f32_bf16 v154, v53, s33, v154
    v_dot2_f32_bf16 v155, v53, s34, v155
    v_dot2_f32_bf16 v156, v54, s33, v156
    v_dot2_f32_bf16 v157, v54, s34, v157
    v_dot2_f32_bf16 v158, v55, s33, v158
    v_dot2_f32_bf16 v159, v55, s34, v159
    s_waitcnt vmcnt(17)
    v_dot2_f32_bf16 v152, v56, s33, v152
    v_dot2_f32_bf16 v153, v56, s34, v153
    v_dot2_f32_bf16 v154, v57, s33, v154
    v_dot2_f32_bf16 v155, v57, s34, v155
    v_dot2_f32_bf16 v156, v58, s33, v156
    v_dot2_f32_bf16 v157, v58, s34, v157
    v_dot2_f32_bf16 v158, v59, s33, v158
    v_dot2_f32_bf16 v159, v59, s34, v159
    s_waitcnt vmcnt(16)
    v_dot2_f32_bf16 v152, v60, s33, v152
    v_dot2_f32_bf16 v153, v60, s34, v153
    v_dot2_f32_bf16 v154, v61, s33, v154
    v_dot2_f32_bf16 v155, v61, s34, v155
    v_dot2_f32_bf16 v156, v62, s33, v156
    v_dot2_f32_bf16 v157, v62, s34, v157
    v_dot2_f32_bf16 v158, v63, s33, v158
    v_dot2_f32_bf16 v159, v63, s34, v159
    s_nop 1
    v_pk_mul_f32 v[152:153], v[152:153], s[94:95]
    v_pk_mul_f32 v[154:155], v[154:155], s[94:95]
    v_pk_mul_f32 v[156:157], v[156:157], s[94:95]
    v_pk_mul_f32 v[158:159], v[158:159], s[94:95]
    v_cvt_pk_bf16_f32 v24, v152, v153
    v_cvt_pk_bf16_f32 v25, v154, v155
    v_cvt_pk_bf16_f32 v26, v156, v157
    v_cvt_pk_bf16_f32 v27, v158, v159
    v_lshlrev_b32 v160, 16, v224
    v_lshlrev_b32 v162, 16, v225
    v_lshlrev_b32 v164, 16, v226
    v_lshlrev_b32 v166, 16, v227
    v_and_b32 v161, 0xffff0000, v224
    v_and_b32 v163, 0xffff0000, v225
    v_and_b32 v165, 0xffff0000, v226
    v_and_b32 v167, 0xffff0000, v227
    v_dot2_f32_bf16 v160, v24, s33, v160
    v_dot2_f32_bf16 v162, v25, s33, v162
    v_dot2_f32_bf16 v164, v26, s33, v164
    v_dot2_f32_bf16 v166, v27, s33, v166
    v_dot2_f32_bf16 v161, v24, s34, v161
    v_dot2_f32_bf16 v163, v25, s34, v163
    v_dot2_f32_bf16 v165, v26, s34, v165
    v_dot2_f32_bf16 v167, v27, s34, v167
    v_cvt_pk_bf16_f32 v224, v160, v161
    v_cvt_pk_bf16_f32 v225, v162, v163
    v_cvt_pk_bf16_f32 v226, v164, v165
    v_cvt_pk_bf16_f32 v227, v166, v167
    buffer_store_dwordx4 v[224:227], v250, s[60:63], s86 offen
    s_waitcnt vmcnt(16)
    v_dot2_f32_bf16 v152, v64, s33, 0
    v_dot2_f32_bf16 v153, v64, s34, 0
    v_dot2_f32_bf16 v154, v65, s33, 0
    v_dot2_f32_bf16 v155, v65, s34, 0
    v_dot2_f32_bf16 v156, v66, s33, 0
    v_dot2_f32_bf16 v157, v66, s34, 0
    v_dot2_f32_bf16 v158, v67, s33, 0
    v_dot2_f32_bf16 v159, v67, s34, 0
    s_waitcnt vmcnt(15)
    v_dot2_f32_bf16 v152, v68, s33, v152
    v_dot2_f32_bf16 v153, v68, s34, v153
    v_dot2_f32_bf16 v154, v69, s33, v154
    v_dot2_f32_bf16 v155, v69, s34, v155
    v_dot2_f32_bf16 v156, v70, s33, v156
    v_dot2_f32_bf16 v157, v70, s34, v157
    v_dot2_f32_bf16 v158, v71, s33, v158
    v_dot2_f32_bf16 v159, v71, s34, v159
    s_waitcnt vmcnt(14)
    v_dot2_f32_bf16 v152, v72, s33, v152
    v_dot2_f32_bf16 v153, v72, s34, v153
    v_dot2_f32_bf16 v154, v73, s33, v154
    v_dot2_f32_bf16 v155, v73, s34, v155
    v_dot2_f32_bf16 v156, v74, s33, v156
    v_dot2_f32_bf16 v157, v74, s34, v157
    v_dot2_f32_bf16 v158, v75, s33, v158
    v_dot2_f32_bf16 v159, v75, s34, v159
    s_waitcnt vmcnt(13)
    v_dot2_f32_bf16 v152, v76, s33, v152
    v_dot2_f32_bf16 v153, v76, s34, v153
    v_dot2_f32_bf16 v154, v77, s33, v154
    v_dot2_f32_bf16 v155, v77, s34, v155
    v_dot2_f32_bf16 v156, v78, s33, v156
    v_dot2_f32_bf16 v157, v78, s34, v157
    v_dot2_f32_bf16 v158, v79, s33, v158
    v_dot2_f32_bf16 v159, v79, s34, v159
    s_waitcnt vmcnt(12)
    v_dot2_f32_bf16 v152, v80, s33, v152
    v_dot2_f32_bf16 v153, v80, s34, v153
    v_dot2_f32_bf16 v154, v81, s33, v154
    v_dot2_f32_bf16 v155, v81, s34, v155
    v_dot2_f32_bf16 v156, v82, s33, v156
    v_dot2_f32_bf16 v157, v82, s34, v157
    v_dot2_f32_bf16 v158, v83, s33, v158
    v_dot2_f32_bf16 v159, v83, s34, v159
    s_waitcnt vmcnt(11)
    v_dot2_f32_bf16 v152, v84, s33, v152
    v_dot2_f32_bf16 v153, v84, s34, v153
    v_dot2_f32_bf16 v154, v85, s33, v154
    v_dot2_f32_bf16 v155, v85, s34, v155
    v_dot2_f32_bf16 v156, v86, s33, v156
    v_dot2_f32_bf16 v157, v86, s34, v157
    v_dot2_f32_bf16 v158, v87, s33, v158
    v_dot2_f32_bf16 v159, v87, s34, v159
    s_waitcnt vmcnt(10)
    v_dot2_f32_bf16 v152, v88, s33, v152
    v_dot2_f32_bf16 v153, v88, s34, v153
    v_dot2_f32_bf16 v154, v89, s33, v154
    v_dot2_f32_bf16 v155, v89, s34, v155
    v_dot2_f32_bf16 v156, v90, s33, v156
    v_dot2_f32_bf16 v157, v90, s34, v157
    v_dot2_f32_bf16 v158, v91, s33, v158
    v_dot2_f32_bf16 v159, v91, s34, v159
    s_waitcnt vmcnt(9)
    v_dot2_f32_bf16 v152, v92, s33, v152
    v_dot2_f32_bf16 v153, v92, s34, v153
    v_dot2_f32_bf16 v154, v93, s33, v154
    v_dot2_f32_bf16 v155, v93, s34, v155
    v_dot2_f32_bf16 v156, v94, s33, v156
    v_dot2_f32_bf16 v157, v94, s34, v157
    v_dot2_f32_bf16 v158, v95, s33, v158
    v_dot2_f32_bf16 v159, v95, s34, v159
    s_nop 1
    v_pk_mul_f32 v[152:153], v[152:153], s[94:95]
    v_pk_mul_f32 v[154:155], v[154:155], s[94:95]
    v_pk_mul_f32 v[156:157], v[156:157], s[94:95]
    v_pk_mul_f32 v[158:159], v[158:159], s[94:95]
    v_cvt_pk_bf16_f32 v24, v152, v153
    v_cvt_pk_bf16_f32 v25, v154, v155
    v_cvt_pk_bf16_f32 v26, v156, v157
    v_cvt_pk_bf16_f32 v27, v158, v159
    v_lshlrev_b32 v160, 16, v228
    v_lshlrev_b32 v162, 16, v229
    v_lshlrev_b32 v164, 16, v230
    v_lshlrev_b32 v166, 16, v231
    v_and_b32 v161, 0xffff0000, v228
    v_and_b32 v163, 0xffff0000, v229
    v_and_b32 v165, 0xffff0000, v230
    v_and_b32 v167, 0xffff0000, v231
    v_dot2_f32_bf16 v160, v24, s33, v160
    v_dot2_f32_bf16 v162, v25, s33, v162
    v_dot2_f32_bf16 v164, v26, s33, v164
    v_dot2_f32_bf16 v166, v27, s33, v166
    v_dot2_f32_bf16 v161, v24, s34, v161
    v_dot2_f32_bf16 v163, v25, s34, v163
    v_dot2_f32_bf16 v165, v26, s34, v165
    v_dot2_f32_bf16 v167, v27, s34, v167
    v_cvt_pk_bf16_f32 v228, v160, v161
    v_cvt_pk_bf16_f32 v229, v162, v163
    v_cvt_pk_bf16_f32 v230, v164, v165
    v_cvt_pk_bf16_f32 v231, v166, v167
    buffer_store_dwordx4 v[228:231], v251, s[60:63], s86 offen
    s_waitcnt vmcnt(9)
    v_dot2_f32_bf16 v152, v96, s33, 0
    v_dot2_f32_bf16 v153, v96, s34, 0
    v_dot2_f32_bf16 v154, v97, s33, 0
    v_dot2_f32_bf16 v155, v97, s34, 0
    v_dot2_f32_bf16 v156, v98, s33, 0
    v_dot2_f32_bf16 v157, v98, s34, 0
    v_dot2_f32_bf16 v158, v99, s33, 0
    v_dot2_f32_bf16 v159, v99, s34, 0
    s_waitcnt vmcnt(8)
    v_dot2_f32_bf16 v152, v100, s33, v152
    v_dot2_f32_bf16 v153, v100, s34, v153
    v_dot2_f32_bf16 v154, v101, s33, v154
    v_dot2_f32_bf16 v155, v101, s34, v155
    v_dot2_f32_bf16 v156, v102, s33, v156
    v_dot2_f32_bf16 v157, v102, s34, v157
    v_dot2_f32_bf16 v158, v103, s33, v158
    v_dot2_f32_bf16 v159, v103, s34, v159
    s_waitcnt vmcnt(7)
    v_dot2_f32_bf16 v152, v104, s33, v152
    v_dot2_f32_bf16 v153, v104, s34, v153
    v_dot2_f32_bf16 v154, v105, s33, v154
    v_dot2_f32_bf16 v155, v105, s34, v155
    v_dot2_f32_bf16 v156, v106, s33, v156
    v_dot2_f32_bf16 v157, v106, s34, v157
    v_dot2_f32_bf16 v158, v107, s33, v158
    v_dot2_f32_bf16 v159, v107, s34, v159
    s_waitcnt vmcnt(6)
    v_dot2_f32_bf16 v152, v108, s33, v152
    v_dot2_f32_bf16 v153, v108, s34, v153
    v_dot2_f32_bf16 v154, v109, s33, v154
    v_dot2_f32_bf16 v155, v109, s34, v155
    v_dot2_f32_bf16 v156, v110, s33, v156
    v_dot2_f32_bf16 v157, v110, s34, v157
    v_dot2_f32_bf16 v158, v111, s33, v158
    v_dot2_f32_bf16 v159, v111, s34, v159
    s_waitcnt vmcnt(5)
    v_dot2_f32_bf16 v152, v112, s33, v152
    v_dot2_f32_bf16 v153, v112, s34, v153
    v_dot2_f32_bf16 v154, v113, s33, v154
    v_dot2_f32_bf16 v155, v113, s34, v155
    v_dot2_f32_bf16 v156, v114, s33, v156
    v_dot2_f32_bf16 v157, v114, s34, v157
    v_dot2_f32_bf16 v158, v115, s33, v158
    v_dot2_f32_bf16 v159, v115, s34, v159
    s_waitcnt vmcnt(4)
    v_dot2_f32_bf16 v152, v116, s33, v152
    v_dot2_f32_bf16 v153, v116, s34, v153
    v_dot2_f32_bf16 v154, v117, s33, v154
    v_dot2_f32_bf16 v155, v117, s34, v155
    v_dot2_f32_bf16 v156, v118, s33, v156
    v_dot2_f32_bf16 v157, v118, s34, v157
    v_dot2_f32_bf16 v158, v119, s33, v158
    v_dot2_f32_bf16 v159, v119, s34, v159
    s_waitcnt vmcnt(3)
    v_dot2_f32_bf16 v152, v120, s33, v152
    v_dot2_f32_bf16 v153, v120, s34, v153
    v_dot2_f32_bf16 v154, v121, s33, v154
    v_dot2_f32_bf16 v155, v121, s34, v155
    v_dot2_f32_bf16 v156, v122, s33, v156
    v_dot2_f32_bf16 v157, v122, s34, v157
    v_dot2_f32_bf16 v158, v123, s33, v158
    v_dot2_f32_bf16 v159, v123, s34, v159
    s_waitcnt vmcnt(2)
    v_dot2_f32_bf16 v152, v124, s33, v152
    v_dot2_f32_bf16 v153, v124, s34, v153
    v_dot2_f32_bf16 v154, v125, s33, v154
    v_dot2_f32_bf16 v155, v125, s34, v155
    v_dot2_f32_bf16 v156, v126, s33, v156
    v_dot2_f32_bf16 v157, v126, s34, v157
    v_dot2_f32_bf16 v158, v127, s33, v158
    v_dot2_f32_bf16 v159, v127, s34, v159
    s_nop 1
    v_pk_mul_f32 v[152:153], v[152:153], s[94:95]
    v_pk_mul_f32 v[154:155], v[154:155], s[94:95]
    v_pk_mul_f32 v[156:157], v[156:157], s[94:95]
    v_pk_mul_f32 v[158:159], v[158:159], s[94:95]
    v_cvt_pk_bf16_f32 v24, v152, v153
    v_cvt_pk_bf16_f32 v25, v154, v155
    v_cvt_pk_bf16_f32 v26, v156, v157
    v_cvt_pk_bf16_f32 v27, v158, v159
    v_lshlrev_b32 v160, 16, v232
    v_lshlrev_b32 v162, 16, v233
    v_lshlrev_b32 v164, 16, v234
    v_lshlrev_b32 v166, 16, v235
    v_and_b32 v161, 0xffff0000, v232
    v_and_b32 v163, 0xffff0000, v233
    v_and_b32 v165, 0xffff0000, v234
    v_and_b32 v167, 0xffff0000, v235
    v_dot2_f32_bf16 v160, v24, s33, v160
    v_dot2_f32_bf16 v162, v25, s33, v162
    v_dot2_f32_bf16 v164, v26, s33, v164
    v_dot2_f32_bf16 v166, v27, s33, v166
    v_dot2_f32_bf16 v161, v24, s34, v161
    v_dot2_f32_bf16 v163, v25, s34, v163
    v_dot2_f32_bf16 v165, v26, s34, v165
    v_dot2_f32_bf16 v167, v27, s34, v167
    v_cvt_pk_bf16_f32 v232, v160, v161
    v_cvt_pk_bf16_f32 v233, v162, v163
    v_cvt_pk_bf16_f32 v234, v164, v165
    v_cvt_pk_bf16_f32 v235, v166, v167
    buffer_store_dwordx4 v[232:235], v252, s[60:63], s86 offen
    s_endpgm
L_a4_poll:
    s_mov_b32 s33, 0
    v_mov_b32 v18, 128
L_a4_poll2:
    s_sleep 16
    global_load_dword v20, v18, s[100:101] sc1
    s_add_u32 s33, s33, 1
    s_waitcnt vmcnt(0)
    v_readfirstlane_b32 s87, v20
    s_cmp_eq_u32 s87, 48
    s_cbranch_scc1 L_a4_go
    s_cmp_lt_u32 s33, 0x4000
    s_cbranch_scc1 L_a4_poll2
    s_branch L_a4_go
L_reg_check:
    v_mov_b32 v248, s81
    v_readfirstlane_b32 s33, v239
    s_mov_b32 s87, 0
L_reg_wait:
    s_lshr_b32 s35, s33, 4
    s_and_b32 s35, s35, 0x0f0f0f0f
    s_and_b32 s96, s33, 0x0f0f0f0f
    s_add_u32 s35, s35, s96
    s_mul_i32 s35, s35, 0x01010101
    s_lshr_b32 s35, s35, 24
    s_cmp_eq_u32 s35, 8
    s_cbranch_scc1 L_reg_ok
    s_sleep 16
    global_load_dword v239, v248, s[26:27] sc1
    s_add_u32 s87, s87, 1
    s_waitcnt vmcnt(0)
    v_readfirstlane_b32 s33, v239
    s_cmp_lt_u32 s87, 0x4000
    s_cbranch_scc1 L_reg_wait
    s_branch L_reg_ok
L_flag_wt:
    global_store_dword v16, v17, s[100:101] offset:256 sc0 sc1
    s_branch L_flag_done
L_signal:
    s_waitcnt vmcnt(21)
    s_barrier
    s_cmp_lg_u32 s30, 0
    s_cbranch_scc1 L_sig_back
    s_getreg_b32 s34, hwreg(HW_REG_XCC_ID)
    s_and_b32 s34, s34, 7
    s_lshl_b32 s34, s34, 2
    s_lshl_b32 s34, 1, s34
    v_mov_b32 v28, s81
    v_mov_b32 v29, s34
    s_mov_b64 exec, 1
    global_atomic_add v28, v29, s[26:27] sc1
    s_mov_b64 exec, -1
    s_branch L_sig_back
L_switch:
    v_mov_b32 v1, v12
    v_mov_b32 v9, v31
    v_add_u32 v2, 1152, v12
    v_add_u32 v3, 2304, v12
    v_add_u32 v4, 3456, v12
    v_add_u32 v5, 4608, v12
    v_add_u32 v6, 5760, v12
    v_add_u32 v7, 6912, v12
    v_add_u32 v8, 8064, v12
    s_mov_b32 s40, s22
    s_and_b32 s41, s23, 0xffff
    s_mul_i32 s55, s32, 663552
    s_mov_b32 s51, 36864
    v_mov_b32 v248, s81
    global_load_dword v239, v248, s[26:27] sc1
    s_lshr_b32 s33, s2, 3
    s_lshl_b32 s33, s33, 2
    s_add_u32 s33, s33, s30
    s_lshl_b32 s33, s33, 7
    s_add_u32 s33, s33, L_silu - L_pc0
    s_min_u32 s33, s33, L_main_end - L_pc0
    v_mov_b32 v28, s33
    s_mov_b64 exec, 1
    global_load_dword v249, v28, s[94:95]
    s_mov_b64 exec, -1
    s_branch L_sw_back
    .p2alignl 6, 0xbf800000
L_silu:
    v_accvgpr_read_b32 v250, a244
    v_accvgpr_read_b32 v28, a240
    v_accvgpr_read_b32 v29, a241
    v_readfirstlane_b32 s84, v239
    s_getreg_b32 s34, hwreg(HW_REG_XCC_ID)
    s_and_b32 s34, s34, 7
    s_lshl_b32 s34, s34, 2
    s_lshl_b32 s34, 8, s34
    s_cmp_eq_u32 s84, s34
    s_cselect_b32 s84, 0, 0x40000000
    s_cbranch_scc0 L_reg_check
L_reg_ok:
    s_or_b32 s99, s97, s84
    s_cmp_lt_u32 s30, 3
    s_cselect_b32 s99, s99, 0x40000000
    v_lshlrev_b32 v236, 3, v250
    v_subrev_u32 v10, 92160, v10
    s_barrier
    .p2alignl 3, 0xbf800000
    v_accvgpr_read_b32 v240, a0
    v_accvgpr_read_b32 v241, a20
    v_accvgpr_read_b32 v242, a40
    v_accvgpr_read_b32 v243, a60
    v_accvgpr_read_b32 v244, a80
    v_accvgpr_read_b32 v245, a100
    v_accvgpr_read_b32 v246, a120
    v_accvgpr_read_b32 v247, a140
    v_exp_f32 v30, v240
    v_exp_f32 v31, v241
    v_exp_f32 v238, v242
    v_exp_f32 v239, v243
    v_exp_f32 v250, v244
    v_exp_f32 v251, v245
    v_exp_f32 v252, v246
    v_exp_f32 v253, v247
    v_pk_add_f32 v[30:31], v[30:31], 1.0 op_sel_hi:[1,0]
    v_pk_add_f32 v[238:239], v[238:239], 1.0 op_sel_hi:[1,0]
    v_pk_add_f32 v[250:251], v[250:251], 1.0 op_sel_hi:[1,0]
    v_pk_add_f32 v[252:253], v[252:253], 1.0 op_sel_hi:[1,0]
    v_rcp_f32 v30, v30
    v_rcp_f32 v31, v31
    v_rcp_f32 v238, v238
    v_rcp_f32 v239, v239
    v_rcp_f32 v250, v250
    v_rcp_f32 v251, v251
    v_rcp_f32 v252, v252
    v_rcp_f32 v253, v253
    v_pk_mul_f32 v[30:31], v[240:241], v[30:31]
    v_pk_mul_f32 v[238:239], v[242:243], v[238:239]
    v_pk_mul_f32 v[250:251], v[244:245], v[250:251]
    v_pk_mul_f32 v[252:253], v[246:247], v[252:253]
    v_cvt_pk_bf16_f32 v20, v30, v31
    v_cvt_pk_bf16_f32 v21, v238, v239
    v_cvt_pk_bf16_f32 v22, v250, v251
    v_cvt_pk_bf16_f32 v23, v252, v253
    s_add_u32 s33, s97, 128
    s_or_b32 s33, s33, s84
    s_nop 0
    buffer_load_dword v249, v236, s[44:47], s33 offen sc1
    v_accvgpr_read_b32 v240, a1
    v_accvgpr_read_b32 v241, a21
    v_accvgpr_read_b32 v242, a41
    v_accvgpr_read_b32 v243, a61
    v_accvgpr_read_b32 v244, a81
    v_accvgpr_read_b32 v245, a101
    v_accvgpr_read_b32 v246, a121
    v_accvgpr_read_b32 v247, a141
    v_exp_f32 v30, v240
    v_exp_f32 v31, v241
    v_exp_f32 v238, v242
    v_exp_f32 v239, v243
    v_exp_f32 v250, v244
    v_exp_f32 v251, v245
    v_exp_f32 v252, v246
    v_exp_f32 v253, v247
    v_pk_add_f32 v[30:31], v[30:31], 1.0 op_sel_hi:[1,0]
    v_pk_add_f32 v[238:239], v[238:239], 1.0 op_sel_hi:[1,0]
    v_pk_add_f32 v[250:251], v[250:251], 1.0 op_sel_hi:[1,0]
    v_pk_add_f32 v[252:253], v[252:253], 1.0 op_sel_hi:[1,0]
    v_rcp_f32 v30, v30
    v_rcp_f32 v31, v31
    v_rcp_f32 v238, v238
    v_rcp_f32 v239, v239
    v_rcp_f32 v250, v250
    v_rcp_f32 v251, v251
    v_rcp_f32 v252, v252
    v_rcp_f32 v253, v253
    v_pk_mul_f32 v[30:31], v[240:241], v[30:31]
    v_pk_mul_f32 v[238:239], v[242:243], v[238:239]
    v_pk_mul_f32 v[250:251], v[244:245], v[250:251]
    v_pk_mul_f32 v[252:253], v[246:247], v[252:253]
    v_cvt_pk_bf16_f32 v24, v30, v31
    v_cvt_pk_bf16_f32 v25, v238, v239
    v_cvt_pk_bf16_f32 v26, v250, v251
    v_cvt_pk_bf16_f32 v27, v252, v253
    ds_write_b128 v28, v[20:23] offset:0
    ds_write_b128 v28, v[24:27] offset:64
    v_accvgpr_read_b32 v240, a2
    v_accvgpr_read_b32 v241, a22
    v_accvgpr_read_b32 v242, a42
    v_accvgpr_read_b32 v243, a62
    v_accvgpr_read_b32 v244, a82
    v_accvgpr_read_b32 v245, a102
    v_accvgpr_read_b32 v246, a122
    v_accvgpr_read_b32 v247, a142
    v_exp_f32 v30, v240
    v_exp_f32 v31, v241
    v_exp_f32 v238, v242
    v_exp_f32 v239, v243
    v_exp_f32 v250, v244
    v_exp_f32 v251, v245
    v_exp_f32 v252, v246
    v_exp_f32 v253, v247
    v_pk_add_f32 v[30:31], v[30:31], 1.0 op_sel_hi:[1,0]
    v_pk_add_f32 v[238:239], v[238:239], 1.0 op_sel_hi:[1,0]
    v_pk_add_f32 v[250:251], v[250:251], 1.0 op_sel_hi:[1,0]
    v_pk_add_f32 v[252:253], v[252:253], 1.0 op_sel_hi:[1,0]
    v_rcp_f32 v30, v30
    v_rcp_f32 v31, v31
    v_rcp_f32 v238, v238
    v_rcp_f32 v239, v239
    v_rcp_f32 v250, v250
    v_rcp_f32 v251, v251
    v_rcp_f32 v252, v252
    v_rcp_f32 v253, v253
    v_pk_mul_f32 v[30:31], v[240:241], v[30:31]
    v_pk_mul_f32 v[238:239], v[242:243], v[238:239]
    v_pk_mul_f32 v[250:251], v[244:245], v[250:251]
    v_pk_mul_f32 v[252:253], v[246:247], v[252:253]
    v_cvt_pk_bf16_f32 v20, v30, v31
    v_cvt_pk_bf16_f32 v21, v238, v239
    v_cvt_pk_bf16_f32 v22, v250, v251
    v_cvt_pk_bf16_f32 v23, v252, v253
    v_accvgpr_read_b32 v240, a3
    v_accvgpr_read_b32 v241, a23
    v_accvgpr_read_b32 v242, a43
    v_accvgpr_read_b32 v243, a63
    v_accvgpr_read_b32 v244, a83
    v_accvgpr_read_b32 v245, a103
    v_accvgpr_read_b32 v246, a123
    v_accvgpr_read_b32 v247, a143
    v_exp_f32 v30, v240
    v_exp_f32 v31, v241
    v_exp_f32 v238, v242
    v_exp_f32 v239, v243
    v_exp_f32 v250, v244
    v_exp_f32 v251, v245
    v_exp_f32 v252, v246
    v_exp_f32 v253, v247
    v_pk_add_f32 v[30:31], v[30:31], 1.0 op_sel_hi:[1,0]
    v_pk_add_f32 v[238:239], v[238:239], 1.0 op_sel_hi:[1,0]
    v_pk_add_f32 v[250:251], v[250:251], 1.0 op_sel_hi:[1,0]
    v_pk_add_f32 v[252:253], v[252:253], 1.0 op_sel_hi:[1,0]
    v_rcp_f32 v30, v30
    v_rcp_f32 v31, v31
    v_rcp_f32 v238, v238
    v_rcp_f32 v239, v239
    v_rcp_f32 v250, v250
    v_rcp_f32 v251, v251
    v_rcp_f32 v252, v252
    v_rcp_f32 v253, v253
    v_pk_mul_f32 v[30:31], v[240:241], v[30:31]
    v_pk_mul_f32 v[238:239], v[242:243], v[238:239]
    v_pk_mul_f32 v[250:251], v[244:245], v[250:251]
    v_pk_mul_f32 v[252:253], v[246:247], v[252:253]
    v_cvt_pk_bf16_f32 v24, v30, v31
    v_cvt_pk_bf16_f32 v25, v238, v239
    v_cvt_pk_bf16_f32 v26, v250, v251
    v_cvt_pk_bf16_f32 v27, v252, v253
    ds_write_b128 v28, v[20:23] offset:128
    ds_write_b128 v28, v[24:27] offset:192
    v_accvgpr_read_b32 v240, a4
    v_accvgpr_read_b32 v241, a24
    v_accvgpr_read_b32 v242, a44
    v_accvgpr_read_b32 v243, a64
    v_accvgpr_read_b32 v244, a84
    v_accvgpr_read_b32 v245, a104
    v_accvgpr_read_b32 v246, a124
    v_accvgpr_read_b32 v247, a144
    v_exp_f32 v30, v240
    v_exp_f32 v31, v241
    v_exp_f32 v238, v242
    v_exp_f32 v239, v243
    v_exp_f32 v250, v244
    v_exp_f32 v251, v245
    v_exp_f32 v252, v246
    v_exp_f32 v253, v247
    v_pk_add_f32 v[30:31], v[30:31], 1.0 op_sel_hi:[1,0]
    v_pk_add_f32 v[238:239], v[238:239], 1.0 op_sel_hi:[1,0]
    v_pk_add_f32 v[250:251], v[250:251], 1.0 op_sel_hi:[1,0]
    v_pk_add_f32 v[252:253], v[252:253], 1.0 op_sel_hi:[1,0]
    v_rcp_f32 v30, v30
    v_rcp_f32 v31, v31
    v_rcp_f32 v238, v238
    v_rcp_f32 v239, v239
    v_rcp_f32 v250, v250
    v_rcp_f32 v251, v251
    v_rcp_f32 v252, v252
    v_rcp_f32 v253, v253
    v_pk_mul_f32 v[30:31], v[240:241], v[30:31]
    v_pk_mul_f32 v[238:239], v[242:243], v[238:239]
    v_pk_mul_f32 v[250:251], v[244:245], v[250:251]
    v_pk_mul_f32 v[252:253], v[246:247], v[252:253]
    v_cvt_pk_bf16_f32 v20, v30, v31
    v_cvt_pk_bf16_f32 v21, v238, v239
    v_cvt_pk_bf16_f32 v22, v250, v251
    v_cvt_pk_bf16_f32 v23, v252, v253
    v_accvgpr_read_b32 v240, a5
    v_accvgpr_read_b32 v241, a25
    v_accvgpr_read_b32 v242, a45
    v_accvgpr_read_b32 v243, a65
    v_accvgpr_read_b32 v244, a85
    v_accvgpr_read_b32 v245, a105
    v_accvgpr_read_b32 v246, a125
    v_accvgpr_read_b32 v247, a145
    v_exp_f32 v30, v240
    v_exp_f32 v31, v241
    v_exp_f32 v238, v242
    v_exp_f32 v239, v243
    v_exp_f32 v250, v244
    v_exp_f32 v251, v245
    v_exp_f32 v252, v246
    v_exp_f32 v253, v247
    v_pk_add_f32 v[30:31], v[30:31], 1.0 op_sel_hi:[1,0]
    v_pk_add_f32 v[238:239], v[238:239], 1.0 op_sel_hi:[1,0]
    v_pk_add_f32 v[250:251], v[250:251], 1.0 op_sel_hi:[1,0]
    v_pk_add_f32 v[252:253], v[252:253], 1.0 op_sel_hi:[1,0]
    v_rcp_f32 v30, v30
    v_rcp_f32 v31, v31
    v_rcp_f32 v238, v238
    v_rcp_f32 v239, v239
    v_rcp_f32 v250, v250
    v_rcp_f32 v251, v251
    v_rcp_f32 v252, v252
    v_rcp_f32 v253, v253
    v_pk_mul_f32 v[30:31], v[240:241], v[30:31]
    v_pk_mul_f32 v[238:239], v[242:243], v[238:239]
    v_pk_mul_f32 v[250:251], v[244:245], v[250:251]
    v_pk_mul_f32 v[252:253], v[246:247], v[252:253]
    v_cvt_pk_bf16_f32 v24, v30, v31
    v_cvt_pk_bf16_f32 v25, v238, v239
    v_cvt_pk_bf16_f32 v26, v250, v251
    v_cvt_pk_bf16_f32 v27, v252, v253
    ds_write_b128 v28, v[20:23] offset:1024
    ds_write_b128 v28, v[24:27] offset:1088
    v_accvgpr_read_b32 v240, a6
    v_accvgpr_read_b32 v241, a26
    v_accvgpr_read_b32 v242, a46
    v_accvgpr_read_b32 v243, a66
    v_accvgpr_read_b32 v244, a86
    v_accvgpr_read_b32 v245, a106
    v_accvgpr_read_b32 v246, a126
    v_accvgpr_read_b32 v247, a146
    v_exp_f32 v30, v240
    v_exp_f32 v31, v241
    v_exp_f32 v238, v242
    v_exp_f32 v239, v243
    v_exp_f32 v250, v244
    v_exp_f32 v251, v245
    v_exp_f32 v252, v246
    v_exp_f32 v253, v247
    v_pk_add_f32 v[30:31], v[30:31], 1.0 op_sel_hi:[1,0]
    v_pk_add_f32 v[238:239], v[238:239], 1.0 op_sel_hi:[1,0]
    v_pk_add_f32 v[250:251], v[250:251], 1.0 op_sel_hi:[1,0]
    v_pk_add_f32 v[252:253], v[252:253], 1.0 op_sel_hi:[1,0]
    v_rcp_f32 v30, v30
    v_rcp_f32 v31, v31
    v_rcp_f32 v238, v238
    v_rcp_f32 v239, v239
    v_rcp_f32 v250, v250
    v_rcp_f32 v251, v251
    v_rcp_f32 v252, v252
    v_rcp_f32 v253, v253
    v_pk_mul_f32 v[30:31], v[240:241], v[30:31]
    v_pk_mul_f32 v[238:239], v[242:243], v[238:239]
    v_pk_mul_f32 v[250:251], v[244:245], v[250:251]
    v_pk_mul_f32 v[252:253], v[246:247], v[252:253]
    v_cvt_pk_bf16_f32 v20, v30, v31
    v_cvt_pk_bf16_f32 v21, v238, v239
    v_cvt_pk_bf16_f32 v22, v250, v251
    v_cvt_pk_bf16_f32 v23, v252, v253
    v_accvgpr_read_b32 v240, a7
    v_accvgpr_read_b32 v241, a27
    v_accvgpr_read_b32 v242, a47
    v_accvgpr_read_b32 v243, a67
    v_accvgpr_read_b32 v244, a87
    v_accvgpr_read_b32 v245, a107
    v_accvgpr_read_b32 v246, a127
    v_accvgpr_read_b32 v247, a147
    v_exp_f32 v30, v240
    v_exp_f32 v31, v241
    v_exp_f32 v238, v242
    v_exp_f32 v239, v243
    v_exp_f32 v250, v244
    v_exp_f32 v251, v245
    v_exp_f32 v252, v246
    v_exp_f32 v253, v247
    v_pk_add_f32 v[30:31], v[30:31], 1.0 op_sel_hi:[1,0]
    v_pk_add_f32 v[238:239], v[238:239], 1.0 op_sel_hi:[1,0]
    v_pk_add_f32 v[250:251], v[250:251], 1.0 op_sel_hi:[1,0]
    v_pk_add_f32 v[252:253], v[252:253], 1.0 op_sel_hi:[1,0]
    v_rcp_f32 v30, v30
    v_rcp_f32 v31, v31
    v_rcp_f32 v238, v238
    v_rcp_f32 v239, v239
    v_rcp_f32 v250, v250
    v_rcp_f32 v251, v251
    v_rcp_f32 v252, v252
    v_rcp_f32 v253, v253
    v_pk_mul_f32 v[30:31], v[240:241], v[30:31]
    v_pk_mul_f32 v[238:239], v[242:243], v[238:239]
    v_pk_mul_f32 v[250:251], v[244:245], v[250:251]
    v_pk_mul_f32 v[252:253], v[246:247], v[252:253]
    v_cvt_pk_bf16_f32 v24, v30, v31
    v_cvt_pk_bf16_f32 v25, v238, v239
    v_cvt_pk_bf16_f32 v26, v250, v251
    v_cvt_pk_bf16_f32 v27, v252, v253
    ds_write_b128 v28, v[20:23] offset:1152
    ds_write_b128 v28, v[24:27] offset:1216
    v_accvgpr_read_b32 v240, a8
    v_accvgpr_read_b32 v241, a28
    v_accvgpr_read_b32 v242, a48
    v_accvgpr_read_b32 v243, a68
    v_accvgpr_read_b32 v244, a88
    v_accvgpr_read_b32 v245, a108
    v_accvgpr_read_b32 v246, a128
    v_accvgpr_read_b32 v247, a148
    v_exp_f32 v30, v240
    v_exp_f32 v31, v241
    v_exp_f32 v238, v242
    v_exp_f32 v239, v243
    v_exp_f32 v250, v244
    v_exp_f32 v251, v245
    v_exp_f32 v252, v246
    v_exp_f32 v253, v247
    v_pk_add_f32 v[30:31], v[30:31], 1.0 op_sel_hi:[1,0]
    v_pk_add_f32 v[238:239], v[238:239], 1.0 op_sel_hi:[1,0]
    v_pk_add_f32 v[250:251], v[250:251], 1.0 op_sel_hi:[1,0]
    v_pk_add_f32 v[252:253], v[252:253], 1.0 op_sel_hi:[1,0]
    v_rcp_f32 v30, v30
    v_rcp_f32 v31, v31
    v_rcp_f32 v238, v238
    v_rcp_f32 v239, v239
    v_rcp_f32 v250, v250
    v_rcp_f32 v251, v251
    v_rcp_f32 v252, v252
    v_rcp_f32 v253, v253
    v_pk_mul_f32 v[30:31], v[240:241], v[30:31]
    v_pk_mul_f32 v[238:239], v[242:243], v[238:239]
    v_pk_mul_f32 v[250:251], v[244:245], v[250:251]
    v_pk_mul_f32 v[252:253], v[246:247], v[252:253]
    v_cvt_pk_bf16_f32 v20, v30, v31
    v_cvt_pk_bf16_f32 v21, v238, v239
    v_cvt_pk_bf16_f32 v22, v250, v251
    v_cvt_pk_bf16_f32 v23, v252, v253
    s_add_u32 s33, s97, 32768
    s_or_b32 s33, s33, s84
    s_nop 0
    buffer_load_dword v249, v236, s[44:47], s33 offen sc1
    v_accvgpr_read_b32 v240, a9
    v_accvgpr_read_b32 v241, a29
    v_accvgpr_read_b32 v242, a49
    v_accvgpr_read_b32 v243, a69
    v_accvgpr_read_b32 v244, a89
    v_accvgpr_read_b32 v245, a109
    v_accvgpr_read_b32 v246, a129
    v_accvgpr_read_b32 v247, a149
    v_exp_f32 v30, v240
    v_exp_f32 v31, v241
    v_exp_f32 v238, v242
    v_exp_f32 v239, v243
    v_exp_f32 v250, v244
    v_exp_f32 v251, v245
    v_exp_f32 v252, v246
    v_exp_f32 v253, v247
    v_pk_add_f32 v[30:31], v[30:31], 1.0 op_sel_hi:[1,0]
    v_pk_add_f32 v[238:239], v[238:239], 1.0 op_sel_hi:[1,0]
    v_pk_add_f32 v[250:251], v[250:251], 1.0 op_sel_hi:[1,0]
    v_pk_add_f32 v[252:253], v[252:253], 1.0 op_sel_hi:[1,0]
    v_rcp_f32 v30, v30
    v_rcp_f32 v31, v31
    v_rcp_f32 v238, v238
    v_rcp_f32 v239, v239
    v_rcp_f32 v250, v250
    v_rcp_f32 v251, v251
    v_rcp_f32 v252, v252
    v_rcp_f32 v253, v253
    v_pk_mul_f32 v[30:31], v[240:241], v[30:31]
    v_pk_mul_f32 v[238:239], v[242:243], v[238:239]
    v_pk_mul_f32 v[250:251], v[244:245], v[250:251]
    v_pk_mul_f32 v[252:253], v[246:247], v[252:253]
    v_cvt_pk_bf16_f32 v24, v30, v31
    v_cvt_pk_bf16_f32 v25, v238, v239
    v_cvt_pk_bf16_f32 v26, v250, v251
    v_cvt_pk_bf16_f32 v27, v252, v253
    ds_write_b128 v28, v[20:23] offset:2048
    ds_write_b128 v28, v[24:27] offset:2112
    v_accvgpr_read_b32 v240, a10
    v_accvgpr_read_b32 v241, a30
    v_accvgpr_read_b32 v242, a50
    v_accvgpr_read_b32 v243, a70
    v_accvgpr_read_b32 v244, a90
    v_accvgpr_read_b32 v245, a110
    v_accvgpr_read_b32 v246, a130
    v_accvgpr_read_b32 v247, a150
    v_exp_f32 v30, v240
    v_exp_f32 v31, v241
    v_exp_f32 v238, v242
    v_exp_f32 v239, v243
    v_exp_f32 v250, v244
    v_exp_f32 v251, v245
    v_exp_f32 v252, v246
    v_exp_f32 v253, v247
    v_pk_add_f32 v[30:31], v[30:31], 1.0 op_sel_hi:[1,0]
    v_pk_add_f32 v[238:239], v[238:239], 1.0 op_sel_hi:[1,0]
    v_pk_add_f32 v[250:251], v[250:251], 1.0 op_sel_hi:[1,0]
    v_pk_add_f32 v[252:253], v[252:253], 1.0 op_sel_hi:[1,0]
    v_rcp_f32 v30, v30
    v_rcp_f32 v31, v31
    v_rcp_f32 v238, v238
    v_rcp_f32 v239, v239
    v_rcp_f32 v250, v250
    v_rcp_f32 v251, v251
    v_rcp_f32 v252, v252
    v_rcp_f32 v253, v253
    v_pk_mul_f32 v[30:31], v[240:241], v[30:31]
    v_pk_mul_f32 v[238:239], v[242:243], v[238:239]
    v_pk_mul_f32 v[250:251], v[244:245], v[250:251]
    v_pk_mul_f32 v[252:253], v[246:247], v[252:253]
    v_cvt_pk_bf16_f32 v20, v30, v31
    v_cvt_pk_bf16_f32 v21, v238, v239
    v_cvt_pk_bf16_f32 v22, v250, v251
    v_cvt_pk_bf16_f32 v23, v252, v253
    v_accvgpr_read_b32 v240, a11
    v_accvgpr_read_b32 v241, a31
    v_accvgpr_read_b32 v242, a51
    v_accvgpr_read_b32 v243, a71
    v_accvgpr_read_b32 v244, a91
    v_accvgpr_read_b32 v245, a111
    v_accvgpr_read_b32 v246, a131
    v_accvgpr_read_b32 v247, a151
    v_exp_f32 v30, v240
    v_exp_f32 v31, v241
    v_exp_f32 v238, v242
    v_exp_f32 v239, v243
    v_exp_f32 v250, v244
    v_exp_f32 v251, v245
    v_exp_f32 v252, v246
    v_exp_f32 v253, v247
    v_pk_add_f32 v[30:31], v[30:31], 1.0 op_sel_hi:[1,0]
    v_pk_add_f32 v[238:239], v[238:239], 1.0 op_sel_hi:[1,0]
    v_pk_add_f32 v[250:251], v[250:251], 1.0 op_sel_hi:[1,0]
    v_pk_add_f32 v[252:253], v[252:253], 1.0 op_sel_hi:[1,0]
    v_rcp_f32 v30, v30
    v_rcp_f32 v31, v31
    v_rcp_f32 v238, v238
    v_rcp_f32 v239, v239
    v_rcp_f32 v250, v250
    v_rcp_f32 v251, v251
    v_rcp_f32 v252, v252
    v_rcp_f32 v253, v253
    v_pk_mul_f32 v[30:31], v[240:241], v[30:31]
    v_pk_mul_f32 v[238:239], v[242:243], v[238:239]
    v_pk_mul_f32 v[250:251], v[244:245], v[250:251]
    v_pk_mul_f32 v[252:253], v[246:247], v[252:253]
    v_cvt_pk_bf16_f32 v24, v30, v31
    v_cvt_pk_bf16_f32 v25, v238, v239
    v_cvt_pk_bf16_f32 v26, v250, v251
    v_cvt_pk_bf16_f32 v27, v252, v253
    ds_write_b128 v28, v[20:23] offset:2176
    ds_write_b128 v28, v[24:27] offset:2240
    v_accvgpr_read_b32 v240, a12
    v_accvgpr_read_b32 v241, a32
    v_accvgpr_read_b32 v242, a52
    v_accvgpr_read_b32 v243, a72
    v_accvgpr_read_b32 v244, a92
    v_accvgpr_read_b32 v245, a112
    v_accvgpr_read_b32 v246, a132
    v_accvgpr_read_b32 v247, a152
    v_exp_f32 v30, v240
    v_exp_f32 v31, v241
    v_exp_f32 v238, v242
    v_exp_f32 v239, v243
    v_exp_f32 v250, v244
    v_exp_f32 v251, v245
    v_exp_f32 v252, v246
    v_exp_f32 v253, v247
    v_pk_add_f32 v[30:31], v[30:31], 1.0 op_sel_hi:[1,0]
    v_pk_add_f32 v[238:239], v[238:239], 1.0 op_sel_hi:[1,0]
    v_pk_add_f32 v[250:251], v[250:251], 1.0 op_sel_hi:[1,0]
    v_pk_add_f32 v[252:253], v[252:253], 1.0 op_sel_hi:[1,0]
    v_rcp_f32 v30, v30
    v_rcp_f32 v31, v31
    v_rcp_f32 v238, v238
    v_rcp_f32 v239, v239
    v_rcp_f32 v250, v250
    v_rcp_f32 v251, v251
    v_rcp_f32 v252, v252
    v_rcp_f32 v253, v253
    v_pk_mul_f32 v[30:31], v[240:241], v[30:31]
    v_pk_mul_f32 v[238:239], v[242:243], v[238:239]
    v_pk_mul_f32 v[250:251], v[244:245], v[250:251]
    v_pk_mul_f32 v[252:253], v[246:247], v[252:253]
    v_cvt_pk_bf16_f32 v20, v30, v31
    v_cvt_pk_bf16_f32 v21, v238, v239
    v_cvt_pk_bf16_f32 v22, v250, v251
    v_cvt_pk_bf16_f32 v23, v252, v253
    v_accvgpr_read_b32 v240, a13
    v_accvgpr_read_b32 v241, a33
    v_accvgpr_read_b32 v242, a53
    v_accvgpr_read_b32 v243, a73
    v_accvgpr_read_b32 v244, a93
    v_accvgpr_read_b32 v245, a113
    v_accvgpr_read_b32 v246, a133
    v_accvgpr_read_b32 v247, a153
    v_exp_f32 v30, v240
    v_exp_f32 v31, v241
    v_exp_f32 v238, v242
    v_exp_f32 v239, v243
    v_exp_f32 v250, v244
    v_exp_f32 v251, v245
    v_exp_f32 v252, v246
    v_exp_f32 v253, v247
    v_pk_add_f32 v[30:31], v[30:31], 1.0 op_sel_hi:[1,0]
    v_pk_add_f32 v[238:239], v[238:239], 1.0 op_sel_hi:[1,0]
    v_pk_add_f32 v[250:251], v[250:251], 1.0 op_sel_hi:[1,0]
    v_pk_add_f32 v[252:253], v[252:253], 1.0 op_sel_hi:[1,0]
    v_rcp_f32 v30, v30
    v_rcp_f32 v31, v31
    v_rcp_f32 v238, v238
    v_rcp_f32 v239, v239
    v_rcp_f32 v250, v250
    v_rcp_f32 v251, v251
    v_rcp_f32 v252, v252
    v_rcp_f32 v253, v253
    v_pk_mul_f32 v[30:31], v[240:241], v[30:31]
    v_pk_mul_f32 v[238:239], v[242:243], v[238:239]
    v_pk_mul_f32 v[250:251], v[244:245], v[250:251]
    v_pk_mul_f32 v[252:253], v[246:247], v[252:253]
    v_cvt_pk_bf16_f32 v24, v30, v31
    v_cvt_pk_bf16_f32 v25, v238, v239
    v_cvt_pk_bf16_f32 v26, v250, v251
    v_cvt_pk_bf16_f32 v27, v252, v253
    ds_write_b128 v28, v[20:23] offset:3072
    ds_write_b128 v28, v[24:27] offset:3136
    v_accvgpr_read_b32 v240, a14
    v_accvgpr_read_b32 v241, a34
    v_accvgpr_read_b32 v242, a54
    v_accvgpr_read_b32 v243, a74
    v_accvgpr_read_b32 v244, a94
    v_accvgpr_read_b32 v245, a114
    v_accvgpr_read_b32 v246, a134
    v_accvgpr_read_b32 v247, a154
    v_exp_f32 v30, v240
    v_exp_f32 v31, v241
    v_exp_f32 v238, v242
    v_exp_f32 v239, v243
    v_exp_f32 v250, v244
    v_exp_f32 v251, v245
    v_exp_f32 v252, v246
    v_exp_f32 v253, v247
    v_pk_add_f32 v[30:31], v[30:31], 1.0 op_sel_hi:[1,0]
    v_pk_add_f32 v[238:239], v[238:239], 1.0 op_sel_hi:[1,0]
    v_pk_add_f32 v[250:251], v[250:251], 1.0 op_sel_hi:[1,0]
    v_pk_add_f32 v[252:253], v[252:253], 1.0 op_sel_hi:[1,0]
    v_rcp_f32 v30, v30
    v_rcp_f32 v31, v31
    v_rcp_f32 v238, v238
    v_rcp_f32 v239, v239
    v_rcp_f32 v250, v250
    v_rcp_f32 v251, v251
    v_rcp_f32 v252, v252
    v_rcp_f32 v253, v253
    v_pk_mul_f32 v[30:31], v[240:241], v[30:31]
    v_pk_mul_f32 v[238:239], v[242:243], v[238:239]
    v_pk_mul_f32 v[250:251], v[244:245], v[250:251]
    v_pk_mul_f32 v[252:253], v[246:247], v[252:253]
    v_cvt_pk_bf16_f32 v20, v30, v31
    v_cvt_pk_bf16_f32 v21, v238, v239
    v_cvt_pk_bf16_f32 v22, v250, v251
    v_cvt_pk_bf16_f32 v23, v252, v253
    v_accvgpr_read_b32 v240, a15
    v_accvgpr_read_b32 v241, a35
    v_accvgpr_read_b32 v242, a55
    v_accvgpr_read_b32 v243, a75
    v_accvgpr_read_b32 v244, a95
    v_accvgpr_read_b32 v245, a115
    v_accvgpr_read_b32 v246, a135
    v_accvgpr_read_b32 v247, a155
    v_exp_f32 v30, v240
    v_exp_f32 v31, v241
    v_exp_f32 v238, v242
    v_exp_f32 v239, v243
    v_exp_f32 v250, v244
    v_exp_f32 v251, v245
    v_exp_f32 v252, v246
    v_exp_f32 v253, v247
    v_pk_add_f32 v[30:31], v[30:31], 1.0 op_sel_hi:[1,0]
    v_pk_add_f32 v[238:239], v[238:239], 1.0 op_sel_hi:[1,0]
    v_pk_add_f32 v[250:251], v[250:251], 1.0 op_sel_hi:[1,0]
    v_pk_add_f32 v[252:253], v[252:253], 1.0 op_sel_hi:[1,0]
    v_rcp_f32 v30, v30
    v_rcp_f32 v31, v31
    v_rcp_f32 v238, v238
    v_rcp_f32 v239, v239
    v_rcp_f32 v250, v250
    v_rcp_f32 v251, v251
    v_rcp_f32 v252, v252
    v_rcp_f32 v253, v253
    v_pk_mul_f32 v[30:31], v[240:241], v[30:31]
    v_pk_mul_f32 v[238:239], v[242:243], v[238:239]
    v_pk_mul_f32 v[250:251], v[244:245], v[250:251]
    v_pk_mul_f32 v[252:253], v[246:247], v[252:253]
    v_cvt_pk_bf16_f32 v24, v30, v31
    v_cvt_pk_bf16_f32 v25, v238, v239
    v_cvt_pk_bf16_f32 v26, v250, v251
    v_cvt_pk_bf16_f32 v27, v252, v253
    ds_write_b128 v28, v[20:23] offset:3200
    ds_write_b128 v28, v[24:27] offset:3264
    s_lshr_b32 s33, s2, 3
    s_lshl_b32 s33, s33, 2
    s_add_u32 s33, s33, s30
    s_lshl_b32 s33, s33, 7
    s_add_u32 s33, s33, L_tail - L_pc0
    s_min_u32 s33, s33, L_main_end - L_pc0
    v_mov_b32 v12, s33
    s_mov_b64 exec, 1
    global_load_dword v249, v12, s[94:95]
    s_mov_b64 exec, -1
    .p2alignl 3, 0xbf800000
    v_accvgpr_read_b32 v240, a16
    v_accvgpr_read_b32 v241, a36
    v_accvgpr_read_b32 v242, a56
    v_accvgpr_read_b32 v243, a76
    v_accvgpr_read_b32 v244, a96
    v_accvgpr_read_b32 v245, a116
    v_accvgpr_read_b32 v246, a136
    v_accvgpr_read_b32 v247, a156
    v_exp_f32 v30, v240
    v_exp_f32 v31, v241
    v_exp_f32 v238, v242
    v_exp_f32 v239, v243
    v_exp_f32 v250, v244
    v_exp_f32 v251, v245
    v_exp_f32 v252, v246
    v_exp_f32 v253, v247
    v_pk_add_f32 v[30:31], v[30:31], 1.0 op_sel_hi:[1,0]
    v_pk_add_f32 v[238:239], v[238:239], 1.0 op_sel_hi:[1,0]
    v_pk_add_f32 v[250:251], v[250:251], 1.0 op_sel_hi:[1,0]
    v_pk_add_f32 v[252:253], v[252:253], 1.0 op_sel_hi:[1,0]
    v_rcp_f32 v30, v30
    v_rcp_f32 v31, v31
    v_rcp_f32 v238, v238
    v_rcp_f32 v239, v239
    v_rcp_f32 v250, v250
    v_rcp_f32 v251, v251
    v_rcp_f32 v252, v252
    v_rcp_f32 v253, v253
    v_pk_mul_f32 v[30:31], v[240:241], v[30:31]
    v_pk_mul_f32 v[238:239], v[242:243], v[238:239]
    v_pk_mul_f32 v[250:251], v[244:245], v[250:251]
    v_pk_mul_f32 v[252:253], v[246:247], v[252:253]
    v_cvt_pk_bf16_f32 v20, v30, v31
    v_cvt_pk_bf16_f32 v21, v238, v239
    v_cvt_pk_bf16_f32 v22, v250, v251
    v_cvt_pk_bf16_f32 v23, v252, v253
    v_accvgpr_read_b32 v240, a17
    v_accvgpr_read_b32 v241, a37
    v_accvgpr_read_b32 v242, a57
    v_accvgpr_read_b32 v243, a77
    v_accvgpr_read_b32 v244, a97
    v_accvgpr_read_b32 v245, a117
    v_accvgpr_read_b32 v246, a137
    v_accvgpr_read_b32 v247, a157
    v_exp_f32 v30, v240
    v_exp_f32 v31, v241
    v_exp_f32 v238, v242
    v_exp_f32 v239, v243
    v_exp_f32 v250, v244
    v_exp_f32 v251, v245
    v_exp_f32 v252, v246
    v_exp_f32 v253, v247
    v_pk_add_f32 v[30:31], v[30:31], 1.0 op_sel_hi:[1,0]
    v_pk_add_f32 v[238:239], v[238:239], 1.0 op_sel_hi:[1,0]
    v_pk_add_f32 v[250:251], v[250:251], 1.0 op_sel_hi:[1,0]
    v_pk_add_f32 v[252:253], v[252:253], 1.0 op_sel_hi:[1,0]
    v_rcp_f32 v30, v30
    v_rcp_f32 v31, v31
    v_rcp_f32 v238, v238
    v_rcp_f32 v239, v239
    v_rcp_f32 v250, v250
    v_rcp_f32 v251, v251
    v_rcp_f32 v252, v252
    v_rcp_f32 v253, v253
    v_pk_mul_f32 v[30:31], v[240:241], v[30:31]
    v_pk_mul_f32 v[238:239], v[242:243], v[238:239]
    v_pk_mul_f32 v[250:251], v[244:245], v[250:251]
    v_pk_mul_f32 v[252:253], v[246:247], v[252:253]
    v_cvt_pk_bf16_f32 v24, v30, v31
    v_cvt_pk_bf16_f32 v25, v238, v239
    v_cvt_pk_bf16_f32 v26, v250, v251
    v_cvt_pk_bf16_f32 v27, v252, v253
    ds_write_b128 v28, v[20:23] offset:4096
    ds_write_b128 v28, v[24:27] offset:4160
    v_accvgpr_read_b32 v240, a18
    v_accvgpr_read_b32 v241, a38
    v_accvgpr_read_b32 v242, a58
    v_accvgpr_read_b32 v243, a78
    v_accvgpr_read_b32 v244, a98
    v_accvgpr_read_b32 v245, a118
    v_accvgpr_read_b32 v246, a138
    v_accvgpr_read_b32 v247, a158
    v_exp_f32 v30, v240
    v_exp_f32 v31, v241
    v_exp_f32 v238, v242
    v_exp_f32 v239, v243
    v_exp_f32 v250, v244
    v_exp_f32 v251, v245
    v_exp_f32 v252, v246
    v_exp_f32 v253, v247
    v_pk_add_f32 v[30:31], v[30:31], 1.0 op_sel_hi:[1,0]
    v_pk_add_f32 v[238:239], v[238:239], 1.0 op_sel_hi:[1,0]
    v_pk_add_f32 v[250:251], v[250:251], 1.0 op_sel_hi:[1,0]
    v_pk_add_f32 v[252:253], v[252:253], 1.0 op_sel_hi:[1,0]
    v_rcp_f32 v30, v30
    v_rcp_f32 v31, v31
    v_rcp_f32 v238, v238
    v_rcp_f32 v239, v239
    v_rcp_f32 v250, v250
    v_rcp_f32 v251, v251
    v_rcp_f32 v252, v252
    v_rcp_f32 v253, v253
    v_pk_mul_f32 v[30:31], v[240:241], v[30:31]
    v_pk_mul_f32 v[238:239], v[242:243], v[238:239]
    v_pk_mul_f32 v[250:251], v[244:245], v[250:251]
    v_pk_mul_f32 v[252:253], v[246:247], v[252:253]
    v_cvt_pk_bf16_f32 v20, v30, v31
    v_cvt_pk_bf16_f32 v21, v238, v239
    v_cvt_pk_bf16_f32 v22, v250, v251
    v_cvt_pk_bf16_f32 v23, v252, v253
    v_accvgpr_read_b32 v240, a19
    v_accvgpr_read_b32 v241, a39
    v_accvgpr_read_b32 v242, a59
    v_accvgpr_read_b32 v243, a79
    v_accvgpr_read_b32 v244, a99
    v_accvgpr_read_b32 v245, a119
    v_accvgpr_read_b32 v246, a139
    v_accvgpr_read_b32 v247, a159
    v_exp_f32 v30, v240
    v_exp_f32 v31, v241
    v_exp_f32 v238, v242
    v_exp_f32 v239, v243
    v_exp_f32 v250, v244
    v_exp_f32 v251, v245
    v_exp_f32 v252, v246
    v_exp_f32 v253, v247
    v_pk_add_f32 v[30:31], v[30:31], 1.0 op_sel_hi:[1,0]
    v_pk_add_f32 v[238:239], v[238:239], 1.0 op_sel_hi:[1,0]
    v_pk_add_f32 v[250:251], v[250:251], 1.0 op_sel_hi:[1,0]
    v_pk_add_f32 v[252:253], v[252:253], 1.0 op_sel_hi:[1,0]
    v_rcp_f32 v30, v30
    v_rcp_f32 v31, v31
    v_rcp_f32 v238, v238
    v_rcp_f32 v239, v239
    v_rcp_f32 v250, v250
    v_rcp_f32 v251, v251
    v_rcp_f32 v252, v252
    v_rcp_f32 v253, v253
    v_pk_mul_f32 v[30:31], v[240:241], v[30:31]
    v_pk_mul_f32 v[238:239], v[242:243], v[238:239]
    v_pk_mul_f32 v[250:251], v[244:245], v[250:251]
    v_pk_mul_f32 v[252:253], v[246:247], v[252:253]
    v_cvt_pk_bf16_f32 v24, v30, v31
    v_cvt_pk_bf16_f32 v25, v238, v239
    v_cvt_pk_bf16_f32 v26, v250, v251
    v_cvt_pk_bf16_f32 v27, v252, v253
    ds_write_b128 v28, v[20:23] offset:4224
    ds_write_b128 v28, v[24:27] offset:4288
    v_accvgpr_read_b32 v240, a160
    v_accvgpr_read_b32 v241, a161
    v_accvgpr_read_b32 v242, a162
    v_accvgpr_read_b32 v243, a163
    v_accvgpr_read_b32 v244, a164
    v_accvgpr_read_b32 v245, a165
    v_accvgpr_read_b32 v246, a166
    v_accvgpr_read_b32 v247, a167
    v_exp_f32 v30, v240
    v_exp_f32 v31, v241
    v_exp_f32 v238, v242
    v_exp_f32 v239, v243
    v_exp_f32 v250, v244
    v_exp_f32 v251, v245
    v_exp_f32 v252, v246
    v_exp_f32 v253, v247
    v_pk_add_f32 v[30:31], v[30:31], 1.0 op_sel_hi:[1,0]
    v_pk_add_f32 v[238:239], v[238:239], 1.0 op_sel_hi:[1,0]
    v_pk_add_f32 v[250:251], v[250:251], 1.0 op_sel_hi:[1,0]
    v_pk_add_f32 v[252:253], v[252:253], 1.0 op_sel_hi:[1,0]
    v_rcp_f32 v30, v30
    v_rcp_f32 v31, v31
    v_rcp_f32 v238, v238
    v_rcp_f32 v239, v239
    v_rcp_f32 v250, v250
    v_rcp_f32 v251, v251
    v_rcp_f32 v252, v252
    v_rcp_f32 v253, v253
    v_pk_mul_f32 v[30:31], v[240:241], v[30:31]
    v_pk_mul_f32 v[238:239], v[242:243], v[238:239]
    v_pk_mul_f32 v[250:251], v[244:245], v[250:251]
    v_pk_mul_f32 v[252:253], v[246:247], v[252:253]
    v_cvt_pk_bf16_f32 v20, v30, v31
    v_cvt_pk_bf16_f32 v21, v238, v239
    v_cvt_pk_bf16_f32 v22, v250, v251
    v_cvt_pk_bf16_f32 v23, v252, v253
    ds_write_b64 v29, v[20:21] offset:0
    ds_write_b64 v29, v[22:23] offset:1024
    v_accvgpr_read_b32 v240, a168
    v_accvgpr_read_b32 v241, a169
    v_accvgpr_read_b32 v242, a170
    v_accvgpr_read_b32 v243, a171
    v_accvgpr_read_b32 v244, a172
    v_accvgpr_read_b32 v245, a173
    v_accvgpr_read_b32 v246, a174
    v_accvgpr_read_b32 v247, a175
    v_exp_f32 v30, v240
    v_exp_f32 v31, v241
    v_exp_f32 v238, v242
    v_exp_f32 v239, v243
    v_exp_f32 v250, v244
    v_exp_f32 v251, v245
    v_exp_f32 v252, v246
    v_exp_f32 v253, v247
    v_pk_add_f32 v[30:31], v[30:31], 1.0 op_sel_hi:[1,0]
    v_pk_add_f32 v[238:239], v[238:239], 1.0 op_sel_hi:[1,0]
    v_pk_add_f32 v[250:251], v[250:251], 1.0 op_sel_hi:[1,0]
    v_pk_add_f32 v[252:253], v[252:253], 1.0 op_sel_hi:[1,0]
    v_rcp_f32 v30, v30
    v_rcp_f32 v31, v31
    v_rcp_f32 v238, v238
    v_rcp_f32 v239, v239
    v_rcp_f32 v250, v250
    v_rcp_f32 v251, v251
    v_rcp_f32 v252, v252
    v_rcp_f32 v253, v253
    v_pk_mul_f32 v[30:31], v[240:241], v[30:31]
    v_pk_mul_f32 v[238:239], v[242:243], v[238:239]
    v_pk_mul_f32 v[250:251], v[244:245], v[250:251]
    v_pk_mul_f32 v[252:253], v[246:247], v[252:253]
    v_cvt_pk_bf16_f32 v24, v30, v31
    v_cvt_pk_bf16_f32 v25, v238, v239
    v_cvt_pk_bf16_f32 v26, v250, v251
    v_cvt_pk_bf16_f32 v27, v252, v253
    ds_write_b64 v29, v[24:25] offset:2048
    ds_write_b64 v29, v[26:27] offset:3072
    v_accvgpr_read_b32 v240, a176
    v_accvgpr_read_b32 v241, a177
    v_accvgpr_read_b32 v242, a178
    v_accvgpr_read_b32 v243, a179
    v_exp_f32 v30, v240
    v_exp_f32 v31, v241
    v_exp_f32 v238, v242
    v_exp_f32 v239, v243
    v_pk_add_f32 v[30:31], v[30:31], 1.0 op_sel_hi:[1,0]
    v_pk_add_f32 v[238:239], v[238:239], 1.0 op_sel_hi:[1,0]
    v_rcp_f32 v30, v30
    v_rcp_f32 v31, v31
    v_rcp_f32 v238, v238
    v_rcp_f32 v239, v239
    v_pk_mul_f32 v[30:31], v[240:241], v[30:31]
    v_pk_mul_f32 v[238:239], v[242:243], v[238:239]
    v_cvt_pk_bf16_f32 v20, v30, v31
    v_cvt_pk_bf16_f32 v21, v238, v239
    ds_write_b64 v29, v[20:21] offset:4096
    s_waitcnt lgkmcnt(0)
    s_barrier
    ds_read_b128 a[180:183], v10 offset:0
    ds_read_b128 a[184:187], v10 offset:1024
    ds_read_b128 a[188:191], v10 offset:2048
    ds_read_b128 a[192:195], v10 offset:3072
    ds_read_b128 a[196:199], v10 offset:4096
    s_waitcnt lgkmcnt(0)
    s_branch L_gemm_zero
L_other:
    s_cmp_ge_u32 s34, 32
    s_cbranch_scc1 L_main_end
    s_cmp_lt_u32 s34, 26
    s_cbranch_scc1 L_ffn4
    s_mul_i32 s33, s33, 6
    s_add_u32 s33, s33, s34
    s_sub_u32 s3, s33, 26
L_conv:
    s_lshl_b32 s33, s3, 15
    v_lshl_add_u32 v218, v0, 7, s33
    s_mul_i32 s33, s3, 3072
    v_lshl_add_u32 v1, v0, 2, s33
    s_mul_i32 s33, s3, 24
    v_lshrrev_b32 v2, 6, v0
    v_lshl_add_u32 v2, v2, 1, s33
    s_waitcnt lgkmcnt(0)
    global_load_dword v200, v1, s[6:7] offset:0
    global_load_dword v201, v1, s[8:9] offset:0
    global_load_dword v202, v1, s[10:11] offset:0
    global_load_dword v203, v1, s[12:13] offset:0
    global_load_ushort v212, v2, s[14:15] offset:0
    global_load_ushort v215, v2, s[16:17] offset:0
    global_load_dword v204, v1, s[6:7] offset:1024
    global_load_dword v205, v1, s[8:9] offset:1024
    global_load_dword v206, v1, s[10:11] offset:1024
    global_load_dword v207, v1, s[12:13] offset:1024
    global_load_ushort v213, v2, s[14:15] offset:8
    global_load_ushort v216, v2, s[16:17] offset:8
    global_load_dword v208, v1, s[6:7] offset:2048
    global_load_dword v209, v1, s[8:9] offset:2048
    global_load_dword v210, v1, s[10:11] offset:2048
    global_load_dword v211, v1, s[12:13] offset:2048
    global_load_ushort v214, v2, s[14:15] offset:16
    global_load_ushort v217, v2, s[16:17] offset:16
    s_lshr_b32 s30, s30, 6
    v_and_b32 v13, 63, v0
    v_and_b32 v14, 15, v0
    v_bfe_u32 v15, v0, 4, 2
    s_getpc_b64 s[94:95]
L_pcC:
    s_add_u32 s94, s94, L_pc0 - L_pcC
    s_addc_u32 s95, s95, -1
    s_lshr_b32 s33, s2, 3
    s_mul_i32 s33, s33, 2560
    v_lshlrev_b32 v1, 7, v0
    v_add_u32 v1, s33, v1
    v_min_u32 v1, L_main_end - L_pc0, v1
    v_cmp_gt_u32 vcc, 20, v0
    s_and_saveexec_b64 s[54:55], vcc
    s_cbranch_execz L_nocwC
    global_load_dword v253, v1, s[94:95]
L_nocwC:
    s_mov_b64 exec, s[54:55]
    global_load_dword v219, v218, s[20:21]
    s_mul_i32 s31, s3, 12
    s_add_u32 s31, s31, s30
    s_mul_i32 s32, s30, 24960
    s_add_u32 s32, s32, 55552
    s_mul_i32 s82, s30, 13856
    s_mov_b32 s44, s28
    s_and_b32 s45, s29, 0xffff
    s_mov_b32 s46, 268435456
    s_mov_b32 s47, 0x20000
    s_mov_b32 s56, s28
    s_and_b32 s57, s29, 0xffff
    s_mov_b32 s58, 2359296
    s_mov_b32 s59, 0x20000
    s_mov_b32 s76, s20
    s_and_b32 s77, s21, 0xffff
    s_mov_b32 s78, 5308416
    s_mov_b32 s79, 0x20000
    s_lshl_b32 s33, s3, 2
    s_add_u32 s33, s33, s30
    s_lshl_b32 s33, s33, 13
    s_mov_b32 s72, s22
    s_and_b32 s73, s23, 0xffff
    s_mov_b32 s74, 5308416
    s_mov_b32 s75, 0x20000
    s_lshr_b32 s33, s33, 13
    s_mul_i32 s34, s33, 2731
    s_lshr_b32 s34, s34, 16
    s_mul_i32 s35, s34, 24
    s_sub_u32 s35, s33, s35
    s_mul_i32 s34, s34, 663552
    s_lshl_b32 s35, s35, 12
    s_add_u32 s34, s34, s35
    s_lshl_b32 s33, s33, 12
    v_lshlrev_b32 v225, 7, v13
    v_mov_b32 v227, 0x40000000
    v_cmp_gt_u32 vcc, 32, v13
    v_add_u32 v226, s34, v225
    v_add_u32 v225, s33, v225
    v_cndmask_b32 v226, v227, v226, vcc
    v_cndmask_b32 v225, v227, v225, vcc
    s_mov_b32 s80, 0
    s_mov_b32 s81, 1572864
    s_mov_b32 s68, 0
    v_mov_b32 v4, 0
    v_mov_b32 v5, 0
    v_lshlrev_b32 v3, 3, v13
    v_add_u32 v3, s82, v3
    ds_write_b64 v3, v[4:5] offset:0
    v_and_b32 v6, 7, v13
    v_lshlrev_b32 v6, 3, v6
    v_add_u32 v6, s32, v6
    ds_write_b64 v6, v[4:5] offset:4096
    ds_write_b64 v6, v[4:5] offset:8256
    ds_write_b64 v6, v[4:5] offset:12416
    ds_write_b64 v6, v[4:5] offset:16576
    ds_write_b64 v6, v[4:5] offset:20736
    ds_write_b64 v6, v[4:5] offset:24896
    s_add_u32 s33, s82, 4608
    s_mov_b32 s83, s33
    v_lshl_add_u32 v1, v13, 3, s33
    v_mul_u32_u24 v2, 544, v14
    v_lshl_add_u32 v2, v15, 4, v2
    v_add_u32 v2, s33, v2
    v_and_b32 v16, 1, v15
    v_lshrrev_b32 v17, 1, v15
    v_lshlrev_b32 v18, 3, v16
    v_lshl_add_u32 v18, v17, 8, v18
    v_lshl_add_u32 v18, v14, 4, v18
    v_sub_u32 v3, 4088, v18
    v_add_u32 v3, s32, v3
    v_lshlrev_b32 v18, 6, v15
    v_lshlrev_b32 v19, 2, v14
    v_lshlrev_b32 v20, 1, v14
    v_cmp_gt_u32 vcc, 2, v15
    v_mov_b32 v21, 32
    s_nop 0
    v_cndmask_b32 v19, v20, v19, vcc
    v_cndmask_b32 v21, v21, 2, vcc
    v_add_u32 v18, v18, v19
    v_lshl_add_u32 v4, v18, 2, s33
    v_lshl_add_u32 v5, v21, 2, v4
    v_lshl_add_u32 v18, v15, 6, v14
    v_lshl_add_u32 v6, v18, 2, s33
    v_lshl_add_u32 v7, v13, 2, s33
    v_lshl_add_u32 v8, v13, 3, s33
    v_lshl_add_u32 v9, v13, 4, s33
    v_lshlrev_b32 v18, 4, v13
    v_sub_u32 v10, s32, v18
    v_add_u32 v10, 1008, v10
    v_add_u32 v11, s32, v18
    v_and_b32 v18, 1, v13
    v_cmp_eq_u32 vcc, 0, v18
    v_mov_b32 v19, 0xffff
    s_nop 0
    v_cndmask_b32 v12, -1, v19, vcc
    v_add_u32 v18, 1024, v7
    s_mov_b32 s36, 0x3fb8aa3b
    s_mov_b32 s37, 0x32a57060
    s_mov_b32 s38, 0x3f317218
    s_mov_b32 s39, 0x3e22f983
    s_mov_b32 s40, 0x0000ffff
    s_mov_b32 s85, 0
    s_mov_b32 s84, 1572864
    v_and_b32 v16, 3, v13
    v_lshrrev_b32 v17, 2, v13
    v_lshl_add_u32 v16, v16, 4, v17
    v_lshlrev_b32 v220, 2, v16
    s_mov_b32 s33, 2731
    v_mul_u32_u24 v16, s33, v0
    v_lshrrev_b32 v16, 16, v16
    v_mul_u32_u24 v17, 24, v16
    v_sub_u32 v17, v0, v17
    v_mul_u32_u24 v19, 18432, v16
    v_lshl_add_u32 v222, v17, 4, v19
    v_bfe_u32 v19, v17, 1, 2
    v_mul_u32_u24 v19, 13856, v19
    v_lshrrev_b32 v20, 3, v17
    v_mul_u32_u24 v20, 4608, v20
    v_and_b32 v17, 1, v17
    v_lshlrev_b32 v17, 4, v17
    v_lshl_add_u32 v17, v16, 5, v17
    v_add3_u32 v17, v17, v19, v20
    v_add_u32 v223, 512, v17
    v_cmp_gt_u32 s[92:93], 8, v16
    v_cmp_gt_u32 s[96:97], 10, v16
    v_mov_b32 v19, 0x40000000
    s_mov_b32 s98, 0x40000000
    v_cndmask_b32 v222, v19, v222, s[96:97]
    s_mov_b32 s34, 0x0f0f0f0f
    s_mov_b32 s35, 0x01010101
    s_mov_b32 s91, 0
    v_lshrrev_b32 v16, 1, v15
    v_and_b32 v17, 1, v15
    v_sub_u32 v21, v14, v16
    v_lshlrev_b32 v21, 5, v21
    v_lshl_add_u32 v21, v17, 4, v21
    v_add_u32 v21, 64, v21
    v_add_u32 v230, s82, v21
    v_lshrrev_b32 v21, 1, v14
    v_lshl_add_u32 v21, v16, 3, v21
    v_lshlrev_b32 v19, 2, v17
    v_sub_u32 v21, v19, v21
    v_add_u32 v21, 895, v21
    v_lshlrev_b32 v21, 2, v21
    v_and_b32 v19, 1, v14
    v_xor_b32 v19, 1, v19
    v_mul_u32_u24 v19, 4160, v19
    v_add3_u32 v231, v21, v19, s32
    v_lshlrev_b32 v21, 5, v14
    v_lshl_add_u32 v21, v15, 3, v21
    v_add_u32 v21, 512, v21
    v_add_u32 v232, s82, v21
    v_bfe_u32 v21, v13, 2, 2
    v_mul_u32_u24 v21, 13856, v21
    v_and_b32 v19, 3, v13
    v_lshl_add_u32 v21, v19, 3, v21
    v_lshl_add_u32 v21, v15, 5, v21
    s_lshl_b32 s33, s30, 10
    s_add_u32 s33, s33, 512
    v_add_u32 v233, s33, v21
    v_mul_u32_u24 v21, 18432, v15
    v_lshl_add_u32 v234, v14, 3, v21
    s_waitcnt vmcnt(1)
    v_lshlrev_b32 v70, 16, v202
    v_and_b32 v71, 0xffff0000, v202
    v_lshlrev_b32 v72, 16, v203
    v_and_b32 v73, 0xffff0000, v203
    v_max3_f32 v70, abs(v70), abs(v71), abs(v72)
    v_max_f32 v70, v70, abs(v73)
    v_lshlrev_b32 v22, 16, v212
    v_mul_f32 v23, s36, v22
    v_fma_f32 v24, v22, s36, -v23
    v_max_f32_dpp v70, v70, v70 quad_perm:[1,0,3,2] row_mask:0xf bank_mask:0xf
    v_fma_f32 v24, v22, s37, v24
    v_exp_f32 v23, v23
    v_max_f32_dpp v70, v70, v70 quad_perm:[2,3,0,1] row_mask:0xf bank_mask:0xf
    v_mul_f32 v24, s38, v24
    v_fma_f32 v23, v23, v24, v23
    v_max_f32_dpp v70, v70, v70 row_half_mirror row_mask:0xf bank_mask:0xf
    v_cvt_pk_bf16_f32 v23, v23, v23
    v_lshlrev_b32 v16, 16, v23
    v_max_f32_dpp v70, v70, v70 row_mirror row_mask:0xf bank_mask:0xf
    s_nop 0
    v_readlane_b32 s41, v70, 0
    v_readlane_b32 s42, v70, 16
    v_readlane_b32 s43, v70, 32
    v_readlane_b32 s33, v70, 48
    v_lshlrev_b32 v22, 16, v200
    v_and_b32 v70, 0xffff0000, v200
    v_mul_f32 v23, s36, v22
    v_mul_f32 v71, s36, v70
    v_fma_f32 v24, v22, s36, -v23
    v_fma_f32 v72, v70, s36, -v71
    v_fma_f32 v24, v22, s37, v24
    v_fma_f32 v72, v70, s37, v72
    v_exp_f32 v23, v23
    v_exp_f32 v71, v71
    v_mul_f32 v24, s38, v24
    v_mul_f32 v72, s38, v72
    v_fma_f32 v23, v23, v24, v23
    v_fma_f32 v71, v71, v72, v71
    v_cvt_pk_bf16_f32 v23, v23, v23
    v_cvt_pk_bf16_f32 v71, v71, v71
    v_lshlrev_b32 v20, 16, v23
    v_lshlrev_b32 v68, 16, v71
    s_max_u32 s41, s41, s42
    s_max_u32 s43, s43, s33
    s_max_u32 s41, s41, s43
    s_lshr_b32 s41, s41, 23
    s_min_u32 s41, s41, 252
    s_sub_u32 s42, 253, s41
    s_lshl_b32 s42, s42, 23
    s_add_u32 s41, s41, 2
    s_lshl_b32 s41, s41, 23
    v_mul_f32 v19, s41, v16
    v_mul_f32 v19, 0xbf317218, v19
    v_lshlrev_b32 v21, 16, v201
    v_and_b32 v69, 0xffff0000, v201
    v_lshlrev_b32 v48, 16, v202
    v_and_b32 v96, 0xffff0000, v202
    v_lshlrev_b32 v49, 16, v203
    v_and_b32 v97, 0xffff0000, v203
    v_mul_f32 v20, v20, v16
    v_mul_f32 v68, v68, v16
    v_mul_f32 v21, v21, v16
    v_mul_f32 v69, v69, v16
    v_mul_f32 v48, s42, v48
    v_mul_f32 v96, s42, v96
    v_mul_f32 v49, s42, v49
    v_mul_f32 v97, s42, v97
    v_mul_f32 v20, s36, v20
    v_mul_f32 v68, s36, v68
    v_mul_f32 v21, s39, v21
    v_mul_f32 v69, s39, v69
    v_sub_f32 v20, 0, v20
    v_sub_f32 v68, 0, v68
    v_mov_b32 v200, v204
    v_mov_b32 v201, v205
    v_mov_b32 v202, v206
    v_mov_b32 v203, v207
    v_mov_b32 v204, v208
    v_mov_b32 v205, v209
    v_mov_b32 v206, v210
    v_mov_b32 v207, v211
    v_mov_b32 v212, v213
    v_mov_b32 v213, v214
    v_mul_f32 v22, 0x41000000, v20
    v_mul_f32 v70, 0x41000000, v68
    v_mul_f32 v23, 0x41000000, v21
    v_mul_f32 v71, 0x41000000, v69
    v_exp_f32 v22, v22
    v_exp_f32 v70, v70
    v_fract_f32 v23, v23
    v_fract_f32 v71, v71
    v_cos_f32 v42, v23
    v_cos_f32 v90, v71
    v_sin_f32 v43, v23
    v_sin_f32 v91, v71
    v_pk_mul_f32 v[42:43], v[42:43], v[22:23] op_sel_hi:[1,0]
    v_pk_mul_f32 v[90:91], v[90:91], v[70:71] op_sel_hi:[1,0]
    v_exp_f32 v24, v20
    v_exp_f32 v72, v68
    v_fract_f32 v25, v21
    v_fract_f32 v73, v69
    v_cos_f32 v28, v25
    v_cos_f32 v76, v73
    v_sin_f32 v29, v25
    v_sin_f32 v77, v73
    v_pk_mul_f32 v[28:29], v[28:29], v[24:25] op_sel_hi:[1,0]
    v_pk_mul_f32 v[76:77], v[76:77], v[72:73] op_sel_hi:[1,0]
    v_mul_f32 v22, 0x43000000, v20
    v_mul_f32 v70, 0x43000000, v68
    v_mul_f32 v23, 0x43000000, v21
    v_mul_f32 v71, 0x43000000, v69
    v_exp_f32 v22, v22
    v_exp_f32 v70, v70
    v_fract_f32 v23, v23
    v_fract_f32 v71, v71
    v_cos_f32 v44, v23
    v_cos_f32 v92, v71
    v_sin_f32 v45, v23
    v_sin_f32 v93, v71
    v_pk_mul_f32 v[44:45], v[44:45], v[22:23] op_sel_hi:[1,0]
    v_pk_mul_f32 v[92:93], v[92:93], v[70:71] op_sel_hi:[1,0]
    v_mul_f32 v24, 0x44800000, v20
    v_mul_f32 v72, 0x44800000, v68
    v_mul_f32 v25, 0x44800000, v21
    v_mul_f32 v73, 0x44800000, v69
    v_exp_f32 v24, v24
    v_exp_f32 v72, v72
    v_fract_f32 v25, v25
    v_fract_f32 v73, v73
    v_cos_f32 v46, v25
    v_cos_f32 v94, v73
    v_sin_f32 v47, v25
    v_sin_f32 v95, v73
    v_pk_mul_f32 v[46:47], v[46:47], v[24:25] op_sel_hi:[1,0]
    v_pk_mul_f32 v[94:95], v[94:95], v[72:73] op_sel_hi:[1,0]
L_kgen:
    v_mov_b32 v17, v19
    s_mov_b32 m0, s83
    s_bitcmp1_b32 236, s80
    s_cselect_b32 s84, s81, 0x40000000
    s_cselect_b32 s69, 786432, 0
    buffer_load_dword v219, v225, s[76:79], s84 offen
    s_add_u32 s81, s81, s69
    s_add_u32 s80, s80, 1
    v_cvt_pk_f16_f32 v116, v48, -v49
    v_cvt_pk_f16_f32 v117, v96, -v97
    v_pk_mul_f32 v[50:51], v[48:49], v[42:43] op_sel_hi:[1,0]
    v_pk_mul_f32 v[98:99], v[96:97], v[90:91] op_sel_hi:[1,0]
    v_pk_fma_f32 v[50:51], v[48:49], v[42:43], v[50:51] op_sel:[1,1,0] op_sel_hi:[0,1,1] neg_lo:[1,0,0]
    v_pk_fma_f32 v[98:99], v[96:97], v[90:91], v[98:99] op_sel:[1,1,0] op_sel_hi:[0,1,1] neg_lo:[1,0,0]
    v_cvt_pk_f16_f32 v118, v50, -v51
    v_cvt_pk_f16_f32 v119, v98, -v99
    v_pk_mul_f32 v[48:49], v[50:51], v[42:43] op_sel_hi:[1,0]
    v_pk_mul_f32 v[96:97], v[98:99], v[90:91] op_sel_hi:[1,0]
    v_pk_fma_f32 v[48:49], v[50:51], v[42:43], v[48:49] op_sel:[1,1,0] op_sel_hi:[0,1,1] neg_lo:[1,0,0]
    v_pk_fma_f32 v[96:97], v[98:99], v[90:91], v[96:97] op_sel:[1,1,0] op_sel_hi:[0,1,1] neg_lo:[1,0,0]
    v_pk_mul_f32 v[30:31], v[28:29], v[28:29] op_sel_hi:[1,0]
    v_pk_mul_f32 v[78:79], v[76:77], v[76:77] op_sel_hi:[1,0]
    v_pk_fma_f32 v[30:31], v[28:29], v[28:29], v[30:31] op_sel:[1,1,0] op_sel_hi:[0,1,1] neg_lo:[1,0,0]
    v_pk_fma_f32 v[78:79], v[76:77], v[76:77], v[78:79] op_sel:[1,1,0] op_sel_hi:[0,1,1] neg_lo:[1,0,0]
    v_cvt_pk_f16_f32 v120, v48, -v49
    v_cvt_pk_f16_f32 v121, v96, -v97
    ds_write_addtid_b32 v116 offset:0
    ds_write_addtid_b32 v117 offset:256
    ds_write_addtid_b32 v118 offset:544
    ds_write_addtid_b32 v119 offset:800
    ds_write_addtid_b32 v120 offset:1088
    ds_write_addtid_b32 v121 offset:1344
    v_pk_mul_f32 v[50:51], v[48:49], v[42:43] op_sel_hi:[1,0]
    v_pk_mul_f32 v[98:99], v[96:97], v[90:91] op_sel_hi:[1,0]
    v_pk_fma_f32 v[50:51], v[48:49], v[42:43], v[50:51] op_sel:[1,1,0] op_sel_hi:[0,1,1] neg_lo:[1,0,0]
    v_pk_fma_f32 v[98:99], v[96:97], v[90:91], v[98:99] op_sel:[1,1,0] op_sel_hi:[0,1,1] neg_lo:[1,0,0]
    v_pk_mul_f32 v[32:33], v[28:29], v[30:31] op_sel_hi:[1,0]
    v_pk_mul_f32 v[80:81], v[76:77], v[78:79] op_sel_hi:[1,0]
    v_pk_fma_f32 v[32:33], v[28:29], v[30:31], v[32:33] op_sel:[1,1,0] op_sel_hi:[0,1,1] neg_lo:[1,0,0]
    v_pk_fma_f32 v[80:81], v[76:77], v[78:79], v[80:81] op_sel:[1,1,0] op_sel_hi:[0,1,1] neg_lo:[1,0,0]
    v_cvt_pk_f16_f32 v122, v50, -v51
    v_cvt_pk_f16_f32 v123, v98, -v99
    v_pk_mul_f32 v[48:49], v[50:51], v[42:43] op_sel_hi:[1,0]
    v_pk_mul_f32 v[96:97], v[98:99], v[90:91] op_sel_hi:[1,0]
    v_pk_fma_f32 v[48:49], v[50:51], v[42:43], v[48:49] op_sel:[1,1,0] op_sel_hi:[0,1,1] neg_lo:[1,0,0]
    v_pk_fma_f32 v[96:97], v[98:99], v[90:91], v[96:97] op_sel:[1,1,0] op_sel_hi:[0,1,1] neg_lo:[1,0,0]
    v_pk_mul_f32 v[34:35], v[30:31], v[30:31] op_sel_hi:[1,0]
    v_pk_mul_f32 v[82:83], v[78:79], v[78:79] op_sel_hi:[1,0]
    v_pk_fma_f32 v[34:35], v[30:31], v[30:31], v[34:35] op_sel:[1,1,0] op_sel_hi:[0,1,1] neg_lo:[1,0,0]
    v_pk_fma_f32 v[82:83], v[78:79], v[78:79], v[82:83] op_sel:[1,1,0] op_sel_hi:[0,1,1] neg_lo:[1,0,0]
    v_cvt_pk_f16_f32 v116, v48, -v49
    v_cvt_pk_f16_f32 v117, v96, -v97
    v_pk_mul_f32 v[50:51], v[48:49], v[42:43] op_sel_hi:[1,0]
    v_pk_mul_f32 v[98:99], v[96:97], v[90:91] op_sel_hi:[1,0]
    v_pk_fma_f32 v[50:51], v[48:49], v[42:43], v[50:51] op_sel:[1,1,0] op_sel_hi:[0,1,1] neg_lo:[1,0,0]
    v_pk_fma_f32 v[98:99], v[96:97], v[90:91], v[98:99] op_sel:[1,1,0] op_sel_hi:[0,1,1] neg_lo:[1,0,0]
    v_pk_mul_f32 v[36:37], v[30:31], v[32:33] op_sel_hi:[1,0]
    v_pk_mul_f32 v[84:85], v[78:79], v[80:81] op_sel_hi:[1,0]
    v_pk_fma_f32 v[36:37], v[30:31], v[32:33], v[36:37] op_sel:[1,1,0] op_sel_hi:[0,1,1] neg_lo:[1,0,0]
    v_pk_fma_f32 v[84:85], v[78:79], v[80:81], v[84:85] op_sel:[1,1,0] op_sel_hi:[0,1,1] neg_lo:[1,0,0]
    v_cvt_pk_f16_f32 v118, v50, -v51
    v_cvt_pk_f16_f32 v119, v98, -v99
    ds_write_addtid_b32 v122 offset:1632
    ds_write_addtid_b32 v123 offset:1888
    ds_write_addtid_b32 v116 offset:2176
    ds_write_addtid_b32 v117 offset:2432
    ds_write_addtid_b32 v118 offset:2720
    ds_write_addtid_b32 v119 offset:2976
    v_pk_mul_f32 v[48:49], v[50:51], v[42:43] op_sel_hi:[1,0]
    v_pk_mul_f32 v[96:97], v[98:99], v[90:91] op_sel_hi:[1,0]
    v_pk_fma_f32 v[48:49], v[50:51], v[42:43], v[48:49] op_sel:[1,1,0] op_sel_hi:[0,1,1] neg_lo:[1,0,0]
    v_pk_fma_f32 v[96:97], v[98:99], v[90:91], v[96:97] op_sel:[1,1,0] op_sel_hi:[0,1,1] neg_lo:[1,0,0]
    v_pk_mul_f32 v[38:39], v[32:33], v[32:33] op_sel_hi:[1,0]
    v_pk_mul_f32 v[86:87], v[80:81], v[80:81] op_sel_hi:[1,0]
    v_pk_fma_f32 v[38:39], v[32:33], v[32:33], v[38:39] op_sel:[1,1,0] op_sel_hi:[0,1,1] neg_lo:[1,0,0]
    v_pk_fma_f32 v[86:87], v[80:81], v[80:81], v[86:87] op_sel:[1,1,0] op_sel_hi:[0,1,1] neg_lo:[1,0,0]
    v_cvt_pk_f16_f32 v120, v48, -v49
    v_cvt_pk_f16_f32 v121, v96, -v97
    v_pk_mul_f32 v[50:51], v[48:49], v[42:43] op_sel_hi:[1,0]
    v_pk_mul_f32 v[98:99], v[96:97], v[90:91] op_sel_hi:[1,0]
    v_pk_fma_f32 v[50:51], v[48:49], v[42:43], v[50:51] op_sel:[1,1,0] op_sel_hi:[0,1,1] neg_lo:[1,0,0]
    v_pk_fma_f32 v[98:99], v[96:97], v[90:91], v[98:99] op_sel:[1,1,0] op_sel_hi:[0,1,1] neg_lo:[1,0,0]
    v_pk_mul_f32 v[40:41], v[32:33], v[34:35] op_sel_hi:[1,0]
    v_pk_mul_f32 v[88:89], v[80:81], v[82:83] op_sel_hi:[1,0]
    v_pk_fma_f32 v[40:41], v[32:33], v[34:35], v[40:41] op_sel:[1,1,0] op_sel_hi:[0,1,1] neg_lo:[1,0,0]
    v_pk_fma_f32 v[88:89], v[80:81], v[82:83], v[88:89] op_sel:[1,1,0] op_sel_hi:[0,1,1] neg_lo:[1,0,0]
    v_cvt_pk_f16_f32 v122, v50, -v51
    v_cvt_pk_f16_f32 v123, v98, -v99
    v_pk_mul_f32 v[48:49], v[50:51], v[42:43] op_sel_hi:[1,0]
    v_pk_mul_f32 v[96:97], v[98:99], v[90:91] op_sel_hi:[1,0]
    v_pk_fma_f32 v[48:49], v[50:51], v[42:43], v[48:49] op_sel:[1,1,0] op_sel_hi:[0,1,1] neg_lo:[1,0,0]
    v_pk_fma_f32 v[96:97], v[98:99], v[90:91], v[96:97] op_sel:[1,1,0] op_sel_hi:[0,1,1] neg_lo:[1,0,0]
    v_cvt_pk_f16_f32 v116, v48, -v49
    v_cvt_pk_f16_f32 v117, v96, -v97
    ds_write_addtid_b32 v120 offset:3264
    ds_write_addtid_b32 v121 offset:3520
    ds_write_addtid_b32 v122 offset:3808
    ds_write_addtid_b32 v123 offset:4064
    ds_write_addtid_b32 v116 offset:4352
    ds_write_addtid_b32 v117 offset:4608
    v_pk_mul_f32 v[50:51], v[48:49], v[42:43] op_sel_hi:[1,0]
    v_pk_mul_f32 v[98:99], v[96:97], v[90:91] op_sel_hi:[1,0]
    v_pk_fma_f32 v[50:51], v[48:49], v[42:43], v[50:51] op_sel:[1,1,0] op_sel_hi:[0,1,1] neg_lo:[1,0,0]
    v_pk_fma_f32 v[98:99], v[96:97], v[90:91], v[98:99] op_sel:[1,1,0] op_sel_hi:[0,1,1] neg_lo:[1,0,0]
    v_cvt_pk_f16_f32 v118, v50, -v51
    v_cvt_pk_f16_f32 v119, v98, -v99
    v_pk_mul_f32 v[48:49], v[50:51], v[42:43] op_sel_hi:[1,0]
    v_pk_mul_f32 v[96:97], v[98:99], v[90:91] op_sel_hi:[1,0]
    v_pk_fma_f32 v[48:49], v[50:51], v[42:43], v[48:49] op_sel:[1,1,0] op_sel_hi:[0,1,1] neg_lo:[1,0,0]
    v_pk_fma_f32 v[96:97], v[98:99], v[90:91], v[96:97] op_sel:[1,1,0] op_sel_hi:[0,1,1] neg_lo:[1,0,0]
    v_cvt_pk_f16_f32 v120, v48, -v49
    v_cvt_pk_f16_f32 v121, v96, -v97
    v_pk_mul_f32 v[50:51], v[48:49], v[42:43] op_sel_hi:[1,0]
    v_pk_mul_f32 v[98:99], v[96:97], v[90:91] op_sel_hi:[1,0]
    v_pk_fma_f32 v[50:51], v[48:49], v[42:43], v[50:51] op_sel:[1,1,0] op_sel_hi:[0,1,1] neg_lo:[1,0,0]
    v_pk_fma_f32 v[98:99], v[96:97], v[90:91], v[98:99] op_sel:[1,1,0] op_sel_hi:[0,1,1] neg_lo:[1,0,0]
    v_cvt_pk_f16_f32 v122, v50, -v51
    v_cvt_pk_f16_f32 v123, v98, -v99
    ds_write_addtid_b32 v118 offset:4896
    ds_write_addtid_b32 v119 offset:5152
    ds_write_addtid_b32 v120 offset:5440
    ds_write_addtid_b32 v121 offset:5696
    ds_write_addtid_b32 v122 offset:5984
    ds_write_addtid_b32 v123 offset:6240
    v_pk_mul_f32 v[48:49], v[50:51], v[42:43] op_sel_hi:[1,0]
    v_pk_mul_f32 v[96:97], v[98:99], v[90:91] op_sel_hi:[1,0]
    v_pk_fma_f32 v[48:49], v[50:51], v[42:43], v[48:49] op_sel:[1,1,0] op_sel_hi:[0,1,1] neg_lo:[1,0,0]
    v_pk_fma_f32 v[96:97], v[98:99], v[90:91], v[96:97] op_sel:[1,1,0] op_sel_hi:[0,1,1] neg_lo:[1,0,0]
    v_cvt_pk_f16_f32 v116, v48, -v49
    v_cvt_pk_f16_f32 v117, v96, -v97
    v_pk_mul_f32 v[50:51], v[48:49], v[42:43] op_sel_hi:[1,0]
    v_pk_mul_f32 v[98:99], v[96:97], v[90:91] op_sel_hi:[1,0]
    v_pk_fma_f32 v[50:51], v[48:49], v[42:43], v[50:51] op_sel:[1,1,0] op_sel_hi:[0,1,1] neg_lo:[1,0,0]
    v_pk_fma_f32 v[98:99], v[96:97], v[90:91], v[98:99] op_sel:[1,1,0] op_sel_hi:[0,1,1] neg_lo:[1,0,0]
    v_cvt_pk_f16_f32 v118, v50, -v51
    v_cvt_pk_f16_f32 v119, v98, -v99
    v_pk_mul_f32 v[48:49], v[50:51], v[42:43] op_sel_hi:[1,0]
    v_pk_mul_f32 v[96:97], v[98:99], v[90:91] op_sel_hi:[1,0]
    v_pk_fma_f32 v[48:49], v[50:51], v[42:43], v[48:49] op_sel:[1,1,0] op_sel_hi:[0,1,1] neg_lo:[1,0,0]
    v_pk_fma_f32 v[96:97], v[98:99], v[90:91], v[96:97] op_sel:[1,1,0] op_sel_hi:[0,1,1] neg_lo:[1,0,0]
    v_cvt_pk_f16_f32 v120, v48, -v49
    v_cvt_pk_f16_f32 v121, v96, -v97
    ds_write_addtid_b32 v116 offset:6528
    ds_write_addtid_b32 v117 offset:6784
    ds_write_addtid_b32 v118 offset:7072
    ds_write_addtid_b32 v119 offset:7328
    ds_write_addtid_b32 v120 offset:7616
    ds_write_addtid_b32 v121 offset:7872
    v_pk_mul_f32 v[50:51], v[48:49], v[42:43] op_sel_hi:[1,0]
    v_pk_mul_f32 v[98:99], v[96:97], v[90:91] op_sel_hi:[1,0]
    v_pk_fma_f32 v[50:51], v[48:49], v[42:43], v[50:51] op_sel:[1,1,0] op_sel_hi:[0,1,1] neg_lo:[1,0,0]
    v_pk_fma_f32 v[98:99], v[96:97], v[90:91], v[98:99] op_sel:[1,1,0] op_sel_hi:[0,1,1] neg_lo:[1,0,0]
    v_cvt_pk_f16_f32 v122, v50, -v51
    v_cvt_pk_f16_f32 v123, v98, -v99
    ds_write_addtid_b32 v122 offset:8160
    ds_write_addtid_b32 v123 offset:8416
    ds_read_b128 v[124:127], v2 offset:0
    ds_read_b128 v[128:131], v2 offset:64
    ds_read_b128 v[132:135], v2 offset:128
    ds_read_b128 v[136:139], v2 offset:192
    ds_read_b128 v[140:143], v2 offset:256
    ds_read_b128 v[144:147], v2 offset:320
    ds_read_b128 v[148:151], v2 offset:384
    ds_read_b128 v[152:155], v2 offset:448
    v_mov_b32 v116, 0x3c00
    v_mov_b32 v117, 0x3c00
    v_cvt_pk_f16_f32 v118, v28, v29
    v_cvt_pk_f16_f32 v119, v76, v77
    v_cvt_pk_f16_f32 v120, v30, v31
    v_cvt_pk_f16_f32 v121, v78, v79
    ds_write_addtid_b32 v116
    ds_write_addtid_b32 v117 offset:256
    ds_write_addtid_b32 v118 offset:544
    ds_write_addtid_b32 v119 offset:800
    ds_write_addtid_b32 v120 offset:1088
    ds_write_addtid_b32 v121 offset:1344
    v_cvt_pk_f16_f32 v122, v32, v33
    v_cvt_pk_f16_f32 v123, v80, v81
    v_cvt_pk_f16_f32 v116, v34, v35
    v_cvt_pk_f16_f32 v117, v82, v83
    v_cvt_pk_f16_f32 v118, v36, v37
    v_cvt_pk_f16_f32 v119, v84, v85
    ds_write_addtid_b32 v122 offset:1632
    ds_write_addtid_b32 v123 offset:1888
    ds_write_addtid_b32 v116 offset:2176
    ds_write_addtid_b32 v117 offset:2432
    ds_write_addtid_b32 v118 offset:2720
    ds_write_addtid_b32 v119 offset:2976
    v_cvt_pk_f16_f32 v120, v38, v39
    v_cvt_pk_f16_f32 v121, v86, v87
    v_cvt_pk_f16_f32 v122, v40, v41
    v_cvt_pk_f16_f32 v123, v88, v89
    v_cvt_pk_f16_f32 v116, v44, v45
    v_cvt_pk_f16_f32 v117, v92, v93
    ds_write_addtid_b32 v120 offset:3264
    ds_write_addtid_b32 v121 offset:3520
    ds_write_addtid_b32 v122 offset:3808
    ds_write_addtid_b32 v123 offset:4064
    ds_write_addtid_b32 v116 offset:4352
    ds_write_addtid_b32 v117 offset:4608
    v_pk_mul_f32 v[48:49], v[28:29], v[44:45] op_sel_hi:[1,0]
    v_pk_mul_f32 v[96:97], v[76:77], v[92:93] op_sel_hi:[1,0]
    v_pk_fma_f32 v[48:49], v[28:29], v[44:45], v[48:49] op_sel:[1,1,0] op_sel_hi:[0,1,1] neg_lo:[1,0,0]
    v_pk_fma_f32 v[96:97], v[76:77], v[92:93], v[96:97] op_sel:[1,1,0] op_sel_hi:[0,1,1] neg_lo:[1,0,0]
    v_cvt_pk_f16_f32 v118, v48, v49
    v_cvt_pk_f16_f32 v119, v96, v97
    v_pk_mul_f32 v[50:51], v[30:31], v[44:45] op_sel_hi:[1,0]
    v_pk_mul_f32 v[98:99], v[78:79], v[92:93] op_sel_hi:[1,0]
    v_pk_fma_f32 v[50:51], v[30:31], v[44:45], v[50:51] op_sel:[1,1,0] op_sel_hi:[0,1,1] neg_lo:[1,0,0]
    v_pk_fma_f32 v[98:99], v[78:79], v[92:93], v[98:99] op_sel:[1,1,0] op_sel_hi:[0,1,1] neg_lo:[1,0,0]
    v_cvt_pk_f16_f32 v120, v50, v51
    v_cvt_pk_f16_f32 v121, v98, v99
    v_pk_mul_f32 v[48:49], v[32:33], v[44:45] op_sel_hi:[1,0]
    v_pk_mul_f32 v[96:97], v[80:81], v[92:93] op_sel_hi:[1,0]
    v_pk_fma_f32 v[48:49], v[32:33], v[44:45], v[48:49] op_sel:[1,1,0] op_sel_hi:[0,1,1] neg_lo:[1,0,0]
    v_pk_fma_f32 v[96:97], v[80:81], v[92:93], v[96:97] op_sel:[1,1,0] op_sel_hi:[0,1,1] neg_lo:[1,0,0]
    v_cvt_pk_f16_f32 v122, v48, v49
    v_cvt_pk_f16_f32 v123, v96, v97
    ds_write_addtid_b32 v118 offset:4896
    ds_write_addtid_b32 v119 offset:5152
    ds_write_addtid_b32 v120 offset:5440
    ds_write_addtid_b32 v121 offset:5696
    ds_write_addtid_b32 v122 offset:5984
    ds_write_addtid_b32 v123 offset:6240
    v_pk_mul_f32 v[50:51], v[34:35], v[44:45] op_sel_hi:[1,0]
    v_pk_mul_f32 v[98:99], v[82:83], v[92:93] op_sel_hi:[1,0]
    v_pk_fma_f32 v[50:51], v[34:35], v[44:45], v[50:51] op_sel:[1,1,0] op_sel_hi:[0,1,1] neg_lo:[1,0,0]
    v_pk_fma_f32 v[98:99], v[82:83], v[92:93], v[98:99] op_sel:[1,1,0] op_sel_hi:[0,1,1] neg_lo:[1,0,0]
    v_cvt_pk_f16_f32 v116, v50, v51
    v_cvt_pk_f16_f32 v117, v98, v99
    v_pk_mul_f32 v[48:49], v[36:37], v[44:45] op_sel_hi:[1,0]
    v_pk_mul_f32 v[96:97], v[84:85], v[92:93] op_sel_hi:[1,0]
    v_pk_fma_f32 v[48:49], v[36:37], v[44:45], v[48:49] op_sel:[1,1,0] op_sel_hi:[0,1,1] neg_lo:[1,0,0]
    v_pk_fma_f32 v[96:97], v[84:85], v[92:93], v[96:97] op_sel:[1,1,0] op_sel_hi:[0,1,1] neg_lo:[1,0,0]
    v_cvt_pk_f16_f32 v118, v48, v49
    v_cvt_pk_f16_f32 v119, v96, v97
    v_pk_mul_f32 v[50:51], v[38:39], v[44:45] op_sel_hi:[1,0]
    v_pk_mul_f32 v[98:99], v[86:87], v[92:93] op_sel_hi:[1,0]
    v_pk_fma_f32 v[50:51], v[38:39], v[44:45], v[50:51] op_sel:[1,1,0] op_sel_hi:[0,1,1] neg_lo:[1,0,0]
    v_pk_fma_f32 v[98:99], v[86:87], v[92:93], v[98:99] op_sel:[1,1,0] op_sel_hi:[0,1,1] neg_lo:[1,0,0]
    v_cvt_pk_f16_f32 v120, v50, v51
    v_cvt_pk_f16_f32 v121, v98, v99
    ds_write_addtid_b32 v116 offset:6528
    ds_write_addtid_b32 v117 offset:6784
    ds_write_addtid_b32 v118 offset:7072
    ds_write_addtid_b32 v119 offset:7328
    ds_write_addtid_b32 v120 offset:7616
    ds_write_addtid_b32 v121 offset:7872
    v_pk_mul_f32 v[48:49], v[40:41], v[44:45] op_sel_hi:[1,0]
    v_pk_mul_f32 v[96:97], v[88:89], v[92:93] op_sel_hi:[1,0]
    v_pk_fma_f32 v[48:49], v[40:41], v[44:45], v[48:49] op_sel:[1,1,0] op_sel_hi:[0,1,1] neg_lo:[1,0,0]
    v_pk_fma_f32 v[96:97], v[88:89], v[92:93], v[96:97] op_sel:[1,1,0] op_sel_hi:[0,1,1] neg_lo:[1,0,0]
    v_cvt_pk_f16_f32 v122, v48, v49
    v_cvt_pk_f16_f32 v123, v96, v97
    ds_write_addtid_b32 v122 offset:8160
    ds_write_addtid_b32 v123 offset:8416
    ds_read_b128 v[156:159], v2 offset:0
    ds_read_b128 v[160:163], v2 offset:64
    ds_read_b128 v[164:167], v2 offset:128
    ds_read_b128 v[168:171], v2 offset:192
    ds_read_b128 v[172:175], v2 offset:256
    ds_read_b128 v[176:179], v2 offset:320
    ds_read_b128 v[180:183], v2 offset:384
    ds_read_b128 v[184:187], v2 offset:448
    s_bitcmp1_b32 236, s80
    s_cselect_b32 s84, s81, 0x40000000
    s_cselect_b32 s69, 786432, 0
    buffer_load_dword v219, v225, s[76:79], s84 offen
    s_add_u32 s81, s81, s69
    s_add_u32 s80, s80, 1
    v_pk_mul_f32 v[52:53], v[44:45], v[44:45] op_sel_hi:[1,0]
    v_pk_mul_f32 v[100:101], v[92:93], v[92:93] op_sel_hi:[1,0]
    v_pk_fma_f32 v[52:53], v[44:45], v[44:45], v[52:53] op_sel:[1,1,0] op_sel_hi:[0,1,1] neg_lo:[1,0,0]
    v_pk_fma_f32 v[100:101], v[92:93], v[92:93], v[100:101] op_sel:[1,1,0] op_sel_hi:[0,1,1] neg_lo:[1,0,0]
    v_pk_mul_f32 v[54:55], v[52:53], v[44:45] op_sel_hi:[1,0]
    v_pk_mul_f32 v[102:103], v[100:101], v[92:93] op_sel_hi:[1,0]
    v_pk_fma_f32 v[54:55], v[52:53], v[44:45], v[54:55] op_sel:[1,1,0] op_sel_hi:[0,1,1] neg_lo:[1,0,0]
    v_pk_fma_f32 v[102:103], v[100:101], v[92:93], v[102:103] op_sel:[1,1,0] op_sel_hi:[0,1,1] neg_lo:[1,0,0]
    v_cvt_pk_f16_f32 v116, v52, v53
    v_cvt_pk_f16_f32 v117, v100, v101
    v_cvt_pk_f16_f32 v118, v54, v55
    v_cvt_pk_f16_f32 v119, v102, v103
    v_pk_mul_f32 v[48:49], v[30:31], v[52:53] op_sel_hi:[1,0]
    v_pk_mul_f32 v[96:97], v[78:79], v[100:101] op_sel_hi:[1,0]
    v_pk_fma_f32 v[48:49], v[30:31], v[52:53], v[48:49] op_sel:[1,1,0] op_sel_hi:[0,1,1] neg_lo:[1,0,0]
    v_pk_fma_f32 v[96:97], v[78:79], v[100:101], v[96:97] op_sel:[1,1,0] op_sel_hi:[0,1,1] neg_lo:[1,0,0]
    v_pk_mul_f32 v[50:51], v[30:31], v[54:55] op_sel_hi:[1,0]
    v_pk_mul_f32 v[98:99], v[78:79], v[102:103] op_sel_hi:[1,0]
    v_pk_fma_f32 v[50:51], v[30:31], v[54:55], v[50:51] op_sel:[1,1,0] op_sel_hi:[0,1,1] neg_lo:[1,0,0]
    v_pk_fma_f32 v[98:99], v[78:79], v[102:103], v[98:99] op_sel:[1,1,0] op_sel_hi:[0,1,1] neg_lo:[1,0,0]
    v_cvt_pk_f16_f32 v120, v48, v49
    v_cvt_pk_f16_f32 v121, v96, v97
    ds_write_addtid_b32 v116 offset:0
    ds_write_addtid_b32 v117 offset:256
    ds_write_addtid_b32 v118 offset:2176
    ds_write_addtid_b32 v119 offset:2432
    ds_write_addtid_b32 v120 offset:544
    ds_write_addtid_b32 v121 offset:800
    v_cvt_pk_f16_f32 v122, v50, v51
    v_cvt_pk_f16_f32 v123, v98, v99
    v_pk_mul_f32 v[48:49], v[34:35], v[52:53] op_sel_hi:[1,0]
    v_pk_mul_f32 v[96:97], v[82:83], v[100:101] op_sel_hi:[1,0]
    v_pk_fma_f32 v[48:49], v[34:35], v[52:53], v[48:49] op_sel:[1,1,0] op_sel_hi:[0,1,1] neg_lo:[1,0,0]
    v_pk_fma_f32 v[96:97], v[82:83], v[100:101], v[96:97] op_sel:[1,1,0] op_sel_hi:[0,1,1] neg_lo:[1,0,0]
    v_pk_mul_f32 v[50:51], v[34:35], v[54:55] op_sel_hi:[1,0]
    v_pk_mul_f32 v[98:99], v[82:83], v[102:103] op_sel_hi:[1,0]
    v_pk_fma_f32 v[50:51], v[34:35], v[54:55], v[50:51] op_sel:[1,1,0] op_sel_hi:[0,1,1] neg_lo:[1,0,0]
    v_pk_fma_f32 v[98:99], v[82:83], v[102:103], v[98:99] op_sel:[1,1,0] op_sel_hi:[0,1,1] neg_lo:[1,0,0]
    v_cvt_pk_f16_f32 v116, v48, v49
    v_cvt_pk_f16_f32 v117, v96, v97
    v_cvt_pk_f16_f32 v118, v50, v51
    v_cvt_pk_f16_f32 v119, v98, v99
    ds_write_addtid_b32 v122 offset:2720
    ds_write_addtid_b32 v123 offset:2976
    ds_write_addtid_b32 v116 offset:1088
    ds_write_addtid_b32 v117 offset:1344
    ds_write_addtid_b32 v118 offset:3264
    ds_write_addtid_b32 v119 offset:3520
    v_pk_mul_f32 v[48:49], v[38:39], v[52:53] op_sel_hi:[1,0]
    v_pk_mul_f32 v[96:97], v[86:87], v[100:101] op_sel_hi:[1,0]
    v_pk_fma_f32 v[48:49], v[38:39], v[52:53], v[48:49] op_sel:[1,1,0] op_sel_hi:[0,1,1] neg_lo:[1,0,0]
    v_pk_fma_f32 v[96:97], v[86:87], v[100:101], v[96:97] op_sel:[1,1,0] op_sel_hi:[0,1,1] neg_lo:[1,0,0]
    v_pk_mul_f32 v[50:51], v[38:39], v[54:55] op_sel_hi:[1,0]
    v_pk_mul_f32 v[98:99], v[86:87], v[102:103] op_sel_hi:[1,0]
    v_pk_fma_f32 v[50:51], v[38:39], v[54:55], v[50:51] op_sel:[1,1,0] op_sel_hi:[0,1,1] neg_lo:[1,0,0]
    v_pk_fma_f32 v[98:99], v[86:87], v[102:103], v[98:99] op_sel:[1,1,0] op_sel_hi:[0,1,1] neg_lo:[1,0,0]
    v_cvt_pk_f16_f32 v120, v48, v49
    v_cvt_pk_f16_f32 v121, v96, v97
    v_cvt_pk_f16_f32 v122, v50, v51
    v_cvt_pk_f16_f32 v123, v98, v99
    v_pk_mul_f32 v[54:55], v[52:53], v[52:53] op_sel_hi:[1,0]
    v_pk_mul_f32 v[102:103], v[100:101], v[100:101] op_sel_hi:[1,0]
    v_pk_fma_f32 v[54:55], v[52:53], v[52:53], v[54:55] op_sel:[1,1,0] op_sel_hi:[0,1,1] neg_lo:[1,0,0]
    v_pk_fma_f32 v[102:103], v[100:101], v[100:101], v[102:103] op_sel:[1,1,0] op_sel_hi:[0,1,1] neg_lo:[1,0,0]
    ds_write_addtid_b32 v120 offset:1632
    ds_write_addtid_b32 v121 offset:1888
    ds_write_addtid_b32 v122 offset:3808
    ds_write_addtid_b32 v123 offset:4064
    s_waitcnt lgkmcnt(15)
    v_mfma_f32_16x16x32_f16 v[188:191], v[156:159], v[124:127], 0
    v_pk_mul_f32 v[48:49], v[34:35], v[54:55] op_sel_hi:[1,0]
    v_pk_mul_f32 v[96:97], v[82:83], v[102:103] op_sel_hi:[1,0]
    v_pk_fma_f32 v[48:49], v[34:35], v[54:55], v[48:49] op_sel:[1,1,0] op_sel_hi:[0,1,1] neg_lo:[1,0,0]
    v_mfma_f32_16x16x32_f16 v[188:191], v[160:163], v[128:131], v[188:191]
    v_pk_fma_f32 v[96:97], v[82:83], v[102:103], v[96:97] op_sel:[1,1,0] op_sel_hi:[0,1,1] neg_lo:[1,0,0]
    v_cvt_pk_f16_f32 v116, v54, v55
    v_cvt_pk_f16_f32 v117, v102, v103
    v_mfma_f32_16x16x32_f16 v[188:191], v[164:167], v[132:135], v[188:191]
    v_pk_mul_f32 v[52:53], v[54:55], v[44:45] op_sel_hi:[1,0]
    v_mfma_f32_16x16x32_f16 v[188:191], v[168:171], v[136:139], v[188:191]
    v_pk_mul_f32 v[100:101], v[102:103], v[92:93] op_sel_hi:[1,0]
    v_pk_fma_f32 v[52:53], v[54:55], v[44:45], v[52:53] op_sel:[1,1,0] op_sel_hi:[0,1,1] neg_lo:[1,0,0]
    v_pk_fma_f32 v[100:101], v[102:103], v[92:93], v[100:101] op_sel:[1,1,0] op_sel_hi:[0,1,1] neg_lo:[1,0,0]
    v_mfma_f32_16x16x32_f16 v[188:191], v[172:175], v[140:143], v[188:191]
    v_cvt_pk_f16_f32 v118, v48, v49
    v_cvt_pk_f16_f32 v119, v96, v97
    v_mfma_f32_16x16x32_f16 v[188:191], v[176:179], v[144:147], v[188:191]
    v_pk_mul_f32 v[48:49], v[34:35], v[52:53] op_sel_hi:[1,0]
    v_pk_mul_f32 v[96:97], v[82:83], v[100:101] op_sel_hi:[1,0]
    v_mfma_f32_16x16x32_f16 v[188:191], v[180:183], v[148:151], v[188:191]
    v_pk_fma_f32 v[48:49], v[34:35], v[52:53], v[48:49] op_sel:[1,1,0] op_sel_hi:[0,1,1] neg_lo:[1,0,0]
    v_pk_fma_f32 v[96:97], v[82:83], v[100:101], v[96:97] op_sel:[1,1,0] op_sel_hi:[0,1,1] neg_lo:[1,0,0]
    v_cvt_pk_f16_f32 v120, v52, v53
    v_mfma_f32_16x16x32_f16 v[188:191], v[184:187], v[152:155], v[188:191]
    v_cvt_pk_f16_f32 v121, v100, v101
    ds_write_addtid_b32 v116 offset:4352
    ds_write_addtid_b32 v117 offset:4608
    ds_write_addtid_b32 v118 offset:4896
    ds_write_addtid_b32 v119 offset:5152
    ds_write_addtid_b32 v120 offset:5440
    ds_write_addtid_b32 v121 offset:5696
    v_pk_mul_f32 v[54:55], v[52:53], v[44:45] op_sel_hi:[1,0]
    v_pk_mul_f32 v[102:103], v[100:101], v[92:93] op_sel_hi:[1,0]
    v_pk_fma_f32 v[54:55], v[52:53], v[44:45], v[54:55] op_sel:[1,1,0] op_sel_hi:[0,1,1] neg_lo:[1,0,0]
    v_pk_fma_f32 v[102:103], v[100:101], v[92:93], v[102:103] op_sel:[1,1,0] op_sel_hi:[0,1,1] neg_lo:[1,0,0]
    v_cvt_pk_f16_f32 v122, v48, v49
    v_cvt_pk_f16_f32 v123, v96, v97
    v_pk_mul_f32 v[48:49], v[34:35], v[54:55] op_sel_hi:[1,0]
    v_pk_mul_f32 v[96:97], v[82:83], v[102:103] op_sel_hi:[1,0]
    v_pk_fma_f32 v[48:49], v[34:35], v[54:55], v[48:49] op_sel:[1,1,0] op_sel_hi:[0,1,1] neg_lo:[1,0,0]
    v_pk_fma_f32 v[96:97], v[82:83], v[102:103], v[96:97] op_sel:[1,1,0] op_sel_hi:[0,1,1] neg_lo:[1,0,0]
    v_cvt_pk_f16_f32 v116, v54, v55
    v_cvt_pk_f16_f32 v117, v102, v103
    v_pk_mul_f32 v[52:53], v[54:55], v[44:45] op_sel_hi:[1,0]
    v_pk_mul_f32 v[100:101], v[102:103], v[92:93] op_sel_hi:[1,0]
    v_pk_fma_f32 v[52:53], v[54:55], v[44:45], v[52:53] op_sel:[1,1,0] op_sel_hi:[0,1,1] neg_lo:[1,0,0]
    v_pk_fma_f32 v[100:101], v[102:103], v[92:93], v[100:101] op_sel:[1,1,0] op_sel_hi:[0,1,1] neg_lo:[1,0,0]
    v_cvt_pk_f16_f32 v118, v48, v49
    v_cvt_pk_f16_f32 v119, v96, v97
    ds_write_addtid_b32 v122 offset:5984
    ds_write_addtid_b32 v123 offset:6240
    ds_write_addtid_b32 v116 offset:6528
    ds_write_addtid_b32 v117 offset:6784
    ds_write_addtid_b32 v118 offset:7072
    ds_write_addtid_b32 v119 offset:7328
    v_pk_mul_f32 v[48:49], v[34:35], v[52:53] op_sel_hi:[1,0]
    v_pk_mul_f32 v[96:97], v[82:83], v[100:101] op_sel_hi:[1,0]
    v_pk_fma_f32 v[48:49], v[34:35], v[52:53], v[48:49] op_sel:[1,1,0] op_sel_hi:[0,1,1] neg_lo:[1,0,0]
    v_pk_fma_f32 v[96:97], v[82:83], v[100:101], v[96:97] op_sel:[1,1,0] op_sel_hi:[0,1,1] neg_lo:[1,0,0]
    v_cvt_pk_f16_f32 v120, v52, v53
    v_cvt_pk_f16_f32 v121, v100, v101
    v_cvt_pk_f16_f32 v122, v48, v49
    v_cvt_pk_f16_f32 v123, v96, v97
    ds_write_addtid_b32 v120 offset:7616
    ds_write_addtid_b32 v121 offset:7872
    ds_write_addtid_b32 v122 offset:8160
    ds_write_addtid_b32 v123 offset:8416
    ds_read_b128 v[156:159], v2 offset:0
    ds_read_b128 v[160:163], v2 offset:64
    ds_read_b128 v[164:167], v2 offset:128
    ds_read_b128 v[168:171], v2 offset:192
    ds_read_b128 v[172:175], v2 offset:256
    ds_read_b128 v[176:179], v2 offset:320
    ds_read_b128 v[180:183], v2 offset:384
    ds_read_b128 v[184:187], v2 offset:448
    s_bitcmp1_b32 236, s80
    s_cselect_b32 s84, s81, 0x40000000
    s_cselect_b32 s69, 786432, 0
    buffer_load_dword v219, v225, s[76:79], s84 offen
    s_add_u32 s81, s81, s69
    s_bitcmp1_b32 500480, s80
    s_cselect_b32 s84, s68, 0x40000000
    s_cselect_b32 s69, 98304, 0
    buffer_load_dword v219, v226, s[72:75], s84 offen
    s_add_u32 s68, s68, s69
    s_add_u32 s80, s80, 1
    s_cmp_eq_u32 s85, 2
    s_cbranch_scc1 L_uhook1
L_uhook1_back:
    v_cvt_pk_f16_f32 v116, v46, v47
    v_cvt_pk_f16_f32 v117, v94, v95
    v_pk_mul_f32 v[48:49], v[46:47], v[44:45] op_sel_hi:[1,0]
    v_pk_mul_f32 v[96:97], v[94:95], v[92:93] op_sel_hi:[1,0]
    v_pk_fma_f32 v[48:49], v[46:47], v[44:45], v[48:49] op_sel:[1,1,0] op_sel_hi:[0,1,1] neg_lo:[1,0,0]
    v_pk_fma_f32 v[96:97], v[94:95], v[92:93], v[96:97] op_sel:[1,1,0] op_sel_hi:[0,1,1] neg_lo:[1,0,0]
    v_cvt_pk_f16_f32 v118, v48, v49
    v_cvt_pk_f16_f32 v119, v96, v97
    v_pk_mul_f32 v[50:51], v[48:49], v[44:45] op_sel_hi:[1,0]
    v_pk_mul_f32 v[98:99], v[96:97], v[92:93] op_sel_hi:[1,0]
    v_pk_fma_f32 v[50:51], v[48:49], v[44:45], v[50:51] op_sel:[1,1,0] op_sel_hi:[0,1,1] neg_lo:[1,0,0]
    v_pk_fma_f32 v[98:99], v[96:97], v[92:93], v[98:99] op_sel:[1,1,0] op_sel_hi:[0,1,1] neg_lo:[1,0,0]
    v_cvt_pk_f16_f32 v120, v50, v51
    v_cvt_pk_f16_f32 v121, v98, v99
    ds_write_addtid_b32 v116 offset:0
    ds_write_addtid_b32 v117 offset:256
    ds_write_addtid_b32 v118 offset:544
    ds_write_addtid_b32 v119 offset:800
    ds_write_addtid_b32 v120 offset:1088
    ds_write_addtid_b32 v121 offset:1344
    v_pk_mul_f32 v[52:53], v[50:51], v[44:45] op_sel_hi:[1,0]
    v_pk_mul_f32 v[100:101], v[98:99], v[92:93] op_sel_hi:[1,0]
    v_pk_fma_f32 v[52:53], v[50:51], v[44:45], v[52:53] op_sel:[1,1,0] op_sel_hi:[0,1,1] neg_lo:[1,0,0]
    v_pk_fma_f32 v[100:101], v[98:99], v[92:93], v[100:101] op_sel:[1,1,0] op_sel_hi:[0,1,1] neg_lo:[1,0,0]
    v_cvt_pk_f16_f32 v122, v52, v53
    v_cvt_pk_f16_f32 v123, v100, v101
    v_pk_mul_f32 v[54:55], v[52:53], v[44:45] op_sel_hi:[1,0]
    v_pk_mul_f32 v[102:103], v[100:101], v[92:93] op_sel_hi:[1,0]
    v_pk_fma_f32 v[54:55], v[52:53], v[44:45], v[54:55] op_sel:[1,1,0] op_sel_hi:[0,1,1] neg_lo:[1,0,0]
    v_pk_fma_f32 v[102:103], v[100:101], v[92:93], v[102:103] op_sel:[1,1,0] op_sel_hi:[0,1,1] neg_lo:[1,0,0]
    v_cvt_pk_f16_f32 v116, v54, v55
    v_cvt_pk_f16_f32 v117, v102, v103
    v_mul_f32 v188, v188, v17
    v_mul_f32 v189, v189, v17
    v_mul_f32 v190, v190, v17
    v_mul_f32 v191, v191, v17
    v_cvt_pk_bf16_f32 v191, v191, v190
    v_cvt_pk_bf16_f32 v189, v189, v188
    v_mov_b32 v188, v191
    ds_write_addtid_b32 v122 offset:1632
    ds_write_addtid_b32 v123 offset:1888
    ds_write_addtid_b32 v116 offset:2176
    ds_write_addtid_b32 v117 offset:2432
    ds_write_b64 v3, v[188:189]
    s_waitcnt lgkmcnt(11)
    v_mfma_f32_16x16x32_f16 v[192:195], v[156:159], v[124:127], 0
    v_pk_mul_f32 v[48:49], v[54:55], v[44:45] op_sel_hi:[1,0]
    v_pk_mul_f32 v[96:97], v[102:103], v[92:93] op_sel_hi:[1,0]
    v_pk_fma_f32 v[48:49], v[54:55], v[44:45], v[48:49] op_sel:[1,1,0] op_sel_hi:[0,1,1] neg_lo:[1,0,0]
    v_mfma_f32_16x16x32_f16 v[192:195], v[160:163], v[128:131], v[192:195]
    v_pk_fma_f32 v[96:97], v[102:103], v[92:93], v[96:97] op_sel:[1,1,0] op_sel_hi:[0,1,1] neg_lo:[1,0,0]
    v_cvt_pk_f16_f32 v118, v48, v49
    v_cvt_pk_f16_f32 v119, v96, v97
    v_mfma_f32_16x16x32_f16 v[192:195], v[164:167], v[132:135], v[192:195]
    v_pk_mul_f32 v[50:51], v[48:49], v[44:45] op_sel_hi:[1,0]
    v_mfma_f32_16x16x32_f16 v[192:195], v[168:171], v[136:139], v[192:195]
    v_pk_mul_f32 v[98:99], v[96:97], v[92:93] op_sel_hi:[1,0]
    v_pk_fma_f32 v[50:51], v[48:49], v[44:45], v[50:51] op_sel:[1,1,0] op_sel_hi:[0,1,1] neg_lo:[1,0,0]
    v_pk_fma_f32 v[98:99], v[96:97], v[92:93], v[98:99] op_sel:[1,1,0] op_sel_hi:[0,1,1] neg_lo:[1,0,0]
    v_mfma_f32_16x16x32_f16 v[192:195], v[172:175], v[140:143], v[192:195]
    v_cvt_pk_f16_f32 v120, v50, v51
    v_cvt_pk_f16_f32 v121, v98, v99
    v_mfma_f32_16x16x32_f16 v[192:195], v[176:179], v[144:147], v[192:195]
    v_pk_mul_f32 v[52:53], v[50:51], v[44:45] op_sel_hi:[1,0]
    v_pk_mul_f32 v[100:101], v[98:99], v[92:93] op_sel_hi:[1,0]
    v_mfma_f32_16x16x32_f16 v[192:195], v[180:183], v[148:151], v[192:195]
    v_pk_fma_f32 v[52:53], v[50:51], v[44:45], v[52:53] op_sel:[1,1,0] op_sel_hi:[0,1,1] neg_lo:[1,0,0]
    v_pk_fma_f32 v[100:101], v[98:99], v[92:93], v[100:101] op_sel:[1,1,0] op_sel_hi:[0,1,1] neg_lo:[1,0,0]
    v_cvt_pk_f16_f32 v122, v52, v53
    v_mfma_f32_16x16x32_f16 v[192:195], v[184:187], v[152:155], v[192:195]
    v_cvt_pk_f16_f32 v123, v100, v101
    ds_write_addtid_b32 v118 offset:2720
    ds_write_addtid_b32 v119 offset:2976
    ds_write_addtid_b32 v120 offset:3264
    ds_write_addtid_b32 v121 offset:3520
    ds_write_addtid_b32 v122 offset:3808
    ds_write_addtid_b32 v123 offset:4064
    v_pk_mul_f32 v[54:55], v[52:53], v[44:45] op_sel_hi:[1,0]
    v_pk_mul_f32 v[102:103], v[100:101], v[92:93] op_sel_hi:[1,0]
    v_pk_fma_f32 v[54:55], v[52:53], v[44:45], v[54:55] op_sel:[1,1,0] op_sel_hi:[0,1,1] neg_lo:[1,0,0]
    v_pk_fma_f32 v[102:103], v[100:101], v[92:93], v[102:103] op_sel:[1,1,0] op_sel_hi:[0,1,1] neg_lo:[1,0,0]
    v_cvt_pk_f16_f32 v116, v54, v55
    v_cvt_pk_f16_f32 v117, v102, v103
    ds_write_addtid_b32 v116 offset:4352
    ds_write_addtid_b32 v117 offset:4608
    ds_read_b128 v[156:159], v2 offset:0
    ds_read_b128 v[160:163], v2 offset:64
    ds_read_b128 v[164:167], v2 offset:128
    ds_read_b128 v[168:171], v2 offset:192
    ds_read_b128 v[172:175], v2 offset:256
    ds_read_b128 v[176:179], v2 offset:320
    ds_read_b128 v[180:183], v2 offset:384
    ds_read_b128 v[184:187], v2 offset:448
    s_cmp_eq_u32 s85, 2
    s_cbranch_scc1 L_kgen_last
    v_lshlrev_b32 v70, 16, v202
    v_and_b32 v71, 0xffff0000, v202
    v_lshlrev_b32 v72, 16, v203
    v_and_b32 v73, 0xffff0000, v203
    v_max3_f32 v70, abs(v70), abs(v71), abs(v72)
    v_max_f32 v70, v70, abs(v73)
    v_lshlrev_b32 v22, 16, v212
    v_mul_f32 v23, s36, v22
    v_fma_f32 v24, v22, s36, -v23
    v_max_f32_dpp v70, v70, v70 quad_perm:[1,0,3,2] row_mask:0xf bank_mask:0xf
    v_fma_f32 v24, v22, s37, v24
    v_exp_f32 v23, v23
    v_mul_f32 v192, v192, v17
    v_mul_f32 v193, v193, v17
    v_mul_f32 v194, v194, v17
    v_mul_f32 v195, v195, v17
    v_cvt_pk_bf16_f32 v192, v192, v192
    v_cvt_pk_bf16_f32 v193, v193, v193
    v_cvt_pk_bf16_f32 v194, v194, v194
    v_cvt_pk_bf16_f32 v195, v195, v195
    ds_write2_b32 v4, v192, v193 offset0:0 offset1:1
    ds_write2_b32 v5, v194, v195 offset0:0 offset1:1
    v_max_f32_dpp v70, v70, v70 quad_perm:[2,3,0,1] row_mask:0xf bank_mask:0xf
    v_mul_f32 v24, s38, v24
    v_fma_f32 v23, v23, v24, v23
    v_max_f32_dpp v70, v70, v70 row_half_mirror row_mask:0xf bank_mask:0xf
    v_cvt_pk_bf16_f32 v23, v23, v23
    v_lshlrev_b32 v16, 16, v23
    v_max_f32_dpp v70, v70, v70 row_mirror row_mask:0xf bank_mask:0xf
    s_nop 0
    v_readlane_b32 s41, v70, 0
    v_readlane_b32 s42, v70, 16
    v_readlane_b32 s43, v70, 32
    v_readlane_b32 s33, v70, 48
    s_waitcnt lgkmcnt(2)
    v_mfma_f32_16x16x32_f16 v[196:199], v[156:159], v[124:127], 0
    v_lshlrev_b32 v22, 16, v200
    v_and_b32 v70, 0xffff0000, v200
    v_mfma_f32_16x16x32_f16 v[196:199], v[160:163], v[128:131], v[196:199]
    v_mul_f32 v23, s36, v22
    v_mul_f32 v71, s36, v70
    v_mfma_f32_16x16x32_f16 v[196:199], v[164:167], v[132:135], v[196:199]
    v_fma_f32 v24, v22, s36, -v23
    v_fma_f32 v72, v70, s36, -v71
    v_mfma_f32_16x16x32_f16 v[196:199], v[168:171], v[136:139], v[196:199]
    v_fma_f32 v24, v22, s37, v24
    v_fma_f32 v72, v70, s37, v72
    v_mfma_f32_16x16x32_f16 v[196:199], v[172:175], v[140:143], v[196:199]
    v_exp_f32 v23, v23
    v_exp_f32 v71, v71
    v_mfma_f32_16x16x32_f16 v[196:199], v[176:179], v[144:147], v[196:199]
    v_mul_f32 v24, s38, v24
    v_mul_f32 v72, s38, v72
    v_mfma_f32_16x16x32_f16 v[196:199], v[180:183], v[148:151], v[196:199]
    v_fma_f32 v23, v23, v24, v23
    v_fma_f32 v71, v71, v72, v71
    v_mfma_f32_16x16x32_f16 v[196:199], v[184:187], v[152:155], v[196:199]
    v_cvt_pk_bf16_f32 v23, v23, v23
    v_cvt_pk_bf16_f32 v71, v71, v71
    ds_read_b64 v[128:129], v8 offset:512
    ds_read_b128 v[132:135], v9
    ds_read_b32 v136, v9 offset:16
    v_lshlrev_b32 v20, 16, v23
    v_lshlrev_b32 v68, 16, v71
    s_max_u32 s41, s41, s42
    s_max_u32 s43, s43, s33
    s_max_u32 s41, s41, s43
    s_lshr_b32 s41, s41, 23
    s_min_u32 s41, s41, 252
    s_sub_u32 s42, 253, s41
    s_lshl_b32 s42, s42, 23
    s_add_u32 s41, s41, 2
    v_mul_f32 v196, v196, v17
    v_mul_f32 v197, v197, v17
    v_mul_f32 v198, v198, v17
    v_mul_f32 v199, v199, v17
    v_cvt_pk_bf16_f32 v196, v196, v196
    v_cvt_pk_bf16_f32 v197, v197, v197
    v_cvt_pk_bf16_f32 v198, v198, v198
    v_cvt_pk_bf16_f32 v199, v199, v199
    ds_write_b32 v6, v196 offset:1024
    ds_write_b32 v6, v197 offset:1088
    ds_write_b32 v6, v198 offset:1152
    ds_write_b32 v6, v199 offset:1216
    ds_read_b32 v130, v8 offset:520
    ds_read2_b32 v[124:125], v18 offset0:0 offset1:1
    ds_read2_b32 v[126:127], v18 offset0:64 offset1:65
    s_waitcnt lgkmcnt(7)
    v_bfi_b32 v152, s40, v136, v135
    v_mov_b32 v153, v134
    v_bfi_b32 v154, s40, v134, v133
    v_mov_b32 v155, v132
    s_mov_b32 exec_hi, 0
    ds_write_b128 v10, v[152:155] offset:2560
    s_mov_b64 exec, -1
    s_lshl_b32 s41, s41, 23
    v_mul_f32 v19, s41, v16
    v_mul_f32 v19, 0xbf317218, v19
    v_lshlrev_b32 v21, 16, v201
    v_and_b32 v69, 0xffff0000, v201
    v_lshlrev_b32 v48, 16, v202
    v_and_b32 v96, 0xffff0000, v202
    v_lshlrev_b32 v49, 16, v203
    v_and_b32 v97, 0xffff0000, v203
    v_mul_f32 v20, v20, v16
    v_mul_f32 v68, v68, v16
    v_mul_f32 v21, v21, v16
    v_mul_f32 v69, v69, v16
    v_mul_f32 v48, s42, v48
    v_mul_f32 v96, s42, v96
    v_mul_f32 v49, s42, v49
    v_mul_f32 v97, s42, v97
    v_mul_f32 v20, s36, v20
    v_mul_f32 v68, s36, v68
    v_mul_f32 v21, s39, v21
    s_waitcnt lgkmcnt(1)
    v_mov_b32 v148, v130
    v_mov_b32 v149, v129
    v_bfi_b32 v150, s40, v129, v128
    v_mov_b32 v151, v128
    ds_write_b128 v10, v[148:151] offset:2048
    v_mov_b32 v140, v125
    v_bfi_b32 v141, v12, v125, v124
    v_mov_b32 v142, v124
    v_mov_b32 v143, v124
    ds_write_b128 v10, v[140:143] offset:1024
    v_mov_b32 v144, v127
    v_bfi_b32 v145, v12, v127, v126
    v_mov_b32 v146, v126
    v_mov_b32 v147, v126
    ds_write_b128 v10, v[144:147] offset:0
    ds_read_b128 v[156:159], v11 offset:0
    ds_read_b32 v160, v11 offset:16
    ds_read_b128 v[164:167], v11 offset:1024
    ds_read_b32 v168, v11 offset:1040
    ds_read_b128 v[172:175], v11 offset:2048
    ds_read_b32 v176, v11 offset:2064
    ds_read_b128 v[180:183], v11 offset:3072
    ds_read_b32 v184, v11 offset:3088
    v_mul_f32 v69, s39, v69
    v_sub_f32 v20, 0, v20
    v_sub_f32 v68, 0, v68
    v_mov_b32 v200, v204
    v_mov_b32 v201, v205
    v_mov_b32 v202, v206
    v_mov_b32 v203, v207
    v_mov_b32 v204, v208
    v_mov_b32 v205, v209
    v_mov_b32 v206, v210
    v_mov_b32 v207, v211
    v_mov_b32 v212, v213
    v_mov_b32 v213, v214
    v_mul_f32 v22, 0x41000000, v20
    v_mul_f32 v70, 0x41000000, v68
    v_mul_f32 v23, 0x41000000, v21
    v_mul_f32 v71, 0x41000000, v69
    v_exp_f32 v22, v22
    v_exp_f32 v70, v70
    v_fract_f32 v23, v23
    v_fract_f32 v71, v71
    v_cos_f32 v42, v23
    v_cos_f32 v90, v71
    v_sin_f32 v43, v23
    v_sin_f32 v91, v71
    v_pk_mul_f32 v[42:43], v[42:43], v[22:23] op_sel_hi:[1,0]
    v_pk_mul_f32 v[90:91], v[90:91], v[70:71] op_sel_hi:[1,0]
    v_exp_f32 v24, v20
    v_exp_f32 v72, v68
    v_fract_f32 v25, v21
    v_fract_f32 v73, v69
    v_cos_f32 v28, v25
    v_cos_f32 v76, v73
    v_sin_f32 v29, v25
    v_sin_f32 v77, v73
    v_pk_mul_f32 v[28:29], v[28:29], v[24:25] op_sel_hi:[1,0]
    v_pk_mul_f32 v[76:77], v[76:77], v[72:73] op_sel_hi:[1,0]
    v_mul_f32 v22, 0x43000000, v20
    v_mul_f32 v70, 0x43000000, v68
    v_mul_f32 v23, 0x43000000, v21
    s_waitcnt lgkmcnt(6)
    v_alignbit_b32 v156, v157, v156, 16
    v_alignbit_b32 v157, v158, v157, 16
    v_alignbit_b32 v158, v159, v158, 16
    v_alignbit_b32 v159, v160, v159, 16
    ds_write_b128 v11, v[156:159] offset:4160
    v_mul_f32 v71, 0x43000000, v69
    v_exp_f32 v22, v22
    v_exp_f32 v70, v70
    v_fract_f32 v23, v23
    v_fract_f32 v71, v71
    v_cos_f32 v44, v23
    s_waitcnt lgkmcnt(5)
    v_alignbit_b32 v164, v165, v164, 16
    v_alignbit_b32 v165, v166, v165, 16
    v_alignbit_b32 v166, v167, v166, 16
    v_alignbit_b32 v167, v168, v167, 16
    ds_write_b128 v11, v[164:167] offset:5184
    v_cos_f32 v92, v71
    v_sin_f32 v45, v23
    v_sin_f32 v93, v71
    v_pk_mul_f32 v[44:45], v[44:45], v[22:23] op_sel_hi:[1,0]
    v_pk_mul_f32 v[92:93], v[92:93], v[70:71] op_sel_hi:[1,0]
    v_mul_f32 v24, 0x44800000, v20
    s_waitcnt lgkmcnt(4)
    v_alignbit_b32 v172, v173, v172, 16
    v_alignbit_b32 v173, v174, v173, 16
    v_alignbit_b32 v174, v175, v174, 16
    v_alignbit_b32 v175, v176, v175, 16
    ds_write_b128 v11, v[172:175] offset:6208
    v_mul_f32 v72, 0x44800000, v68
    v_mul_f32 v25, 0x44800000, v21
    v_mul_f32 v73, 0x44800000, v69
    v_exp_f32 v24, v24
    v_exp_f32 v72, v72
    v_fract_f32 v25, v25
    s_waitcnt lgkmcnt(3)
    v_alignbit_b32 v180, v181, v180, 16
    v_alignbit_b32 v181, v182, v181, 16
    v_alignbit_b32 v182, v183, v182, 16
    v_alignbit_b32 v183, v184, v183, 16
    ds_write_b128 v11, v[180:183] offset:7232
    v_fract_f32 v73, v73
    v_cos_f32 v46, v25
    v_cos_f32 v94, v73
    v_sin_f32 v47, v25
    v_sin_f32 v95, v73
    v_pk_mul_f32 v[46:47], v[46:47], v[24:25] op_sel_hi:[1,0]
    v_pk_mul_f32 v[94:95], v[94:95], v[72:73] op_sel_hi:[1,0]
    v_add_u32 v3, 8320, v3
    v_add_u32 v10, 8320, v10
    v_add_u32 v11, 8320, v11
    s_add_u32 s85, s85, 1
    s_cmp_eq_u32 s85, 99
    s_cbranch_scc0 L_kgen_nosw
    s_mov_b32 s76, s22
    s_and_b32 s77, s23, 0xffff
    s_mov_b32 s84, 0
L_kgen_nosw:
    s_branch L_kgen
L_kgen_last:
    s_waitcnt vmcnt(0)
    v_lshrrev_b32 v224, 4, v221
    v_and_b32 v221, s34, v221
    v_and_b32 v224, s34, v224
    v_add_u32 v221, v221, v224
    v_mul_lo_u32 v221, v221, s35
    v_lshrrev_b32 v221, 24, v221
    v_cmp_eq_u32 vcc, 8, v221
    s_nop 1
    s_and_b32 s98, vcc_lo, 0x3ffffff
    s_cmp_eq_u32 s98, 0x3ffffff
    s_mul_i32 s98, s3, 384
    s_cselect_b32 s98, s98, 0x40000000
    s_cselect_b32 s91, 1, 0
    s_nop 7
    buffer_load_dwordx4 a[0:3], v222, s[56:59], s98 offen sc1
    s_add_u32 s98, s98, 184320
    v_mul_f32 v192, v192, v17
    v_mul_f32 v193, v193, v17
    v_mul_f32 v194, v194, v17
    v_mul_f32 v195, v195, v17
    v_cvt_pk_bf16_f32 v192, v192, v192
    v_cvt_pk_bf16_f32 v193, v193, v193
    v_cvt_pk_bf16_f32 v194, v194, v194
    buffer_load_dwordx4 a[4:7], v222, s[56:59], s98 offen sc1
    s_add_u32 s98, s98, 184320
    v_cvt_pk_bf16_f32 v195, v195, v195
    ds_write2_b32 v4, v192, v193 offset0:0 offset1:1
    ds_write2_b32 v5, v194, v195 offset0:0 offset1:1
    s_waitcnt lgkmcnt(2)
    v_mfma_f32_16x16x32_f16 v[196:199], v[156:159], v[124:127], 0
    v_mfma_f32_16x16x32_f16 v[196:199], v[160:163], v[128:131], v[196:199]
    v_mfma_f32_16x16x32_f16 v[196:199], v[164:167], v[132:135], v[196:199]
    buffer_load_dwordx4 a[8:11], v222, s[56:59], s98 offen sc1
    s_add_u32 s98, s98, 184320
    v_mfma_f32_16x16x32_f16 v[196:199], v[168:171], v[136:139], v[196:199]
    v_mfma_f32_16x16x32_f16 v[196:199], v[172:175], v[140:143], v[196:199]
    v_mfma_f32_16x16x32_f16 v[196:199], v[176:179], v[144:147], v[196:199]
    v_mfma_f32_16x16x32_f16 v[196:199], v[180:183], v[148:151], v[196:199]
    v_mfma_f32_16x16x32_f16 v[196:199], v[184:187], v[152:155], v[196:199]
    s_nop 7
    ds_read_b64 v[128:129], v8 offset:512
    ds_read_b128 v[132:135], v9
    buffer_load_dwordx4 a[12:15], v222, s[56:59], s98 offen sc1
    s_add_u32 s98, s98, 184320
    ds_read_b32 v136, v9 offset:16
    v_mul_f32 v196, v196, v17
    v_mul_f32 v197, v197, v17
    v_mul_f32 v198, v198, v17
    v_mul_f32 v199, v199, v17
    v_cvt_pk_bf16_f32 v196, v196, v196
    v_cvt_pk_bf16_f32 v197, v197, v197
    buffer_load_dwordx4 a[16:19], v222, s[56:59], s98 offen sc1
    s_add_u32 s98, s98, 184320
    v_cvt_pk_bf16_f32 v198, v198, v198
    v_cvt_pk_bf16_f32 v199, v199, v199
    ds_write_b32 v6, v196 offset:1024
    ds_write_b32 v6, v197 offset:1088
    ds_write_b32 v6, v198 offset:1152
    ds_write_b32 v6, v199 offset:1216
    ds_read_b32 v130, v8 offset:520
    buffer_load_dwordx4 a[20:23], v222, s[56:59], s98 offen sc1
    s_add_u32 s98, s98, 184320
    ds_read2_b32 v[124:125], v18 offset0:0 offset1:1
    ds_read2_b32 v[126:127], v18 offset0:64 offset1:65
    s_waitcnt lgkmcnt(7)
    v_bfi_b32 v152, s40, v136, v135
    v_mov_b32 v153, v134
    v_bfi_b32 v154, s40, v134, v133
    v_mov_b32 v155, v132
    buffer_load_dwordx4 a[24:27], v222, s[56:59], s98 offen sc1
    s_add_u32 s98, s98, 184320
    s_mov_b32 exec_hi, 0
    ds_write_b128 v10, v[152:155] offset:2560
    s_mov_b64 exec, -1
    s_waitcnt lgkmcnt(1)
    v_mov_b32 v148, v130
    v_mov_b32 v149, v129
    v_bfi_b32 v150, s40, v129, v128
    v_mov_b32 v151, v128
    ds_write_b128 v10, v[148:151] offset:2048
    buffer_load_dwordx4 a[28:31], v222, s[56:59], s98 offen sc1
    s_add_u32 s98, s98, 184320
    v_mov_b32 v140, v125
    v_bfi_b32 v141, v12, v125, v124
    v_mov_b32 v142, v124
    v_mov_b32 v143, v124
    ds_write_b128 v10, v[140:143] offset:1024
    v_mov_b32 v144, v127
    v_bfi_b32 v145, v12, v127, v126
    buffer_load_dwordx4 a[32:35], v222, s[56:59], s98 offen sc1
    s_add_u32 s98, s98, 184320
    v_mov_b32 v146, v126
    v_mov_b32 v147, v126
    ds_write_b128 v10, v[144:147] offset:0
    ds_read_b128 v[156:159], v11 offset:0
    ds_read_b32 v160, v11 offset:16
    ds_read_b128 v[164:167], v11 offset:1024
    ds_read_b32 v168, v11 offset:1040
    buffer_load_dwordx4 a[36:39], v222, s[56:59], s98 offen sc1
    s_add_u32 s98, s98, 184320
    ds_read_b128 v[172:175], v11 offset:2048
    ds_read_b32 v176, v11 offset:2064
    ds_read_b128 v[180:183], v11 offset:3072
    ds_read_b32 v184, v11 offset:3088
    s_waitcnt lgkmcnt(6)
    v_alignbit_b32 v156, v157, v156, 16
    v_alignbit_b32 v157, v158, v157, 16
    buffer_load_dwordx4 a[40:43], v222, s[56:59], s98 offen sc1
    s_add_u32 s98, s98, 184320
    v_alignbit_b32 v158, v159, v158, 16
    v_alignbit_b32 v159, v160, v159, 16
    ds_write_b128 v11, v[156:159] offset:4160
    s_waitcnt lgkmcnt(5)
    v_alignbit_b32 v164, v165, v164, 16
    v_alignbit_b32 v165, v166, v165, 16
    v_alignbit_b32 v166, v167, v166, 16
    buffer_load_dwordx4 a[44:47], v222, s[56:59], s98 offen sc1
    s_add_u32 s98, s98, 184320
    v_alignbit_b32 v167, v168, v167, 16
    ds_write_b128 v11, v[164:167] offset:5184
    s_waitcnt lgkmcnt(4)
    v_alignbit_b32 v172, v173, v172, 16
    v_alignbit_b32 v173, v174, v173, 16
    v_alignbit_b32 v174, v175, v174, 16
    v_alignbit_b32 v175, v176, v175, 16
    buffer_load_dwordx4 a[48:51], v222, s[56:59], s98 offen sc1
    s_add_u32 s98, s98, 184320
    ds_write_b128 v11, v[172:175] offset:6208
    s_waitcnt lgkmcnt(3)
    v_alignbit_b32 v180, v181, v180, 16
    v_alignbit_b32 v181, v182, v181, 16
    v_alignbit_b32 v182, v183, v182, 16
    v_alignbit_b32 v183, v184, v183, 16
    ds_write_b128 v11, v[180:183] offset:7232
    v_mov_b32 v16, 0
    v_mov_b32 v17, 0
    ds_write_b64 v1, v[16:17]
    ds_write_b64 v1, v[16:17] offset:4608
    s_cmp_eq_u32 s91, 1
    s_cbranch_scc1 L_cv_got
    s_mov_b32 s86, 0
L_cv_poll:
    s_mov_b64 exec, 0x3ffffff
    global_load_dword v221, v220, s[26:27] sc1
    s_mov_b64 exec, -1
    s_waitcnt vmcnt(0)
    v_lshrrev_b32 v224, 4, v221
    v_and_b32 v221, s34, v221
    v_and_b32 v224, s34, v224
    v_add_u32 v221, v221, v224
    v_mul_lo_u32 v221, v221, s35
    v_lshrrev_b32 v221, 24, v221
    v_cmp_eq_u32 vcc, 8, v221
    s_nop 1
    s_and_b32 s98, vcc_lo, 0x3ffffff
    s_cmp_eq_u32 s98, 0x3ffffff
    s_cbranch_scc1 L_cv_polled
    s_sleep 64
    s_add_u32 s86, s86, 1
    s_cmp_lt_u32 s86, 0x1000
    s_cbranch_scc1 L_cv_poll
L_cv_polled:
    s_mul_i32 s98, s3, 384
    s_mov_b64 exec, s[96:97]
    buffer_load_dwordx4 a[0:3], v222, s[56:59], s98 offen sc1
    s_add_u32 s98, s98, 184320
    buffer_load_dwordx4 a[4:7], v222, s[56:59], s98 offen sc1
    s_add_u32 s98, s98, 184320
    buffer_load_dwordx4 a[8:11], v222, s[56:59], s98 offen sc1
    s_add_u32 s98, s98, 184320
    buffer_load_dwordx4 a[12:15], v222, s[56:59], s98 offen sc1
    s_add_u32 s98, s98, 184320
    buffer_load_dwordx4 a[16:19], v222, s[56:59], s98 offen sc1
    s_add_u32 s98, s98, 184320
    buffer_load_dwordx4 a[20:23], v222, s[56:59], s98 offen sc1
    s_add_u32 s98, s98, 184320
    buffer_load_dwordx4 a[24:27], v222, s[56:59], s98 offen sc1
    s_add_u32 s98, s98, 184320
    buffer_load_dwordx4 a[28:31], v222, s[56:59], s98 offen sc1
    s_add_u32 s98, s98, 184320
    buffer_load_dwordx4 a[32:35], v222, s[56:59], s98 offen sc1
    s_add_u32 s98, s98, 184320
    buffer_load_dwordx4 a[36:39], v222, s[56:59], s98 offen sc1
    s_add_u32 s98, s98, 184320
    buffer_load_dwordx4 a[40:43], v222, s[56:59], s98 offen sc1
    s_add_u32 s98, s98, 184320
    buffer_load_dwordx4 a[44:47], v222, s[56:59], s98 offen sc1
    s_add_u32 s98, s98, 184320
    buffer_load_dwordx4 a[48:51], v222, s[56:59], s98 offen sc1
    s_mov_b64 exec, -1
    s_mov_b32 s91, 1
L_cv_got:
    s_waitcnt lgkmcnt(0)
    s_barrier
    s_mul_i32 s88, s3, 384
    s_mul_i32 s34, s30, 589824
    s_add_u32 s88, s88, s34
    s_add_u32 s88, s88, 4194304
    s_mov_b32 s85, 0
    v_add_u32 v180, 0, v230
    v_add_u32 v181, 0, v232
    v_add_u32 v182, 0, v233
    v_mov_b32 v176, v231
    v_subrev_u32 v177, 1024, v231
    v_subrev_u32 v178, 2048, v231
    v_subrev_u32 v179, 3072, v231
    s_and_b32 s33, s2, 7
    s_lshr_b32 s34, s2, 3
    s_sub_u32 s34, s34, 26
    s_lshl_b32 s34, s34, 2
    s_add_u32 s34, s34, s30
    s_lshr_b32 s35, s34, 3
    s_mul_i32 s33, s33, 3
    s_add_u32 s33, s33, s35
    s_mul_i32 s33, s33, 92160
    s_and_b32 s34, s34, 7
    s_mul_i32 s34, s34, 2396160
    s_add_u32 s33, s33, s34
    s_add_u32 s33, s33, 8388608
    s_mov_b32 s99, s33
    s_add_u32 s87, s33, 49152
    s_mov_b32 s70, 3130571416
    s_mov_b32 s71, 1893
    v_lshlrev_b32 v183, 7, v13
    ds_read2_b32 v[48:49], v176 offset0:128 offset1:129
    ds_read2_b32 v[50:51], v176 offset0:130 offset1:131
    ds_read2_b32 v[52:53], v176 offset0:0 offset1:1
    ds_read2_b32 v[54:55], v176 offset0:2 offset1:3
    ds_read2_b32 v[56:57], v177 offset0:128 offset1:129
    ds_read2_b32 v[58:59], v177 offset0:130 offset1:131
    ds_read2_b32 v[60:61], v177 offset0:0 offset1:1
    ds_read2_b32 v[62:63], v177 offset0:2 offset1:3
    ds_read2_b32 v[64:65], v178 offset0:128 offset1:129
    ds_read2_b32 v[66:67], v178 offset0:130 offset1:131
    ds_read2_b32 v[68:69], v178 offset0:0 offset1:1
    ds_read2_b32 v[70:71], v178 offset0:2 offset1:3
    ds_read2_b32 v[72:73], v179 offset0:128 offset1:129
    ds_read2_b32 v[74:75], v179 offset0:130 offset1:131
    ds_read2_b32 v[76:77], v179 offset0:0 offset1:1
    ds_read2_b32 v[78:79], v179 offset0:2 offset1:3
    v_mov_b32 v16, 0
    v_mov_b32 v17, 0
    v_mov_b32 v18, 0
    v_mov_b32 v19, 0
    v_mov_b32 v20, 0
    v_mov_b32 v21, 0
    v_mov_b32 v22, 0
    v_mov_b32 v23, 0
    v_mov_b32 v24, 0
    v_mov_b32 v25, 0
    v_mov_b32 v26, 0
    v_mov_b32 v27, 0
    v_mov_b32 v28, 0
    v_mov_b32 v29, 0
    v_mov_b32 v30, 0
    v_mov_b32 v31, 0
    v_mov_b32 v32, 0
    v_mov_b32 v33, 0
    v_mov_b32 v34, 0
    v_mov_b32 v35, 0
    v_mov_b32 v36, 0
    v_mov_b32 v37, 0
    v_mov_b32 v38, 0
    v_mov_b32 v39, 0
    v_mov_b32 v40, 0
    v_mov_b32 v41, 0
    v_mov_b32 v42, 0
    v_mov_b32 v43, 0
    v_mov_b32 v44, 0
    v_mov_b32 v45, 0
    v_mov_b32 v46, 0
    v_mov_b32 v47, 0
    s_mov_b64 exec, s[96:97]
    s_waitcnt vmcnt(12)
    ds_write_b128 v223, a[0:3] offset:0
    s_waitcnt vmcnt(11)
    ds_write_b128 v223, a[4:7] offset:320
    s_waitcnt vmcnt(10)
    ds_write_b128 v223, a[8:11] offset:640
    s_waitcnt vmcnt(9)
    ds_write_b128 v223, a[12:15] offset:960
    s_waitcnt vmcnt(8)
    ds_write_b128 v223, a[16:19] offset:1280
    s_waitcnt vmcnt(7)
    ds_write_b128 v223, a[20:23] offset:1600
    s_waitcnt vmcnt(6)
    ds_write_b128 v223, a[24:27] offset:1920
    s_waitcnt vmcnt(5)
    ds_write_b128 v223, a[28:31] offset:2240
    s_waitcnt vmcnt(4)
    ds_write_b128 v223, a[32:35] offset:2560
    s_waitcnt vmcnt(3)
    ds_write_b128 v223, a[36:39] offset:2880
    s_waitcnt vmcnt(2)
    ds_write_b128 v223, a[40:43] offset:3200
    s_waitcnt vmcnt(1)
    ds_write_b128 v223, a[44:47] offset:3520
    s_mov_b64 exec, s[92:93]
    s_waitcnt vmcnt(0)
    ds_write_b128 v223, a[48:51] offset:3840
    s_mov_b64 exec, -1
    s_waitcnt lgkmcnt(0)
    s_barrier
    s_bitcmp1_b32 500480, s80
    s_cselect_b32 s84, s68, 0x40000000
    s_cselect_b32 s69, 98304, 0
    buffer_load_dword v219, v226, s[72:75], s84 offen
    s_add_u32 s68, s68, s69
    s_add_u32 s80, s80, 1
    ds_read_b128 v[80:83], v180 offset:448
    ds_read_b128 v[84:87], v180 offset:960
    ds_read_b128 v[88:91], v180 offset:1472
    ds_read_b128 v[92:95], v180 offset:1984
    ds_read_b128 v[96:99], v180 offset:2496
    ds_read_b128 v[100:103], v180 offset:3008
    ds_read_b128 v[104:107], v180 offset:3520
    ds_read_b128 v[108:111], v180 offset:4032
    v_subrev_u32 v176, 64, v176
    v_subrev_u32 v177, 64, v177
    v_subrev_u32 v178, 64, v178
    v_subrev_u32 v179, 64, v179
    v_subrev_u32 v180, 64, v180
L_cv_round:
    s_mov_b32 s33, 0
    s_mov_b32 s89, 64
    s_mov_b32 s90, 64
    s_waitcnt lgkmcnt(0)
L_cv_loop:
    v_mfma_f32_16x16x32_bf16 v[16:19], v[48:51], v[80:83], v[16:19]
    ds_read2_b32 v[112:113], v176 offset0:128 offset1:129
    v_mfma_f32_16x16x32_bf16 v[20:23], v[48:51], v[84:87], v[20:23]
    ds_read2_b32 v[114:115], v176 offset0:130 offset1:131
    v_mfma_f32_16x16x32_bf16 v[24:27], v[48:51], v[88:91], v[24:27]
    ds_read2_b32 v[116:117], v176 offset0:0 offset1:1
    v_mfma_f32_16x16x32_bf16 v[28:31], v[48:51], v[92:95], v[28:31]
    ds_read2_b32 v[118:119], v176 offset0:2 offset1:3
    v_mfma_f32_16x16x32_bf16 v[32:35], v[48:51], v[96:99], v[32:35]
    ds_read2_b32 v[120:121], v177 offset0:128 offset1:129
    v_mfma_f32_16x16x32_bf16 v[36:39], v[48:51], v[100:103], v[36:39]
    ds_read2_b32 v[122:123], v177 offset0:130 offset1:131
    v_mfma_f32_16x16x32_bf16 v[40:43], v[48:51], v[104:107], v[40:43]
    ds_read2_b32 v[124:125], v177 offset0:0 offset1:1
    v_mfma_f32_16x16x32_bf16 v[44:47], v[48:51], v[108:111], v[44:47]
    ds_read2_b32 v[126:127], v177 offset0:2 offset1:3
    v_mfma_f32_16x16x32_bf16 v[20:23], v[52:55], v[80:83], v[20:23]
    ds_read_b128 v[144:147], v180 offset:448
    v_mfma_f32_16x16x32_bf16 v[24:27], v[52:55], v[84:87], v[24:27]
    ds_read_b128 v[148:151], v180 offset:960
    v_mfma_f32_16x16x32_bf16 v[28:31], v[52:55], v[88:91], v[28:31]
    ds_read_b128 v[152:155], v180 offset:1472
    v_mfma_f32_16x16x32_bf16 v[32:35], v[52:55], v[92:95], v[32:35]
    ds_read_b128 v[156:159], v180 offset:1984
    v_mfma_f32_16x16x32_bf16 v[36:39], v[52:55], v[96:99], v[36:39]
    ds_read_b128 v[160:163], v180 offset:2496
    v_mfma_f32_16x16x32_bf16 v[40:43], v[52:55], v[100:103], v[40:43]
    ds_read_b128 v[164:167], v180 offset:3008
    v_mfma_f32_16x16x32_bf16 v[44:47], v[52:55], v[104:107], v[44:47]
    ds_read_b128 v[168:171], v180 offset:3520
    v_mfma_f32_16x16x32_bf16 v[24:27], v[56:59], v[80:83], v[24:27]
    ds_read_b128 v[172:175], v180 offset:4032
    v_mfma_f32_16x16x32_bf16 v[28:31], v[56:59], v[84:87], v[28:31]
    ds_read2_b32 v[128:129], v178 offset0:128 offset1:129
    v_mfma_f32_16x16x32_bf16 v[32:35], v[56:59], v[88:91], v[32:35]
    ds_read2_b32 v[130:131], v178 offset0:130 offset1:131
    v_mfma_f32_16x16x32_bf16 v[36:39], v[56:59], v[92:95], v[36:39]
    ds_read2_b32 v[132:133], v178 offset0:0 offset1:1
    v_mfma_f32_16x16x32_bf16 v[40:43], v[56:59], v[96:99], v[40:43]
    ds_read2_b32 v[134:135], v178 offset0:2 offset1:3
    v_mfma_f32_16x16x32_bf16 v[44:47], v[56:59], v[100:103], v[44:47]
    ds_read2_b32 v[136:137], v179 offset0:128 offset1:129
    v_mfma_f32_16x16x32_bf16 v[28:31], v[60:63], v[80:83], v[28:31]
    ds_read2_b32 v[138:139], v179 offset0:130 offset1:131
    v_mfma_f32_16x16x32_bf16 v[32:35], v[60:63], v[84:87], v[32:35]
    ds_read2_b32 v[140:141], v179 offset0:0 offset1:1
    v_mfma_f32_16x16x32_bf16 v[36:39], v[60:63], v[88:91], v[36:39]
    ds_read2_b32 v[142:143], v179 offset0:2 offset1:3
    v_mfma_f32_16x16x32_bf16 v[40:43], v[60:63], v[92:95], v[40:43]
    v_subrev_u32 v176, s89, v176
    v_mfma_f32_16x16x32_bf16 v[44:47], v[60:63], v[96:99], v[44:47]
    v_subrev_u32 v177, s89, v177
    v_mfma_f32_16x16x32_bf16 v[32:35], v[64:67], v[80:83], v[32:35]
    v_subrev_u32 v178, s89, v178
    v_mfma_f32_16x16x32_bf16 v[36:39], v[64:67], v[84:87], v[36:39]
    v_subrev_u32 v179, s89, v179
    v_mfma_f32_16x16x32_bf16 v[40:43], v[64:67], v[88:91], v[40:43]
    v_subrev_u32 v180, s90, v180
    v_mfma_f32_16x16x32_bf16 v[44:47], v[64:67], v[92:95], v[44:47]
    s_bitcmp1_b32 500480, s80
    s_cselect_b32 s84, s68, 0x40000000
    s_cselect_b32 s69, 98304, 0
    v_mfma_f32_16x16x32_bf16 v[36:39], v[68:71], v[80:83], v[36:39]
    buffer_load_dword v219, v226, s[72:75], s84 offen
    v_mfma_f32_16x16x32_bf16 v[40:43], v[68:71], v[84:87], v[40:43]
    s_add_u32 s68, s68, s69
    s_add_u32 s80, s80, 1
    v_mfma_f32_16x16x32_bf16 v[44:47], v[68:71], v[88:91], v[44:47]
    s_and_b32 s84, s70, 15
    s_lshl_b32 s84, s84, 13
    s_add_u32 s84, s84, s99
    s_bitcmp1_b32 8353792, s80
    s_cselect_b32 s84, s84, 0x40000000
    s_cselect_b32 s69, 4, 0
    v_mfma_f32_16x16x32_bf16 v[40:43], v[72:75], v[80:83], v[40:43]
    buffer_load_dword v184, v183, s[44:47], s84 offen sc1
    s_lshr_b64 s[70:71], s[70:71], s69
    v_mfma_f32_16x16x32_bf16 v[44:47], v[72:75], v[84:87], v[44:47]
    v_mfma_f32_16x16x32_bf16 v[44:47], v[76:79], v[80:83], v[44:47]
    s_waitcnt lgkmcnt(0)
    v_mfma_f32_16x16x32_bf16 v[16:19], v[112:115], v[144:147], v[16:19]
    ds_read2_b32 v[48:49], v176 offset0:128 offset1:129
    v_mfma_f32_16x16x32_bf16 v[20:23], v[112:115], v[148:151], v[20:23]
    ds_read2_b32 v[50:51], v176 offset0:130 offset1:131
    v_mfma_f32_16x16x32_bf16 v[24:27], v[112:115], v[152:155], v[24:27]
    ds_read2_b32 v[52:53], v176 offset0:0 offset1:1
    v_mfma_f32_16x16x32_bf16 v[28:31], v[112:115], v[156:159], v[28:31]
    ds_read2_b32 v[54:55], v176 offset0:2 offset1:3
    v_mfma_f32_16x16x32_bf16 v[32:35], v[112:115], v[160:163], v[32:35]
    ds_read2_b32 v[56:57], v177 offset0:128 offset1:129
    v_mfma_f32_16x16x32_bf16 v[36:39], v[112:115], v[164:167], v[36:39]
    ds_read2_b32 v[58:59], v177 offset0:130 offset1:131
    v_mfma_f32_16x16x32_bf16 v[40:43], v[112:115], v[168:171], v[40:43]
    ds_read2_b32 v[60:61], v177 offset0:0 offset1:1
    v_mfma_f32_16x16x32_bf16 v[44:47], v[112:115], v[172:175], v[44:47]
    ds_read2_b32 v[62:63], v177 offset0:2 offset1:3
    v_mfma_f32_16x16x32_bf16 v[20:23], v[116:119], v[144:147], v[20:23]
    ds_read_b128 v[80:83], v180 offset:448
    v_mfma_f32_16x16x32_bf16 v[24:27], v[116:119], v[148:151], v[24:27]
    ds_read_b128 v[84:87], v180 offset:960
    v_mfma_f32_16x16x32_bf16 v[28:31], v[116:119], v[152:155], v[28:31]
    ds_read_b128 v[88:91], v180 offset:1472
    v_mfma_f32_16x16x32_bf16 v[32:35], v[116:119], v[156:159], v[32:35]
    ds_read_b128 v[92:95], v180 offset:1984
    v_mfma_f32_16x16x32_bf16 v[36:39], v[116:119], v[160:163], v[36:39]
    ds_read_b128 v[96:99], v180 offset:2496
    v_mfma_f32_16x16x32_bf16 v[40:43], v[116:119], v[164:167], v[40:43]
    ds_read_b128 v[100:103], v180 offset:3008
    v_mfma_f32_16x16x32_bf16 v[44:47], v[116:119], v[168:171], v[44:47]
    ds_read_b128 v[104:107], v180 offset:3520
    v_mfma_f32_16x16x32_bf16 v[24:27], v[120:123], v[144:147], v[24:27]
    ds_read_b128 v[108:111], v180 offset:4032
    v_mfma_f32_16x16x32_bf16 v[28:31], v[120:123], v[148:151], v[28:31]
    ds_read2_b32 v[64:65], v178 offset0:128 offset1:129
    v_mfma_f32_16x16x32_bf16 v[32:35], v[120:123], v[152:155], v[32:35]
    ds_read2_b32 v[66:67], v178 offset0:130 offset1:131
    v_mfma_f32_16x16x32_bf16 v[36:39], v[120:123], v[156:159], v[36:39]
    ds_read2_b32 v[68:69], v178 offset0:0 offset1:1
    v_mfma_f32_16x16x32_bf16 v[40:43], v[120:123], v[160:163], v[40:43]
    ds_read2_b32 v[70:71], v178 offset0:2 offset1:3
    v_mfma_f32_16x16x32_bf16 v[44:47], v[120:123], v[164:167], v[44:47]
    ds_read2_b32 v[72:73], v179 offset0:128 offset1:129
    v_mfma_f32_16x16x32_bf16 v[28:31], v[124:127], v[144:147], v[28:31]
    ds_read2_b32 v[74:75], v179 offset0:130 offset1:131
    v_mfma_f32_16x16x32_bf16 v[32:35], v[124:127], v[148:151], v[32:35]
    ds_read2_b32 v[76:77], v179 offset0:0 offset1:1
    v_mfma_f32_16x16x32_bf16 v[36:39], v[124:127], v[152:155], v[36:39]
    ds_read2_b32 v[78:79], v179 offset0:2 offset1:3
    v_mfma_f32_16x16x32_bf16 v[40:43], v[124:127], v[156:159], v[40:43]
    v_subrev_u32 v176, 64, v176
    v_mfma_f32_16x16x32_bf16 v[44:47], v[124:127], v[160:163], v[44:47]
    v_subrev_u32 v177, 64, v177
    v_mfma_f32_16x16x32_bf16 v[32:35], v[128:131], v[144:147], v[32:35]
    v_subrev_u32 v178, 64, v178
    v_mfma_f32_16x16x32_bf16 v[36:39], v[128:131], v[148:151], v[36:39]
    v_subrev_u32 v179, 64, v179
    v_mfma_f32_16x16x32_bf16 v[40:43], v[128:131], v[152:155], v[40:43]
    v_subrev_u32 v180, 64, v180
    v_mfma_f32_16x16x32_bf16 v[44:47], v[128:131], v[156:159], v[44:47]
    s_add_u32 s33, s33, 1
    v_mfma_f32_16x16x32_bf16 v[36:39], v[132:135], v[144:147], v[36:39]
    s_cmp_eq_u32 s33, 3
    v_mfma_f32_16x16x32_bf16 v[40:43], v[132:135], v[148:151], v[40:43]
    s_cselect_b32 s89, 4294958528, 64
    v_mfma_f32_16x16x32_bf16 v[44:47], v[132:135], v[152:155], v[44:47]
    s_cselect_b32 s90, 4294962240, 64
    v_mfma_f32_16x16x32_bf16 v[40:43], v[136:139], v[144:147], v[40:43]
    v_mfma_f32_16x16x32_bf16 v[44:47], v[136:139], v[148:151], v[44:47]
    v_mfma_f32_16x16x32_bf16 v[44:47], v[140:143], v[144:147], v[44:47]
    s_cmp_lt_u32 s33, 4
    s_waitcnt lgkmcnt(0)
    s_cbranch_scc1 L_cv_loop
    ds_read_b64 v[112:113], v181 offset:0
    ds_read_b64 v[114:115], v181 offset:512
    ds_read_b64 v[116:117], v181 offset:1024
    ds_read_b64 v[118:119], v181 offset:1536
    ds_read_b64 v[120:121], v181 offset:2048
    ds_read_b64 v[122:123], v181 offset:2560
    ds_read_b64 v[124:125], v181 offset:3072
    ds_read_b64 v[126:127], v181 offset:3584
    v_lshlrev_b32 v140, 16, v215
    v_mul_f32 v140, 0xbf317218, v140
    v_mov_b32 v215, v216
    v_mov_b32 v216, v217
    s_waitcnt lgkmcnt(6)
    v_lshlrev_b32 v130, 16, v112
    v_lshlrev_b32 v132, 16, v113
    v_lshlrev_b32 v134, 16, v114
    v_lshlrev_b32 v136, 16, v115
    v_and_b32 v131, 0xffff0000, v112
    v_and_b32 v133, 0xffff0000, v113
    v_and_b32 v135, 0xffff0000, v114
    v_and_b32 v137, 0xffff0000, v115
    v_pk_fma_f32 v[130:131], v[130:131], v[140:141], v[16:17] op_sel_hi:[1,0,1]
    v_pk_fma_f32 v[132:133], v[132:133], v[140:141], v[18:19] op_sel_hi:[1,0,1]
    v_pk_fma_f32 v[134:135], v[134:135], v[140:141], v[20:21] op_sel_hi:[1,0,1]
    v_pk_fma_f32 v[136:137], v[136:137], v[140:141], v[22:23] op_sel_hi:[1,0,1]
    v_cvt_pk_bf16_f32 v112, v130, v131
    v_cvt_pk_bf16_f32 v113, v132, v133
    v_cvt_pk_bf16_f32 v114, v134, v135
    v_cvt_pk_bf16_f32 v115, v136, v137
    s_waitcnt lgkmcnt(4)
    v_lshlrev_b32 v130, 16, v116
    v_lshlrev_b32 v132, 16, v117
    v_lshlrev_b32 v134, 16, v118
    v_lshlrev_b32 v136, 16, v119
    v_and_b32 v131, 0xffff0000, v116
    v_and_b32 v133, 0xffff0000, v117
    v_and_b32 v135, 0xffff0000, v118
    v_and_b32 v137, 0xffff0000, v119
    v_pk_fma_f32 v[130:131], v[130:131], v[140:141], v[24:25] op_sel_hi:[1,0,1]
    v_pk_fma_f32 v[132:133], v[132:133], v[140:141], v[26:27] op_sel_hi:[1,0,1]
    v_pk_fma_f32 v[134:135], v[134:135], v[140:141], v[28:29] op_sel_hi:[1,0,1]
    v_pk_fma_f32 v[136:137], v[136:137], v[140:141], v[30:31] op_sel_hi:[1,0,1]
    v_cvt_pk_bf16_f32 v116, v130, v131
    v_cvt_pk_bf16_f32 v117, v132, v133
    v_cvt_pk_bf16_f32 v118, v134, v135
    v_cvt_pk_bf16_f32 v119, v136, v137
    s_waitcnt lgkmcnt(2)
    v_lshlrev_b32 v130, 16, v120
    v_lshlrev_b32 v132, 16, v121
    v_lshlrev_b32 v134, 16, v122
    v_lshlrev_b32 v136, 16, v123
    v_and_b32 v131, 0xffff0000, v120
    v_and_b32 v133, 0xffff0000, v121
    v_and_b32 v135, 0xffff0000, v122
    v_and_b32 v137, 0xffff0000, v123
    v_pk_fma_f32 v[130:131], v[130:131], v[140:141], v[32:33] op_sel_hi:[1,0,1]
    v_pk_fma_f32 v[132:133], v[132:133], v[140:141], v[34:35] op_sel_hi:[1,0,1]
    v_pk_fma_f32 v[134:135], v[134:135], v[140:141], v[36:37] op_sel_hi:[1,0,1]
    v_pk_fma_f32 v[136:137], v[136:137], v[140:141], v[38:39] op_sel_hi:[1,0,1]
    v_cvt_pk_bf16_f32 v120, v130, v131
    v_cvt_pk_bf16_f32 v121, v132, v133
    v_cvt_pk_bf16_f32 v122, v134, v135
    v_cvt_pk_bf16_f32 v123, v136, v137
    s_waitcnt lgkmcnt(0)
    v_lshlrev_b32 v130, 16, v124
    v_lshlrev_b32 v132, 16, v125
    v_lshlrev_b32 v134, 16, v126
    v_lshlrev_b32 v136, 16, v127
    v_and_b32 v131, 0xffff0000, v124
    v_and_b32 v133, 0xffff0000, v125
    v_and_b32 v135, 0xffff0000, v126
    v_and_b32 v137, 0xffff0000, v127
    v_pk_fma_f32 v[130:131], v[130:131], v[140:141], v[40:41] op_sel_hi:[1,0,1]
    v_pk_fma_f32 v[132:133], v[132:133], v[140:141], v[42:43] op_sel_hi:[1,0,1]
    v_pk_fma_f32 v[134:135], v[134:135], v[140:141], v[44:45] op_sel_hi:[1,0,1]
    v_pk_fma_f32 v[136:137], v[136:137], v[140:141], v[46:47] op_sel_hi:[1,0,1]
    v_cvt_pk_bf16_f32 v124, v130, v131
    v_cvt_pk_bf16_f32 v125, v132, v133
    v_cvt_pk_bf16_f32 v126, v134, v135
    v_cvt_pk_bf16_f32 v127, v136, v137
    ds_write_b64 v181, v[112:113] offset:0
    ds_write_b64 v181, v[114:115] offset:512
    ds_write_b64 v181, v[116:117] offset:1024
    ds_write_b64 v181, v[118:119] offset:1536
    ds_write_b64 v181, v[120:121] offset:2048
    ds_write_b64 v181, v[122:123] offset:2560
    ds_write_b64 v181, v[124:125] offset:3072
    ds_write_b64 v181, v[126:127] offset:3584
    v_mov_b32 v16, 0
    v_mov_b32 v17, 0
    v_mov_b32 v18, 0
    v_mov_b32 v19, 0
    v_mov_b32 v20, 0
    v_mov_b32 v21, 0
    v_mov_b32 v22, 0
    v_mov_b32 v23, 0
    v_mov_b32 v24, 0
    v_mov_b32 v25, 0
    v_mov_b32 v26, 0
    v_mov_b32 v27, 0
    s_waitcnt lgkmcnt(0)
    s_barrier
    ds_read_b64_tr_b16 v[112:113], v182 offset:0
    ds_read_b64_tr_b16 v[114:115], v182 offset:128
    ds_read_b64_tr_b16 v[116:117], v182 offset:256
    ds_read_b64_tr_b16 v[118:119], v182 offset:384
    ds_read_b64_tr_b16 v[120:121], v182 offset:512
    ds_read_b64_tr_b16 v[122:123], v182 offset:640
    ds_read_b64_tr_b16 v[124:125], v182 offset:768
    ds_read_b64_tr_b16 v[126:127], v182 offset:896
    s_mov_b32 s33, s88
    v_add_u32 v181, 4608, v181
    v_add_u32 v182, 4608, v182
    s_add_u32 s88, s88, 128
    s_add_u32 s85, s85, 1
    v_mov_b32 v28, 0
    v_mov_b32 v29, 0
    v_mov_b32 v30, 0
    v_mov_b32 v31, 0
    v_mov_b32 v32, 0
    v_mov_b32 v33, 0
    v_mov_b32 v34, 0
    v_mov_b32 v35, 0
    v_mov_b32 v36, 0
    v_mov_b32 v37, 0
    v_mov_b32 v38, 0
    v_mov_b32 v39, 0
    v_mov_b32 v40, 0
    v_mov_b32 v41, 0
    v_mov_b32 v42, 0
    v_mov_b32 v43, 0
    v_mov_b32 v44, 0
    v_mov_b32 v45, 0
    v_mov_b32 v46, 0
    v_mov_b32 v47, 0
    s_waitcnt lgkmcnt(7)
    buffer_store_dwordx2 v[112:113], v234, s[44:47], s33 offen sc0 sc1
    s_add_u32 s33, s33, 73728
    s_waitcnt lgkmcnt(6)
    buffer_store_dwordx2 v[114:115], v234, s[44:47], s33 offen sc0 sc1
    s_add_u32 s33, s33, 73728
    s_waitcnt lgkmcnt(5)
    buffer_store_dwordx2 v[116:117], v234, s[44:47], s33 offen sc0 sc1
    s_add_u32 s33, s33, 73728
    s_waitcnt lgkmcnt(4)
    buffer_store_dwordx2 v[118:119], v234, s[44:47], s33 offen sc0 sc1
    s_add_u32 s33, s33, 73728
    s_waitcnt lgkmcnt(3)
    buffer_store_dwordx2 v[120:121], v234, s[44:47], s33 offen sc0 sc1
    s_add_u32 s33, s33, 73728
    s_waitcnt lgkmcnt(2)
    buffer_store_dwordx2 v[122:123], v234, s[44:47], s33 offen sc0 sc1
    s_add_u32 s33, s33, 73728
    s_waitcnt lgkmcnt(1)
    buffer_store_dwordx2 v[124:125], v234, s[44:47], s33 offen sc0 sc1
    s_add_u32 s33, s33, 73728
    s_waitcnt lgkmcnt(0)
    buffer_store_dwordx2 v[126:127], v234, s[44:47], s33 offen sc0 sc1
    s_cmp_lt_u32 s85, 3
    s_cbranch_scc1 L_cv_round
    s_waitcnt vmcnt(0)
    s_barrier
    s_cmp_lg_u32 s30, 0
    s_cbranch_scc1 L_cv_end
    s_add_u32 s54, s28, 33554560
    s_addc_u32 s55, s29, 0
    v_lshlrev_b32 v16, 11, v13
    v_mov_b32 v17, 1
    s_mov_b64 exec, 0x3ffffff
    global_atomic_add v16, v17, s[54:55] sc1
    s_mov_b64 exec, -1
L_cv_end:
    s_add_u32 s33, s99, 24576
    v_lshlrev_b32 v16, 7, v13
    v_mov_b32 v17, 0x40000000
    v_cmp_gt_u32 vcc, 16, v13
    s_mov_b32 s35, 0
    s_nop 0
    v_cndmask_b32 v17, v17, v16, vcc
L_sweep:
    s_mov_b32 s34, s33
    buffer_load_dword v18, v16, s[44:47], s34 offen sc1
    s_add_u32 s34, s34, 8192
    buffer_load_dword v18, v16, s[44:47], s34 offen sc1
    s_add_u32 s34, s34, 8192
    buffer_load_dword v18, v16, s[44:47], s34 offen sc1
    s_add_u32 s34, s34, 8192
    buffer_load_dword v18, v16, s[44:47], s34 offen sc1
    s_add_u32 s34, s34, 8192
    buffer_load_dword v18, v16, s[44:47], s34 offen sc1
    s_add_u32 s34, s34, 8192
    buffer_load_dword v18, v16, s[44:47], s34 offen sc1
    s_add_u32 s34, s34, 8192
    buffer_load_dword v18, v16, s[44:47], s34 offen sc1
    s_add_u32 s34, s34, 8192
    buffer_load_dword v18, v16, s[44:47], s34 offen sc1
    s_add_u32 s34, s34, 8192
    buffer_load_dword v18, v17, s[44:47], s34 offen sc1
    s_add_u32 s35, s35, 1
    s_cmp_lt_u32 s35, 1
    s_cbranch_scc1 L_sweep
    s_waitcnt vmcnt(0)
    s_endpgm
L_uhook1:
    s_mov_b64 exec, 0x3ffffff
    global_load_dword v221, v220, s[26:27] sc1
    s_mov_b64 exec, -1
    s_branch L_uhook1_back
    s_endpgm
L_ffn4:
    s_mov_b32 s31, s34
    s_mov_b32 s32, s33
    s_lshl_b32 s82, s34, 6
    s_add_u32 s82, s82, 384
    s_mul_i32 s85, s82, 1152
    s_mul_i32 s35, s32, 11520
    s_add_u32 s35, s35, s85
    s_add_u32 s85, s85, s30
    v_bfe_u32 v28, v0, 2, 4
    v_and_b32 v29, 3, v0
    v_lshlrev_b32 v2, 4, v29
    s_movk_i32 s34, 1152
    v_mad_u32_u24 v250, v28, s34, v2
    v_lshlrev_b32 v1, 7, v0
    s_bitcmp1_b32 s30, 7
    s_waitcnt lgkmcnt(0)
    s_mov_b32 s6, 2359296
    s_mov_b32 s7, 0x20000
    s_cbranch_scc1 L4_notouch
    buffer_load_dword v252, v1, s[4:7], s35 offen
L4_notouch:
    buffer_load_dwordx4 v[160:163], v250, s[4:7], s85 offen offset:0
    buffer_load_dwordx4 v[180:183], v250, s[4:7], s85 offen offset:256
    buffer_load_dwordx4 v[200:203], v250, s[4:7], s85 offen offset:512
    buffer_load_dwordx4 v[220:223], v250, s[4:7], s85 offen offset:768
    v_lshlrev_b32 v2, 3, v29
    s_lshr_b32 s34, s30, 1
    s_sub_u32 s34, 1024, s34
    v_sub_u32 v251, v250, v2
    v_add_u32 v251, s34, v251
    buffer_load_dwordx2 v[240:241], v251, s[4:7], s85 offen
    s_lshr_b32 s30, s30, 6
    v_and_b32 v13, 63, v0
    v_and_b32 v14, 15, v0
    v_bfe_u32 v15, v0, 4, 2
    s_getpc_b64 s[94:95]
L4_pcX:
    s_add_u32 s94, s94, L_pc0 - L4_pcX
    s_addc_u32 s95, s95, -1
    s_lshr_b32 s33, s2, 3
    s_mul_i32 s33, s33, 2560
    v_lshlrev_b32 v1, 7, v0
    v_add_u32 v1, s33, v1
    v_min_u32 v1, L_main_end - L_pc0, v1
    v_cmp_gt_u32 vcc, 20, v0
    s_and_saveexec_b64 s[54:55], vcc
    s_cbranch_execz L4_nocw
    global_load_dword v253, v1, s[94:95]
L4_nocw:
    s_mov_b64 exec, s[54:55]
    s_add_u32 s83, s82, 64
    s_mov_b32 s87, 0x3f803f80
    s_add_u32 s85, s85, 18432
    buffer_load_dwordx4 v[164:167], v250, s[4:7], s85 offen offset:0
    buffer_load_dwordx4 v[184:187], v250, s[4:7], s85 offen offset:256
    buffer_load_dwordx4 v[204:207], v250, s[4:7], s85 offen offset:512
    s_mov_b32 s40, s20
    s_and_b32 s41, s21, 0xffff
    s_mov_b32 s42, 5308416
    s_mov_b32 s43, 0x20000
    s_mov_b32 s44, s28
    s_and_b32 s45, s29, 0xffff
    s_mov_b32 s46, 268435456
    s_mov_b32 s47, 0x20000
    s_mov_b32 s56, s28
    s_and_b32 s57, s29, 0xffff
    s_mov_b32 s58, 2359296
    s_mov_b32 s59, 0x20000
    s_mul_i32 s58, s83, 1152
    s_mul_i32 s33, s32, 1152
    s_mov_b32 s48, 0x05040100
    s_mov_b32 s49, 0x07060302
    s_lshl_b32 s34, s30, 8
    v_lshlrev_b32 v32, 4, v14
    v_add_u32 v32, s34, v32
    s_mov_b32 s35, 73728
    v_mul_lo_u32 v1, v15, s35
    v_add3_u32 v1, v1, v32, s33
    v_mul_u32_u24 v33, 9216, v15
    v_add_u32 v12, v33, v32
    v_mul_u32_u24 v33, 4608, v15
    v_add_u32 v33, v33, v32
    v_accvgpr_write_b32 a246, v33
    buffer_load_dwordx4 v[224:227], v250, s[4:7], s85 offen offset:768
    v_add_u32 v2, 9216, v1
    v_add_u32 v3, 18432, v1
    v_add_u32 v4, 27648, v1
    v_add_u32 v5, 36864, v1
    v_add_u32 v6, 46080, v1
    v_add_u32 v7, 55296, v1
    v_add_u32 v8, 64512, v1
    v_lshrrev_b32 v32, 3, v13
    s_lshl_b32 s34, s30, 3
    v_add_u32 v32, s34, v32
    v_bfe_u32 v33, v32, 2, 2
    v_lshrrev_b32 v34, 4, v32
    v_lshl_add_u32 v33, v33, 1, v34
    v_and_b32 v34, 3, v32
    v_lshl_add_u32 v33, v33, 2, v34
    v_and_b32 v32, 6, v32
    v_and_b32 v34, 7, v13
    v_xor_b32 v32, v32, v34
    v_lshlrev_b32 v32, 4, v32
    v_add_u32 v32, 1024, v32
    v_mul_u32_u24 v34, 9216, v33
    v_add3_u32 v9, v34, v32, s33
    v_mul_u32_u24 v34, 1152, v33
    v_add_u32 v31, v34, v32
    s_lshl_b32 s34, s30, 5
    s_add_u32 s34, s34, 1024
    v_mul_u32_u24 v34, 1152, v14
    buffer_load_dwordx2 v[242:243], v251, s[4:7], s85 offen
    v_lshl_add_u32 v34, v15, 3, v34
    v_add_u32 v34, s34, v34
    v_accvgpr_write_b32 a247, v34
    v_lshrrev_b32 v11, 2, v14
    v_lshl_add_u32 v11, v15, 2, v11
    v_bfe_u32 v32, v11, 1, 2
    v_xor_b32 v32, s30, v32
    v_lshlrev_b32 v32, 5, v32
    v_lshl_add_u32 v11, v11, 7, v32
    v_and_b32 v32, 3, v14
    v_lshl_add_u32 v11, v32, 3, v11
    v_add_u32 v11, 92160, v11
    s_lshl_b32 s52, s30, 10
    s_add_u32 s52, s52, 88064
    v_lshrrev_b32 v32, 2, v14
    v_sub_u32 v32, 0, v32
    v_xor_b32 v33, v32, v15
    v_and_b32 v33, 3, v33
    v_lshl_add_u32 v33, v14, 2, v33
    v_lshlrev_b32 v10, 4, v33
    s_and_b32 s34, s30, 1
    s_lshl_b32 s34, s34, 1
    s_lshr_b32 s33, s30, 1
    s_mul_i32 s33, s33, 5120
    s_add_u32 s33, s33, 81920
    v_lshrrev_b32 v33, 1, v15
    v_add_u32 v33, s34, v33
    s_add_u32 s85, s85, 18432
    buffer_load_dwordx4 v[168:171], v250, s[4:7], s85 offen offset:0
    v_xor_b32 v33, v33, v32
    v_and_b32 v33, 3, v33
    v_lshl_add_u32 v33, v14, 2, v33
    v_lshlrev_b32 v33, 4, v33
    v_and_b32 v34, 1, v15
    v_lshl_add_u32 v33, v34, 3, v33
    v_add_u32 v33, s33, v33
    v_accvgpr_write_b32 a241, v33
    v_sub_u32 v32, 0, v15
    v_lshrrev_b32 v33, 1, v29
    v_add_u32 v33, s34, v33
    v_xor_b32 v33, v32, v33
    v_and_b32 v33, 3, v33
    v_lshl_add_u32 v33, v28, 2, v33
    v_lshlrev_b32 v33, 4, v33
    v_and_b32 v34, 1, v29
    v_lshl_add_u32 v33, v34, 3, v33
    v_add_u32 v35, s33, v33
    v_xor_b32 v33, v32, v29
    v_and_b32 v33, 3, v33
    v_lshl_add_u32 v33, v28, 2, v33
    v_lshlrev_b32 v33, 4, v33
    s_mul_i32 s33, s30, 5120
    v_add_u32 v26, s33, v33
    v_xor_b32 v33, v32, v14
    v_and_b32 v33, 3, v33
    v_lshl_add_u32 v33, v15, 4, v33
    buffer_load_dwordx4 v[188:191], v250, s[4:7], s85 offen offset:256
    v_lshlrev_b32 v33, 4, v33
    v_lshrrev_b32 v34, 2, v14
    v_mul_u32_u24 v34, 5120, v34
    s_mul_i32 s33, s30, 20480
    v_add3_u32 v33, v33, v34, s33
    v_accvgpr_write_b32 a240, v33
    v_lshlrev_b32 v33, 5, v28
    v_add_u32 v33, 116736, v33
    s_lshl_b32 s33, s30, 3
    v_add_u32 v27, s33, v33
    v_lshl_add_u32 v29, v29, 3, v33
    v_mov_b32 v28, v35
    s_and_b32 s33, s31, 3
    s_lshl_b32 s33, s33, 4
    s_lshr_b32 s34, s31, 2
    s_add_u32 s33, s33, s34
    s_lshl_b32 s81, s33, 2
    v_mov_b32 v36, 0x40000000
    v_cmp_gt_u32 vcc, 64, v0
    v_lshlrev_b32 v32, 4, v0
    v_accvgpr_write_b32 a244, v32
    v_add_u32 v32, 8192, v32
    v_cndmask_b32 v32, v36, v32, vcc
    v_accvgpr_write_b32 a245, v32
    s_mul_i32 s35, s32, 8
    s_add_u32 s96, s82, s35
    s_mul_i32 s86, s96, 1152
    buffer_load_dwordx4 v[208:211], v250, s[4:7], s85 offen offset:512
    s_mul_i32 s97, s32, 2396160
    s_mul_i32 s34, s31, 92160
    s_add_u32 s97, s97, s34
    s_add_u32 s97, s97, 8388608
    s_mov_b32 s33, 13108
    v_mul_u32_u24 v32, s33, v0
    v_lshrrev_b32 v32, 16, v32
    v_mul_u32_u24 v33, 5, v32
    v_sub_u32 v33, v0, v33
    v_mul_u32_u24 v34, 2304, v33
    v_mad_u32_u24 v34, v32, 24, v34
    v_add_u32 v35, 122880, v34
    v_lshl_add_u32 v33, v33, 1, s96
    v_lshrrev_b32 v34, 4, v33
    v_mul_u32_u24 v34, 18432, v34
    v_and_b32 v33, 15, v33
    v_lshl_add_u32 v34, v33, 3, v34
    v_mul_u32_u24 v32, 384, v32
    v_cmp_gt_u32 vcc, 240, v0
    v_add_u32 v34, v34, v32
    s_lshl_b32 s33, s32, 2
    v_cndmask_b32 v34, v36, v34, vcc
    v_accvgpr_write_b32 a248, v34
    v_mov_b32 v34, 135168
    v_cndmask_b32 v35, v34, v35, vcc
    v_accvgpr_write_b32 a249, v35
    s_add_u32 s89, s33, s30
    buffer_load_dwordx4 v[228:231], v250, s[4:7], s85 offen offset:768
    v_lshrrev_b32 v32, 5, v13
    v_bfe_u32 v33, v13, 4, 1
    v_bfe_u32 v34, v13, 2, 2
    v_bfe_u32 v35, v13, 1, 1
    v_lshl_add_u32 v35, v32, 1, v35
    v_lshl_add_u32 v34, v33, 3, v34
    v_and_b32 v36, 1, v13
    v_lshlrev_b32 v36, 3, v36
    v_lshl_add_u32 v36, v34, 6, v36
    v_lshlrev_b32 v34, 1, v33
    v_sub_u32 v34, 0, v34
    v_xor_b32 v34, v34, v35
    v_and_b32 v34, 3, v34
    v_lshl_add_u32 v0, v34, 4, v36
    v_lshl_add_u32 v30, v32, 4, v14
    v_lshlrev_b32 v30, 5, v30
    v_lshl_add_u32 v30, v33, 4, v30
    s_lshl_b32 s33, s31, 11
    s_add_u32 s33, s33, 33554432
    s_add_u32 s100, s28, s33
    s_addc_u32 s101, s29, 0
    s_lshr_b32 s88, s82, 4
    s_mul_i32 s88, s88, 18432
    s_add_u32 s33, s89, 0
    s_lshl_b32 s90, s33, 10
    s_mul_i32 s34, s33, 13108
    s_lshr_b32 s34, s34, 16
    s_mul_i32 s35, s34, 91136
    buffer_load_dwordx2 v[244:245], v251, s[4:7], s85 offen
    s_mul_i32 s33, s33, 18432
    s_sub_u32 s33, s33, s35
    s_add_u32 s60, s33, s88
    s_add_u32 s33, s89, 32
    s_lshl_b32 s91, s33, 10
    s_mul_i32 s34, s33, 13108
    s_lshr_b32 s34, s34, 16
    s_mul_i32 s35, s34, 91136
    s_mul_i32 s33, s33, 18432
    s_sub_u32 s33, s33, s35
    s_add_u32 s61, s33, s88
    s_add_u32 s33, s89, 64
    s_lshl_b32 s92, s33, 10
    s_mul_i32 s34, s33, 13108
    s_lshr_b32 s34, s34, 16
    s_mul_i32 s35, s34, 91136
    s_mul_i32 s33, s33, 18432
    s_sub_u32 s33, s33, s35
    s_add_u32 s62, s33, s88
    s_cmp_ge_u32 s89, 26
    s_cselect_b32 s62, 0x40000000, s62
    s_add_u32 s85, s85, 18432
    buffer_load_dwordx4 v[172:175], v250, s[4:7], s85 offen offset:0
    buffer_load_dwordx4 v[192:195], v250, s[4:7], s85 offen offset:256
    s_waitcnt vmcnt(12)
    v_dot2_f32_bf16 v16, v160, s87, 0
    v_dot2_f32_bf16 v17, v160, v160, 0
    v_dot2_f32_bf16 v16, v161, s87, v16
    v_dot2_f32_bf16 v17, v161, v161, v17
    v_dot2_f32_bf16 v16, v162, s87, v16
    v_dot2_f32_bf16 v17, v162, v162, v17
    v_dot2_f32_bf16 v16, v163, s87, v16
    v_dot2_f32_bf16 v17, v163, v163, v17
    v_dot2_f32_bf16 v16, v180, s87, v16
    v_dot2_f32_bf16 v17, v180, v180, v17
    v_dot2_f32_bf16 v16, v181, s87, v16
    v_dot2_f32_bf16 v17, v181, v181, v17
    v_dot2_f32_bf16 v16, v182, s87, v16
    v_dot2_f32_bf16 v17, v182, v182, v17
    v_dot2_f32_bf16 v16, v183, s87, v16
    v_dot2_f32_bf16 v17, v183, v183, v17
    v_dot2_f32_bf16 v16, v200, s87, v16
    v_dot2_f32_bf16 v17, v200, v200, v17
    v_dot2_f32_bf16 v16, v201, s87, v16
    v_dot2_f32_bf16 v17, v201, v201, v17
    v_dot2_f32_bf16 v16, v202, s87, v16
    v_dot2_f32_bf16 v17, v202, v202, v17
    v_dot2_f32_bf16 v16, v203, s87, v16
    v_dot2_f32_bf16 v17, v203, v203, v17
    v_dot2_f32_bf16 v16, v220, s87, v16
    v_dot2_f32_bf16 v17, v220, v220, v17
    v_dot2_f32_bf16 v16, v221, s87, v16
    v_dot2_f32_bf16 v17, v221, v221, v17
    v_dot2_f32_bf16 v16, v222, s87, v16
    v_dot2_f32_bf16 v17, v222, v222, v17
    v_dot2_f32_bf16 v16, v223, s87, v16
    v_dot2_f32_bf16 v17, v223, v223, v17
    v_dot2_f32_bf16 v16, v240, s87, v16
    v_dot2_f32_bf16 v17, v240, v240, v17
    v_dot2_f32_bf16 v16, v241, s87, v16
    v_dot2_f32_bf16 v17, v241, v241, v17
    buffer_load_dwordx4 v[212:215], v250, s[4:7], s85 offen offset:512
    buffer_load_dwordx4 v[232:235], v250, s[4:7], s85 offen offset:768
    s_waitcnt vmcnt(9)
    v_dot2_f32_bf16 v18, v164, s87, 0
    v_dot2_f32_bf16 v19, v164, v164, 0
    v_dot2_f32_bf16 v18, v165, s87, v18
    v_dot2_f32_bf16 v19, v165, v165, v19
    v_dot2_f32_bf16 v18, v166, s87, v18
    v_dot2_f32_bf16 v19, v166, v166, v19
    v_dot2_f32_bf16 v18, v167, s87, v18
    v_dot2_f32_bf16 v19, v167, v167, v19
    v_dot2_f32_bf16 v18, v184, s87, v18
    v_dot2_f32_bf16 v19, v184, v184, v19
    v_dot2_f32_bf16 v18, v185, s87, v18
    v_dot2_f32_bf16 v19, v185, v185, v19
    v_dot2_f32_bf16 v18, v186, s87, v18
    v_dot2_f32_bf16 v19, v186, v186, v19
    v_dot2_f32_bf16 v18, v187, s87, v18
    v_dot2_f32_bf16 v19, v187, v187, v19
    v_dot2_f32_bf16 v18, v204, s87, v18
    v_dot2_f32_bf16 v19, v204, v204, v19
    v_dot2_f32_bf16 v18, v205, s87, v18
    v_dot2_f32_bf16 v19, v205, v205, v19
    v_dot2_f32_bf16 v18, v206, s87, v18
    v_dot2_f32_bf16 v19, v206, v206, v19
    v_dot2_f32_bf16 v18, v207, s87, v18
    v_dot2_f32_bf16 v19, v207, v207, v19
    v_dot2_f32_bf16 v18, v224, s87, v18
    v_dot2_f32_bf16 v19, v224, v224, v19
    v_dot2_f32_bf16 v18, v225, s87, v18
    v_dot2_f32_bf16 v19, v225, v225, v19
    v_dot2_f32_bf16 v18, v226, s87, v18
    v_dot2_f32_bf16 v19, v226, v226, v19
    v_dot2_f32_bf16 v18, v227, s87, v18
    v_dot2_f32_bf16 v19, v227, v227, v19
    v_dot2_f32_bf16 v18, v242, s87, v18
    v_dot2_f32_bf16 v19, v242, v242, v19
    v_dot2_f32_bf16 v18, v243, s87, v18
    v_dot2_f32_bf16 v19, v243, v243, v19
    buffer_load_dwordx2 v[246:247], v251, s[4:7], s85 offen
    s_waitcnt vmcnt(5)
    v_dot2_f32_bf16 v20, v168, s87, 0
    v_dot2_f32_bf16 v21, v168, v168, 0
    v_dot2_f32_bf16 v20, v169, s87, v20
    v_dot2_f32_bf16 v21, v169, v169, v21
    v_dot2_f32_bf16 v20, v170, s87, v20
    v_dot2_f32_bf16 v21, v170, v170, v21
    v_dot2_f32_bf16 v20, v171, s87, v20
    v_dot2_f32_bf16 v21, v171, v171, v21
    v_dot2_f32_bf16 v20, v188, s87, v20
    s_mov_b32 s50, 0
    s_nop 0
    buffer_load_dwordx4 v[32:35], v1, s[40:43], s50 offen
    v_dot2_f32_bf16 v21, v188, v188, v21
    v_dot2_f32_bf16 v20, v189, s87, v20
    v_dot2_f32_bf16 v21, v189, v189, v21
    v_dot2_f32_bf16 v20, v190, s87, v20
    v_dot2_f32_bf16 v21, v190, v190, v21
    v_dot2_f32_bf16 v20, v191, s87, v20
    v_dot2_f32_bf16 v21, v191, v191, v21
    v_dot2_f32_bf16 v20, v208, s87, v20
    v_dot2_f32_bf16 v21, v208, v208, v21
    buffer_load_dwordx4 v[36:39], v2, s[40:43], s50 offen
    v_dot2_f32_bf16 v20, v209, s87, v20
    v_dot2_f32_bf16 v21, v209, v209, v21
    v_dot2_f32_bf16 v20, v210, s87, v20
    v_dot2_f32_bf16 v21, v210, v210, v21
    v_dot2_f32_bf16 v20, v211, s87, v20
    v_dot2_f32_bf16 v21, v211, v211, v21
    v_dot2_f32_bf16 v20, v228, s87, v20
    v_dot2_f32_bf16 v21, v228, v228, v21
    v_dot2_f32_bf16 v20, v229, s87, v20
    buffer_load_dwordx4 v[40:43], v3, s[40:43], s50 offen
    v_dot2_f32_bf16 v21, v229, v229, v21
    v_dot2_f32_bf16 v20, v230, s87, v20
    v_dot2_f32_bf16 v21, v230, v230, v21
    v_dot2_f32_bf16 v20, v231, s87, v20
    v_dot2_f32_bf16 v21, v231, v231, v21
    v_dot2_f32_bf16 v20, v244, s87, v20
    v_dot2_f32_bf16 v21, v244, v244, v21
    v_dot2_f32_bf16 v20, v245, s87, v20
    v_dot2_f32_bf16 v21, v245, v245, v21
    buffer_load_dwordx4 v[44:47], v4, s[40:43], s50 offen
    s_waitcnt vmcnt(4)
    v_dot2_f32_bf16 v22, v172, s87, 0
    v_dot2_f32_bf16 v23, v172, v172, 0
    v_dot2_f32_bf16 v22, v173, s87, v22
    v_dot2_f32_bf16 v23, v173, v173, v23
    v_dot2_f32_bf16 v22, v174, s87, v22
    v_dot2_f32_bf16 v23, v174, v174, v23
    v_dot2_f32_bf16 v22, v175, s87, v22
    v_dot2_f32_bf16 v23, v175, v175, v23
    v_dot2_f32_bf16 v22, v192, s87, v22
    buffer_load_dwordx4 v[48:51], v5, s[40:43], s50 offen
    v_dot2_f32_bf16 v23, v192, v192, v23
    v_dot2_f32_bf16 v22, v193, s87, v22
    v_dot2_f32_bf16 v23, v193, v193, v23
    v_dot2_f32_bf16 v22, v194, s87, v22
    v_dot2_f32_bf16 v23, v194, v194, v23
    v_dot2_f32_bf16 v22, v195, s87, v22
    v_dot2_f32_bf16 v23, v195, v195, v23
    v_dot2_f32_bf16 v22, v212, s87, v22
    v_dot2_f32_bf16 v23, v212, v212, v23
    buffer_load_dwordx4 v[52:55], v6, s[40:43], s50 offen
    v_dot2_f32_bf16 v22, v213, s87, v22
    v_dot2_f32_bf16 v23, v213, v213, v23
    v_dot2_f32_bf16 v22, v214, s87, v22
    v_dot2_f32_bf16 v23, v214, v214, v23
    v_dot2_f32_bf16 v22, v215, s87, v22
    v_dot2_f32_bf16 v23, v215, v215, v23
    v_dot2_f32_bf16 v22, v232, s87, v22
    v_dot2_f32_bf16 v23, v232, v232, v23
    v_dot2_f32_bf16 v22, v233, s87, v22
    buffer_load_dwordx4 v[56:59], v7, s[40:43], s50 offen
    v_dot2_f32_bf16 v23, v233, v233, v23
    v_dot2_f32_bf16 v22, v234, s87, v22
    v_dot2_f32_bf16 v23, v234, v234, v23
    v_dot2_f32_bf16 v22, v235, s87, v22
    v_dot2_f32_bf16 v23, v235, v235, v23
    v_dot2_f32_bf16 v22, v246, s87, v22
    v_dot2_f32_bf16 v23, v246, v246, v23
    v_dot2_f32_bf16 v22, v247, s87, v22
    v_dot2_f32_bf16 v23, v247, v247, v23
    s_add_u32 m0, s52, 4096
    buffer_load_dwordx4 v[60:63], v8, s[40:43], s50 offen
    s_nop 2
    v_add_f32_dpp v16, v16, v16 quad_perm:[1,0,3,2] row_mask:0xf bank_mask:0xf
    v_add_f32_dpp v17, v17, v17 quad_perm:[1,0,3,2] row_mask:0xf bank_mask:0xf
    v_add_f32_dpp v18, v18, v18 quad_perm:[1,0,3,2] row_mask:0xf bank_mask:0xf
    v_add_f32_dpp v19, v19, v19 quad_perm:[1,0,3,2] row_mask:0xf bank_mask:0xf
    v_add_f32_dpp v20, v20, v20 quad_perm:[1,0,3,2] row_mask:0xf bank_mask:0xf
    v_add_f32_dpp v21, v21, v21 quad_perm:[1,0,3,2] row_mask:0xf bank_mask:0xf
    v_add_f32_dpp v22, v22, v22 quad_perm:[1,0,3,2] row_mask:0xf bank_mask:0xf
    v_add_f32_dpp v23, v23, v23 quad_perm:[1,0,3,2] row_mask:0xf bank_mask:0xf
    v_add_f32_dpp v16, v16, v16 quad_perm:[2,3,0,1] row_mask:0xf bank_mask:0xf
    v_add_f32_dpp v17, v17, v17 quad_perm:[2,3,0,1] row_mask:0xf bank_mask:0xf
    v_add_f32_dpp v18, v18, v18 quad_perm:[2,3,0,1] row_mask:0xf bank_mask:0xf
    v_add_f32_dpp v19, v19, v19 quad_perm:[2,3,0,1] row_mask:0xf bank_mask:0xf
    v_add_f32_dpp v20, v20, v20 quad_perm:[2,3,0,1] row_mask:0xf bank_mask:0xf
    v_add_f32_dpp v21, v21, v21 quad_perm:[2,3,0,1] row_mask:0xf bank_mask:0xf
    v_add_f32_dpp v22, v22, v22 quad_perm:[2,3,0,1] row_mask:0xf bank_mask:0xf
    v_add_f32_dpp v23, v23, v23 quad_perm:[2,3,0,1] row_mask:0xf bank_mask:0xf
    s_mov_b32 s34, 0x11111111
    s_mov_b32 exec_lo, s34
    s_mov_b32 exec_hi, s34
    ds_write_b64 v27, v[16:17] offset:0
    ds_write_b64 v27, v[18:19] offset:512
    ds_write_b64 v27, v[20:21] offset:1024
    ds_write_b64 v27, v[22:23] offset:1536
    s_mov_b64 exec, -1
    buffer_load_dwordx4 v9, s[40:43], s50 offen lds
    s_mov_b32 s50, 294912
    buffer_load_dwordx4 v[64:67], v1, s[40:43], s50 offen
    v_and_b32 v250, 3, v13
    v_mul_u32_u24 v250, 504, v250
    v_add_u32 v250, v250, v29
    s_waitcnt lgkmcnt(0)
    s_barrier
    ds_read_b128 v[16:19], v250
    ds_read_b128 v[20:23], v250 offset:16
    buffer_load_dwordx4 v[68:71], v2, s[40:43], s50 offen
    buffer_load_dwordx4 v[72:75], v3, s[40:43], s50 offen
    s_mov_b32 s33, 0x3ae38e39
    s_mov_b32 s34, 0x3727c5ac
    s_mov_b32 s35, 3216550459
    s_waitcnt lgkmcnt(0)
    v_pk_add_f32 v[16:17], v[16:17], v[18:19]
    v_pk_add_f32 v[20:21], v[20:21], v[22:23]
    v_pk_add_f32 v[250:251], v[16:17], v[20:21]
    v_pk_mul_f32 v[250:251], v[250:251], s[32:33] op_sel:[0,1] op_sel_hi:[1,1]
    v_fma_f32 v251, -v250, v250, v251
    v_max_f32 v251, 0, v251
    v_cvt_pk_bf16_f32 v251, v251, v250
    v_and_b32 v250, 0xffff0000, v251
    v_lshlrev_b32 v251, 16, v251
    v_add_f32 v251, s34, v251
    v_cvt_pk_bf16_f32 v251, v251, v251
    v_lshlrev_b32 v251, 16, v251
    v_sqrt_f32 v251, v251
    s_nop 0
    v_cvt_pk_bf16_f32 v251, v251, v251
    v_lshlrev_b32 v251, 16, v251
    v_rcp_f32 v251, v251
    s_nop 0
    v_mul_f32 v251, s35, v251
    v_mul_f32 v250, v250, v251
    s_nop 1
    v_mov_b32_dpp v17, v251 quad_perm:[0,0,0,0] row_mask:0xf bank_mask:0xf
    v_mov_b32_dpp v16, v250 quad_perm:[0,0,0,0] row_mask:0xf bank_mask:0xf
    v_mov_b32_dpp v19, v251 quad_perm:[1,1,1,1] row_mask:0xf bank_mask:0xf
    v_mov_b32_dpp v18, v250 quad_perm:[1,1,1,1] row_mask:0xf bank_mask:0xf
    v_mov_b32_dpp v21, v251 quad_perm:[2,2,2,2] row_mask:0xf bank_mask:0xf
    v_mov_b32_dpp v20, v250 quad_perm:[2,2,2,2] row_mask:0xf bank_mask:0xf
    v_mov_b32_dpp v23, v251 quad_perm:[3,3,3,3] row_mask:0xf bank_mask:0xf
    v_mov_b32_dpp v22, v250 quad_perm:[3,3,3,3] row_mask:0xf bank_mask:0xf
    v_lshlrev_b32 v250, 16, v160
    v_lshlrev_b32 v252, 16, v161
    v_and_b32 v251, 0xffff0000, v160
    v_and_b32 v253, 0xffff0000, v161
    v_pk_fma_f32 v[250:251], v[250:251], v[16:17], v[16:17] op_sel:[0,1,0] op_sel_hi:[1,1,0] neg_lo:[0,0,1] neg_hi:[0,0,1]
    v_pk_fma_f32 v[252:253], v[252:253], v[16:17], v[16:17] op_sel:[0,1,0] op_sel_hi:[1,1,0] neg_lo:[0,0,1] neg_hi:[0,0,1]
    v_cvt_pk_bf16_f32 v160, v250, v251
    v_cvt_pk_bf16_f32 v161, v252, v253
    buffer_load_dwordx4 v[76:79], v4, s[40:43], s50 offen
    v_lshlrev_b32 v250, 16, v162
    v_lshlrev_b32 v252, 16, v163
    v_and_b32 v251, 0xffff0000, v162
    v_and_b32 v253, 0xffff0000, v163
    v_pk_fma_f32 v[250:251], v[250:251], v[16:17], v[16:17] op_sel:[0,1,0] op_sel_hi:[1,1,0] neg_lo:[0,0,1] neg_hi:[0,0,1]
    v_pk_fma_f32 v[252:253], v[252:253], v[16:17], v[16:17] op_sel:[0,1,0] op_sel_hi:[1,1,0] neg_lo:[0,0,1] neg_hi:[0,0,1]
    v_cvt_pk_bf16_f32 v162, v250, v251
    v_cvt_pk_bf16_f32 v163, v252, v253
    ds_write_b128 v26, v[160:163] offset:0
    buffer_load_dwordx4 v[80:83], v5, s[40:43], s50 offen
    v_lshlrev_b32 v250, 16, v164
    v_lshlrev_b32 v252, 16, v165
    v_and_b32 v251, 0xffff0000, v164
    v_and_b32 v253, 0xffff0000, v165
    v_pk_fma_f32 v[250:251], v[250:251], v[18:19], v[18:19] op_sel:[0,1,0] op_sel_hi:[1,1,0] neg_lo:[0,0,1] neg_hi:[0,0,1]
    v_pk_fma_f32 v[252:253], v[252:253], v[18:19], v[18:19] op_sel:[0,1,0] op_sel_hi:[1,1,0] neg_lo:[0,0,1] neg_hi:[0,0,1]
    v_cvt_pk_bf16_f32 v164, v250, v251
    v_cvt_pk_bf16_f32 v165, v252, v253
    buffer_load_dwordx4 v[84:87], v6, s[40:43], s50 offen
    v_lshlrev_b32 v250, 16, v166
    v_lshlrev_b32 v252, 16, v167
    v_and_b32 v251, 0xffff0000, v166
    v_and_b32 v253, 0xffff0000, v167
    v_pk_fma_f32 v[250:251], v[250:251], v[18:19], v[18:19] op_sel:[0,1,0] op_sel_hi:[1,1,0] neg_lo:[0,0,1] neg_hi:[0,0,1]
    v_pk_fma_f32 v[252:253], v[252:253], v[18:19], v[18:19] op_sel:[0,1,0] op_sel_hi:[1,1,0] neg_lo:[0,0,1] neg_hi:[0,0,1]
    v_cvt_pk_bf16_f32 v166, v250, v251
    v_cvt_pk_bf16_f32 v167, v252, v253
    ds_write_b128 v26, v[164:167] offset:1024
    buffer_load_dwordx4 v[88:91], v7, s[40:43], s50 offen
    v_lshlrev_b32 v250, 16, v168
    v_lshlrev_b32 v252, 16, v169
    v_and_b32 v251, 0xffff0000, v168
    v_and_b32 v253, 0xffff0000, v169
    v_pk_fma_f32 v[250:251], v[250:251], v[20:21], v[20:21] op_sel:[0,1,0] op_sel_hi:[1,1,0] neg_lo:[0,0,1] neg_hi:[0,0,1]
    v_pk_fma_f32 v[252:253], v[252:253], v[20:21], v[20:21] op_sel:[0,1,0] op_sel_hi:[1,1,0] neg_lo:[0,0,1] neg_hi:[0,0,1]
    v_cvt_pk_bf16_f32 v168, v250, v251
    v_cvt_pk_bf16_f32 v169, v252, v253
    s_add_u32 m0, s52, 8192
    buffer_load_dwordx4 v[92:95], v8, s[40:43], s50 offen
    v_lshlrev_b32 v250, 16, v170
    v_lshlrev_b32 v252, 16, v171
    v_and_b32 v251, 0xffff0000, v170
    v_and_b32 v253, 0xffff0000, v171
    v_pk_fma_f32 v[250:251], v[250:251], v[20:21], v[20:21] op_sel:[0,1,0] op_sel_hi:[1,1,0] neg_lo:[0,0,1] neg_hi:[0,0,1]
    v_pk_fma_f32 v[252:253], v[252:253], v[20:21], v[20:21] op_sel:[0,1,0] op_sel_hi:[1,1,0] neg_lo:[0,0,1] neg_hi:[0,0,1]
    v_cvt_pk_bf16_f32 v170, v250, v251
    v_cvt_pk_bf16_f32 v171, v252, v253
    ds_write_b128 v26, v[168:171] offset:2048
    buffer_load_dwordx4 v9, s[40:43], s50 offen lds
    v_lshlrev_b32 v250, 16, v172
    v_lshlrev_b32 v252, 16, v173
    v_and_b32 v251, 0xffff0000, v172
    v_and_b32 v253, 0xffff0000, v173
    v_pk_fma_f32 v[250:251], v[250:251], v[22:23], v[22:23] op_sel:[0,1,0] op_sel_hi:[1,1,0] neg_lo:[0,0,1] neg_hi:[0,0,1]
    v_pk_fma_f32 v[252:253], v[252:253], v[22:23], v[22:23] op_sel:[0,1,0] op_sel_hi:[1,1,0] neg_lo:[0,0,1] neg_hi:[0,0,1]
    v_cvt_pk_bf16_f32 v172, v250, v251
    v_cvt_pk_bf16_f32 v173, v252, v253
    s_mov_b32 s50, 589824
    buffer_load_dwordx4 v[96:99], v1, s[40:43], s50 offen
    v_lshlrev_b32 v250, 16, v174
    v_lshlrev_b32 v252, 16, v175
    v_and_b32 v251, 0xffff0000, v174
    v_and_b32 v253, 0xffff0000, v175
    v_pk_fma_f32 v[250:251], v[250:251], v[22:23], v[22:23] op_sel:[0,1,0] op_sel_hi:[1,1,0] neg_lo:[0,0,1] neg_hi:[0,0,1]
    v_pk_fma_f32 v[252:253], v[252:253], v[22:23], v[22:23] op_sel:[0,1,0] op_sel_hi:[1,1,0] neg_lo:[0,0,1] neg_hi:[0,0,1]
    v_cvt_pk_bf16_f32 v174, v250, v251
    v_cvt_pk_bf16_f32 v175, v252, v253
    ds_write_b128 v26, v[172:175] offset:3072
    buffer_load_dwordx4 v[100:103], v2, s[40:43], s50 offen
    v_lshlrev_b32 v250, 16, v180
    v_lshlrev_b32 v252, 16, v181
    v_and_b32 v251, 0xffff0000, v180
    v_and_b32 v253, 0xffff0000, v181
    v_pk_fma_f32 v[250:251], v[250:251], v[16:17], v[16:17] op_sel:[0,1,0] op_sel_hi:[1,1,0] neg_lo:[0,0,1] neg_hi:[0,0,1]
    v_pk_fma_f32 v[252:253], v[252:253], v[16:17], v[16:17] op_sel:[0,1,0] op_sel_hi:[1,1,0] neg_lo:[0,0,1] neg_hi:[0,0,1]
    v_cvt_pk_bf16_f32 v180, v250, v251
    v_cvt_pk_bf16_f32 v181, v252, v253
    buffer_load_dwordx4 v[104:107], v3, s[40:43], s50 offen
    v_lshlrev_b32 v250, 16, v182
    v_lshlrev_b32 v252, 16, v183
    v_and_b32 v251, 0xffff0000, v182
    v_and_b32 v253, 0xffff0000, v183
    v_pk_fma_f32 v[250:251], v[250:251], v[16:17], v[16:17] op_sel:[0,1,0] op_sel_hi:[1,1,0] neg_lo:[0,0,1] neg_hi:[0,0,1]
    v_pk_fma_f32 v[252:253], v[252:253], v[16:17], v[16:17] op_sel:[0,1,0] op_sel_hi:[1,1,0] neg_lo:[0,0,1] neg_hi:[0,0,1]
    v_cvt_pk_bf16_f32 v182, v250, v251
    v_cvt_pk_bf16_f32 v183, v252, v253
    ds_write_b128 v26, v[180:183] offset:20480
    v_lshlrev_b32 v250, 16, v184
    v_lshlrev_b32 v252, 16, v185
    v_and_b32 v251, 0xffff0000, v184
    v_and_b32 v253, 0xffff0000, v185
    v_pk_fma_f32 v[250:251], v[250:251], v[18:19], v[18:19] op_sel:[0,1,0] op_sel_hi:[1,1,0] neg_lo:[0,0,1] neg_hi:[0,0,1]
    v_pk_fma_f32 v[252:253], v[252:253], v[18:19], v[18:19] op_sel:[0,1,0] op_sel_hi:[1,1,0] neg_lo:[0,0,1] neg_hi:[0,0,1]
    v_cvt_pk_bf16_f32 v184, v250, v251
    v_cvt_pk_bf16_f32 v185, v252, v253
    buffer_load_dwordx4 v[108:111], v4, s[40:43], s50 offen
    v_lshlrev_b32 v250, 16, v186
    v_lshlrev_b32 v252, 16, v187
    v_and_b32 v251, 0xffff0000, v186
    v_and_b32 v253, 0xffff0000, v187
    v_pk_fma_f32 v[250:251], v[250:251], v[18:19], v[18:19] op_sel:[0,1,0] op_sel_hi:[1,1,0] neg_lo:[0,0,1] neg_hi:[0,0,1]
    v_pk_fma_f32 v[252:253], v[252:253], v[18:19], v[18:19] op_sel:[0,1,0] op_sel_hi:[1,1,0] neg_lo:[0,0,1] neg_hi:[0,0,1]
    v_cvt_pk_bf16_f32 v186, v250, v251
    v_cvt_pk_bf16_f32 v187, v252, v253
    ds_write_b128 v26, v[184:187] offset:21504
    buffer_load_dwordx4 v[112:115], v5, s[40:43], s50 offen
    v_lshlrev_b32 v250, 16, v188
    v_lshlrev_b32 v252, 16, v189
    v_and_b32 v251, 0xffff0000, v188
    v_and_b32 v253, 0xffff0000, v189
    v_pk_fma_f32 v[250:251], v[250:251], v[20:21], v[20:21] op_sel:[0,1,0] op_sel_hi:[1,1,0] neg_lo:[0,0,1] neg_hi:[0,0,1]
    v_pk_fma_f32 v[252:253], v[252:253], v[20:21], v[20:21] op_sel:[0,1,0] op_sel_hi:[1,1,0] neg_lo:[0,0,1] neg_hi:[0,0,1]
    v_cvt_pk_bf16_f32 v188, v250, v251
    v_cvt_pk_bf16_f32 v189, v252, v253
    buffer_load_dwordx4 v[116:119], v6, s[40:43], s50 offen
    v_lshlrev_b32 v250, 16, v190
    v_lshlrev_b32 v252, 16, v191
    v_and_b32 v251, 0xffff0000, v190
    v_and_b32 v253, 0xffff0000, v191
    v_pk_fma_f32 v[250:251], v[250:251], v[20:21], v[20:21] op_sel:[0,1,0] op_sel_hi:[1,1,0] neg_lo:[0,0,1] neg_hi:[0,0,1]
    v_pk_fma_f32 v[252:253], v[252:253], v[20:21], v[20:21] op_sel:[0,1,0] op_sel_hi:[1,1,0] neg_lo:[0,0,1] neg_hi:[0,0,1]
    v_cvt_pk_bf16_f32 v190, v250, v251
    v_cvt_pk_bf16_f32 v191, v252, v253
    ds_write_b128 v26, v[188:191] offset:22528
    buffer_load_dwordx4 v[120:123], v7, s[40:43], s50 offen
    v_lshlrev_b32 v250, 16, v192
    v_lshlrev_b32 v252, 16, v193
    v_and_b32 v251, 0xffff0000, v192
    v_and_b32 v253, 0xffff0000, v193
    v_pk_fma_f32 v[250:251], v[250:251], v[22:23], v[22:23] op_sel:[0,1,0] op_sel_hi:[1,1,0] neg_lo:[0,0,1] neg_hi:[0,0,1]
    v_pk_fma_f32 v[252:253], v[252:253], v[22:23], v[22:23] op_sel:[0,1,0] op_sel_hi:[1,1,0] neg_lo:[0,0,1] neg_hi:[0,0,1]
    v_cvt_pk_bf16_f32 v192, v250, v251
    v_cvt_pk_bf16_f32 v193, v252, v253
    s_add_u32 m0, s52, 12288
    buffer_load_dwordx4 v[124:127], v8, s[40:43], s50 offen
    v_lshlrev_b32 v250, 16, v194
    v_lshlrev_b32 v252, 16, v195
    v_and_b32 v251, 0xffff0000, v194
    v_and_b32 v253, 0xffff0000, v195
    v_pk_fma_f32 v[250:251], v[250:251], v[22:23], v[22:23] op_sel:[0,1,0] op_sel_hi:[1,1,0] neg_lo:[0,0,1] neg_hi:[0,0,1]
    v_pk_fma_f32 v[252:253], v[252:253], v[22:23], v[22:23] op_sel:[0,1,0] op_sel_hi:[1,1,0] neg_lo:[0,0,1] neg_hi:[0,0,1]
    v_cvt_pk_bf16_f32 v194, v250, v251
    v_cvt_pk_bf16_f32 v195, v252, v253
    ds_write_b128 v26, v[192:195] offset:23552
    buffer_load_dwordx4 v9, s[40:43], s50 offen lds
    v_lshlrev_b32 v250, 16, v200
    v_lshlrev_b32 v252, 16, v201
    v_and_b32 v251, 0xffff0000, v200
    v_and_b32 v253, 0xffff0000, v201
    v_pk_fma_f32 v[250:251], v[250:251], v[16:17], v[16:17] op_sel:[0,1,0] op_sel_hi:[1,1,0] neg_lo:[0,0,1] neg_hi:[0,0,1]
    v_pk_fma_f32 v[252:253], v[252:253], v[16:17], v[16:17] op_sel:[0,1,0] op_sel_hi:[1,1,0] neg_lo:[0,0,1] neg_hi:[0,0,1]
    v_cvt_pk_bf16_f32 v200, v250, v251
    v_cvt_pk_bf16_f32 v201, v252, v253
    s_mov_b32 s50, 884736
    buffer_load_dwordx4 v[128:131], v1, s[40:43], s50 offen
    v_lshlrev_b32 v250, 16, v202
    v_lshlrev_b32 v252, 16, v203
    v_and_b32 v251, 0xffff0000, v202
    v_and_b32 v253, 0xffff0000, v203
    v_pk_fma_f32 v[250:251], v[250:251], v[16:17], v[16:17] op_sel:[0,1,0] op_sel_hi:[1,1,0] neg_lo:[0,0,1] neg_hi:[0,0,1]
    v_pk_fma_f32 v[252:253], v[252:253], v[16:17], v[16:17] op_sel:[0,1,0] op_sel_hi:[1,1,0] neg_lo:[0,0,1] neg_hi:[0,0,1]
    v_cvt_pk_bf16_f32 v202, v250, v251
    v_cvt_pk_bf16_f32 v203, v252, v253
    ds_write_b128 v26, v[200:203] offset:40960
    buffer_load_dwordx4 v[132:135], v2, s[40:43], s50 offen
    v_lshlrev_b32 v250, 16, v204
    v_lshlrev_b32 v252, 16, v205
    v_and_b32 v251, 0xffff0000, v204
    v_and_b32 v253, 0xffff0000, v205
    v_pk_fma_f32 v[250:251], v[250:251], v[18:19], v[18:19] op_sel:[0,1,0] op_sel_hi:[1,1,0] neg_lo:[0,0,1] neg_hi:[0,0,1]
    v_pk_fma_f32 v[252:253], v[252:253], v[18:19], v[18:19] op_sel:[0,1,0] op_sel_hi:[1,1,0] neg_lo:[0,0,1] neg_hi:[0,0,1]
    v_cvt_pk_bf16_f32 v204, v250, v251
    v_cvt_pk_bf16_f32 v205, v252, v253
    buffer_load_dwordx4 v[136:139], v3, s[40:43], s50 offen
    v_lshlrev_b32 v250, 16, v206
    v_lshlrev_b32 v252, 16, v207
    v_and_b32 v251, 0xffff0000, v206
    v_and_b32 v253, 0xffff0000, v207
    v_pk_fma_f32 v[250:251], v[250:251], v[18:19], v[18:19] op_sel:[0,1,0] op_sel_hi:[1,1,0] neg_lo:[0,0,1] neg_hi:[0,0,1]
    v_pk_fma_f32 v[252:253], v[252:253], v[18:19], v[18:19] op_sel:[0,1,0] op_sel_hi:[1,1,0] neg_lo:[0,0,1] neg_hi:[0,0,1]
    v_cvt_pk_bf16_f32 v206, v250, v251
    v_cvt_pk_bf16_f32 v207, v252, v253
    ds_write_b128 v26, v[204:207] offset:41984
    buffer_load_dwordx4 v[140:143], v4, s[40:43], s50 offen
    v_lshlrev_b32 v250, 16, v208
    v_lshlrev_b32 v252, 16, v209
    v_and_b32 v251, 0xffff0000, v208
    v_and_b32 v253, 0xffff0000, v209
    v_pk_fma_f32 v[250:251], v[250:251], v[20:21], v[20:21] op_sel:[0,1,0] op_sel_hi:[1,1,0] neg_lo:[0,0,1] neg_hi:[0,0,1]
    v_pk_fma_f32 v[252:253], v[252:253], v[20:21], v[20:21] op_sel:[0,1,0] op_sel_hi:[1,1,0] neg_lo:[0,0,1] neg_hi:[0,0,1]
    v_cvt_pk_bf16_f32 v208, v250, v251
    v_cvt_pk_bf16_f32 v209, v252, v253
    buffer_load_dwordx4 v[144:147], v5, s[40:43], s50 offen
    v_lshlrev_b32 v250, 16, v210
    v_lshlrev_b32 v252, 16, v211
    v_and_b32 v251, 0xffff0000, v210
    v_and_b32 v253, 0xffff0000, v211
    v_pk_fma_f32 v[250:251], v[250:251], v[20:21], v[20:21] op_sel:[0,1,0] op_sel_hi:[1,1,0] neg_lo:[0,0,1] neg_hi:[0,0,1]
    v_pk_fma_f32 v[252:253], v[252:253], v[20:21], v[20:21] op_sel:[0,1,0] op_sel_hi:[1,1,0] neg_lo:[0,0,1] neg_hi:[0,0,1]
    v_cvt_pk_bf16_f32 v210, v250, v251
    v_cvt_pk_bf16_f32 v211, v252, v253
    ds_write_b128 v26, v[208:211] offset:43008
    buffer_load_dwordx4 v[148:151], v6, s[40:43], s50 offen
    v_lshlrev_b32 v250, 16, v212
    v_lshlrev_b32 v252, 16, v213
    v_and_b32 v251, 0xffff0000, v212
    v_and_b32 v253, 0xffff0000, v213
    v_pk_fma_f32 v[250:251], v[250:251], v[22:23], v[22:23] op_sel:[0,1,0] op_sel_hi:[1,1,0] neg_lo:[0,0,1] neg_hi:[0,0,1]
    v_pk_fma_f32 v[252:253], v[252:253], v[22:23], v[22:23] op_sel:[0,1,0] op_sel_hi:[1,1,0] neg_lo:[0,0,1] neg_hi:[0,0,1]
    v_cvt_pk_bf16_f32 v212, v250, v251
    v_cvt_pk_bf16_f32 v213, v252, v253
    v_lshlrev_b32 v250, 16, v214
    v_lshlrev_b32 v252, 16, v215
    v_and_b32 v251, 0xffff0000, v214
    v_and_b32 v253, 0xffff0000, v215
    v_pk_fma_f32 v[250:251], v[250:251], v[22:23], v[22:23] op_sel:[0,1,0] op_sel_hi:[1,1,0] neg_lo:[0,0,1] neg_hi:[0,0,1]
    v_pk_fma_f32 v[252:253], v[252:253], v[22:23], v[22:23] op_sel:[0,1,0] op_sel_hi:[1,1,0] neg_lo:[0,0,1] neg_hi:[0,0,1]
    v_cvt_pk_bf16_f32 v214, v250, v251
    v_cvt_pk_bf16_f32 v215, v252, v253
    ds_write_b128 v26, v[212:215] offset:44032
    buffer_load_dwordx4 v[152:155], v7, s[40:43], s50 offen
    v_lshlrev_b32 v250, 16, v220
    v_lshlrev_b32 v252, 16, v221
    v_and_b32 v251, 0xffff0000, v220
    v_and_b32 v253, 0xffff0000, v221
    v_pk_fma_f32 v[250:251], v[250:251], v[16:17], v[16:17] op_sel:[0,1,0] op_sel_hi:[1,1,0] neg_lo:[0,0,1] neg_hi:[0,0,1]
    v_pk_fma_f32 v[252:253], v[252:253], v[16:17], v[16:17] op_sel:[0,1,0] op_sel_hi:[1,1,0] neg_lo:[0,0,1] neg_hi:[0,0,1]
    v_cvt_pk_bf16_f32 v220, v250, v251
    v_cvt_pk_bf16_f32 v221, v252, v253
    s_add_u32 m0, s52, 16384
    buffer_load_dwordx4 v[156:159], v8, s[40:43], s50 offen
    v_lshlrev_b32 v250, 16, v222
    v_lshlrev_b32 v252, 16, v223
    v_and_b32 v251, 0xffff0000, v222
    v_and_b32 v253, 0xffff0000, v223
    v_pk_fma_f32 v[250:251], v[250:251], v[16:17], v[16:17] op_sel:[0,1,0] op_sel_hi:[1,1,0] neg_lo:[0,0,1] neg_hi:[0,0,1]
    v_pk_fma_f32 v[252:253], v[252:253], v[16:17], v[16:17] op_sel:[0,1,0] op_sel_hi:[1,1,0] neg_lo:[0,0,1] neg_hi:[0,0,1]
    v_cvt_pk_bf16_f32 v222, v250, v251
    v_cvt_pk_bf16_f32 v223, v252, v253
    ds_write_b128 v26, v[220:223] offset:61440
    buffer_load_dwordx4 v9, s[40:43], s50 offen lds
    v_lshlrev_b32 v250, 16, v224
    v_lshlrev_b32 v252, 16, v225
    v_and_b32 v251, 0xffff0000, v224
    v_and_b32 v253, 0xffff0000, v225
    v_pk_fma_f32 v[250:251], v[250:251], v[18:19], v[18:19] op_sel:[0,1,0] op_sel_hi:[1,1,0] neg_lo:[0,0,1] neg_hi:[0,0,1]
    v_pk_fma_f32 v[252:253], v[252:253], v[18:19], v[18:19] op_sel:[0,1,0] op_sel_hi:[1,1,0] neg_lo:[0,0,1] neg_hi:[0,0,1]
    v_cvt_pk_bf16_f32 v224, v250, v251
    v_cvt_pk_bf16_f32 v225, v252, v253
    s_mov_b32 s50, 1179648
    buffer_load_dwordx4 v[160:163], v1, s[40:43], s50 offen
    v_lshlrev_b32 v250, 16, v226
    v_lshlrev_b32 v252, 16, v227
    v_and_b32 v251, 0xffff0000, v226
    v_and_b32 v253, 0xffff0000, v227
    v_pk_fma_f32 v[250:251], v[250:251], v[18:19], v[18:19] op_sel:[0,1,0] op_sel_hi:[1,1,0] neg_lo:[0,0,1] neg_hi:[0,0,1]
    v_pk_fma_f32 v[252:253], v[252:253], v[18:19], v[18:19] op_sel:[0,1,0] op_sel_hi:[1,1,0] neg_lo:[0,0,1] neg_hi:[0,0,1]
    v_cvt_pk_bf16_f32 v226, v250, v251
    v_cvt_pk_bf16_f32 v227, v252, v253
    ds_write_b128 v26, v[224:227] offset:62464
    buffer_load_dwordx4 v[164:167], v2, s[40:43], s50 offen
    v_lshlrev_b32 v250, 16, v228
    v_lshlrev_b32 v252, 16, v229
    v_and_b32 v251, 0xffff0000, v228
    v_and_b32 v253, 0xffff0000, v229
    v_pk_fma_f32 v[250:251], v[250:251], v[20:21], v[20:21] op_sel:[0,1,0] op_sel_hi:[1,1,0] neg_lo:[0,0,1] neg_hi:[0,0,1]
    v_pk_fma_f32 v[252:253], v[252:253], v[20:21], v[20:21] op_sel:[0,1,0] op_sel_hi:[1,1,0] neg_lo:[0,0,1] neg_hi:[0,0,1]
    v_cvt_pk_bf16_f32 v228, v250, v251
    v_cvt_pk_bf16_f32 v229, v252, v253
    buffer_load_dwordx4 v[168:171], v3, s[40:43], s50 offen
    v_lshlrev_b32 v250, 16, v230
    v_lshlrev_b32 v252, 16, v231
    v_and_b32 v251, 0xffff0000, v230
    v_and_b32 v253, 0xffff0000, v231
    v_pk_fma_f32 v[250:251], v[250:251], v[20:21], v[20:21] op_sel:[0,1,0] op_sel_hi:[1,1,0] neg_lo:[0,0,1] neg_hi:[0,0,1]
    v_pk_fma_f32 v[252:253], v[252:253], v[20:21], v[20:21] op_sel:[0,1,0] op_sel_hi:[1,1,0] neg_lo:[0,0,1] neg_hi:[0,0,1]
    v_cvt_pk_bf16_f32 v230, v250, v251
    v_cvt_pk_bf16_f32 v231, v252, v253
    ds_write_b128 v26, v[228:231] offset:63488
    buffer_load_dwordx4 v[172:175], v4, s[40:43], s50 offen
    v_lshlrev_b32 v250, 16, v232
    v_lshlrev_b32 v252, 16, v233
    v_and_b32 v251, 0xffff0000, v232
    v_and_b32 v253, 0xffff0000, v233
    v_pk_fma_f32 v[250:251], v[250:251], v[22:23], v[22:23] op_sel:[0,1,0] op_sel_hi:[1,1,0] neg_lo:[0,0,1] neg_hi:[0,0,1]
    v_pk_fma_f32 v[252:253], v[252:253], v[22:23], v[22:23] op_sel:[0,1,0] op_sel_hi:[1,1,0] neg_lo:[0,0,1] neg_hi:[0,0,1]
    v_cvt_pk_bf16_f32 v232, v250, v251
    v_cvt_pk_bf16_f32 v233, v252, v253
    buffer_load_dwordx4 v[176:179], v5, s[40:43], s50 offen
    v_lshlrev_b32 v250, 16, v234
    v_lshlrev_b32 v252, 16, v235
    v_and_b32 v251, 0xffff0000, v234
    v_and_b32 v253, 0xffff0000, v235
    v_pk_fma_f32 v[250:251], v[250:251], v[22:23], v[22:23] op_sel:[0,1,0] op_sel_hi:[1,1,0] neg_lo:[0,0,1] neg_hi:[0,0,1]
    v_pk_fma_f32 v[252:253], v[252:253], v[22:23], v[22:23] op_sel:[0,1,0] op_sel_hi:[1,1,0] neg_lo:[0,0,1] neg_hi:[0,0,1]
    v_cvt_pk_bf16_f32 v234, v250, v251
    v_cvt_pk_bf16_f32 v235, v252, v253
    ds_write_b128 v26, v[232:235] offset:64512
    buffer_load_dwordx4 v[180:183], v6, s[40:43], s50 offen
    v_lshlrev_b32 v250, 16, v240
    v_lshlrev_b32 v252, 16, v241
    v_and_b32 v251, 0xffff0000, v240
    v_and_b32 v253, 0xffff0000, v241
    v_pk_fma_f32 v[250:251], v[250:251], v[16:17], v[16:17] op_sel:[0,1,0] op_sel_hi:[1,1,0] neg_lo:[0,0,1] neg_hi:[0,0,1]
    v_pk_fma_f32 v[252:253], v[252:253], v[16:17], v[16:17] op_sel:[0,1,0] op_sel_hi:[1,1,0] neg_lo:[0,0,1] neg_hi:[0,0,1]
    v_cvt_pk_bf16_f32 v240, v250, v251
    v_cvt_pk_bf16_f32 v241, v252, v253
    ds_write_b64 v28, v[240:241] offset:0
    buffer_load_dwordx4 v[184:187], v7, s[40:43], s50 offen
    v_lshlrev_b32 v250, 16, v242
    v_lshlrev_b32 v252, 16, v243
    v_and_b32 v251, 0xffff0000, v242
    v_and_b32 v253, 0xffff0000, v243
    v_pk_fma_f32 v[250:251], v[250:251], v[18:19], v[18:19] op_sel:[0,1,0] op_sel_hi:[1,1,0] neg_lo:[0,0,1] neg_hi:[0,0,1]
    v_pk_fma_f32 v[252:253], v[252:253], v[18:19], v[18:19] op_sel:[0,1,0] op_sel_hi:[1,1,0] neg_lo:[0,0,1] neg_hi:[0,0,1]
    v_cvt_pk_bf16_f32 v242, v250, v251
    v_cvt_pk_bf16_f32 v243, v252, v253
    ds_write_b64 v28, v[242:243] offset:1024
    s_add_u32 m0, s52, 20480
    buffer_load_dwordx4 v[188:191], v8, s[40:43], s50 offen
    v_lshlrev_b32 v250, 16, v244
    v_lshlrev_b32 v252, 16, v245
    v_and_b32 v251, 0xffff0000, v244
    v_and_b32 v253, 0xffff0000, v245
    v_pk_fma_f32 v[250:251], v[250:251], v[20:21], v[20:21] op_sel:[0,1,0] op_sel_hi:[1,1,0] neg_lo:[0,0,1] neg_hi:[0,0,1]
    v_pk_fma_f32 v[252:253], v[252:253], v[20:21], v[20:21] op_sel:[0,1,0] op_sel_hi:[1,1,0] neg_lo:[0,0,1] neg_hi:[0,0,1]
    v_cvt_pk_bf16_f32 v244, v250, v251
    v_cvt_pk_bf16_f32 v245, v252, v253
    ds_write_b64 v28, v[244:245] offset:2048
    buffer_load_dwordx4 v9, s[40:43], s50 offen lds
    v_lshlrev_b32 v250, 16, v246
    v_lshlrev_b32 v252, 16, v247
    v_and_b32 v251, 0xffff0000, v246
    v_and_b32 v253, 0xffff0000, v247
    v_pk_fma_f32 v[250:251], v[250:251], v[22:23], v[22:23] op_sel:[0,1,0] op_sel_hi:[1,1,0] neg_lo:[0,0,1] neg_hi:[0,0,1]
    v_pk_fma_f32 v[252:253], v[252:253], v[22:23], v[22:23] op_sel:[0,1,0] op_sel_hi:[1,1,0] neg_lo:[0,0,1] neg_hi:[0,0,1]
    v_cvt_pk_bf16_f32 v246, v250, v251
    v_cvt_pk_bf16_f32 v247, v252, v253
    ds_write_b64 v28, v[246:247] offset:3072
    v_add_u32 v20, s90, v0
    v_xor_b32 v21, 48, v20
    v_add_u32 v22, s91, v0
    v_xor_b32 v23, 48, v22
    v_add_u32 v24, s92, v0
    v_xor_b32 v25, 48, v24
    s_lshl_b32 s33, s31, 11
    s_add_u32 s33, s33, 33554432
    s_or_b32 s34, s32, s30
    s_cmp_eq_u32 s34, 0
    s_cselect_b32 s33, s33, 0x40000000
    v_lshlrev_b32 v27, 5, v13
    v_mov_b32 v28, 0
    v_mov_b32 v29, 0
    s_waitcnt lgkmcnt(0)
    s_barrier
    ds_read_b128 a[180:183], v10 offset:0
    ds_read_b128 a[184:187], v10 offset:1024
    ds_read_b128 a[188:191], v10 offset:2048
    ds_read_b128 a[192:195], v10 offset:3072
    ds_read_b64_tr_b16 v[192:193], v20
    ds_read_b64_tr_b16 v[194:195], v21 offset:256
    ds_read_b64_tr_b16 v[196:197], v22
    ds_read_b64_tr_b16 v[198:199], v23 offset:256
    ds_read_b64_tr_b16 v[200:201], v24
    ds_read_b64_tr_b16 v[202:203], v25 offset:256
    buffer_store_dwordx2 v[28:29], v27, s[44:47], s33 offen sc0 sc1
    s_waitcnt vmcnt(37)
    s_barrier
    v_perm_b32 v16, v36, v32, s48
    v_perm_b32 v17, v44, v40, s48
    v_perm_b32 v18, v52, v48, s48
    v_perm_b32 v19, v60, v56, s48
    s_mov_b32 s53, 0
    s_mov_b32 s51, 294912
    s_waitcnt lgkmcnt(0)
    buffer_store_dwordx4 v[192:195], v30, s[56:59], s60 offen sc0 sc1
    buffer_store_dwordx4 v[196:199], v30, s[56:59], s61 offen sc0 sc1
    buffer_store_dwordx4 v[200:203], v30, s[56:59], s62 offen sc0 sc1
    v_accvgpr_read_b32 v250, a244
    v_accvgpr_read_b32 v252, a245
    v_add_u32 v251, 4096, v250
    buffer_load_dwordx4 v[224:227], v250, s[4:7], s86 offen
    buffer_load_dwordx4 v[228:231], v251, s[4:7], s86 offen
    buffer_load_dwordx4 v[232:235], v252, s[4:7], s86 offen
    s_mov_b32 s50, 1474560
    .p2alignl 3, 0xbf800000
L4_gemm_zero:
    v_mfma_f32_16x16x32_bf16 a[0:3], a[180:183], v[16:19], 0
    v_perm_b32 v20, v36, v32, s49
    v_perm_b32 v21, v44, v40, s49
    v_mfma_f32_16x16x32_bf16 a[4:7], a[184:187], v[16:19], 0
    v_perm_b32 v22, v52, v48, s49
    v_perm_b32 v23, v60, v56, s49
    v_mfma_f32_16x16x32_bf16 a[8:11], a[188:191], v[16:19], 0
    ds_read_b64_tr_b16 v[24:25], v11 offset:0
    v_mfma_f32_16x16x32_bf16 a[12:15], a[192:195], v[16:19], 0
    buffer_load_dwordx4 v[192:195], v1, s[40:43], s50 offen
    v_mfma_f32_16x16x32_bf16 a[20:23], a[180:183], v[20:23], 0
    v_perm_b32 v16, v37, v33, s48
    v_perm_b32 v17, v45, v41, s48
    v_mfma_f32_16x16x32_bf16 a[24:27], a[184:187], v[20:23], 0
    v_perm_b32 v18, v53, v49, s48
    v_perm_b32 v19, v61, v57, s48
    v_mfma_f32_16x16x32_bf16 a[28:31], a[188:191], v[20:23], 0
    ds_read_b64_tr_b16 v[26:27], v11 offset:2048
    v_mfma_f32_16x16x32_bf16 a[32:35], a[192:195], v[20:23], 0
    buffer_load_dwordx4 v[196:199], v2, s[40:43], s50 offen
    v_mfma_f32_16x16x32_bf16 a[40:43], a[180:183], v[16:19], 0
    v_perm_b32 v20, v37, v33, s49
    v_perm_b32 v21, v45, v41, s49
    v_mfma_f32_16x16x32_bf16 a[44:47], a[184:187], v[16:19], 0
    v_perm_b32 v22, v53, v49, s49
    v_perm_b32 v23, v61, v57, s49
    v_mfma_f32_16x16x32_bf16 a[48:51], a[188:191], v[16:19], 0
    ds_read_b128 a[200:203], v10 offset:5120
    v_mfma_f32_16x16x32_bf16 a[52:55], a[192:195], v[16:19], 0
    buffer_load_dwordx4 v[200:203], v3, s[40:43], s50 offen
    v_mfma_f32_16x16x32_bf16 a[60:63], a[180:183], v[20:23], 0
    v_perm_b32 v16, v38, v34, s48
    v_perm_b32 v17, v46, v42, s48
    v_mfma_f32_16x16x32_bf16 a[64:67], a[184:187], v[20:23], 0
    v_perm_b32 v18, v54, v50, s48
    v_perm_b32 v19, v62, v58, s48
    v_mfma_f32_16x16x32_bf16 a[68:71], a[188:191], v[20:23], 0
    ds_read_b128 a[204:207], v10 offset:6144
    v_mfma_f32_16x16x32_bf16 a[72:75], a[192:195], v[20:23], 0
    buffer_load_dwordx4 v[204:207], v4, s[40:43], s50 offen
    v_mfma_f32_16x16x32_bf16 a[80:83], a[180:183], v[16:19], 0
    v_perm_b32 v20, v38, v34, s49
    v_perm_b32 v21, v46, v42, s49
    v_mfma_f32_16x16x32_bf16 a[84:87], a[184:187], v[16:19], 0
    v_perm_b32 v22, v54, v50, s49
    v_perm_b32 v23, v62, v58, s49
    v_mfma_f32_16x16x32_bf16 a[88:91], a[188:191], v[16:19], 0
    ds_read_b128 a[208:211], v10 offset:7168
    v_mfma_f32_16x16x32_bf16 a[92:95], a[192:195], v[16:19], 0
    buffer_load_dwordx4 v[208:211], v5, s[40:43], s50 offen
    v_mfma_f32_16x16x32_bf16 a[100:103], a[180:183], v[20:23], 0
    v_perm_b32 v16, v39, v35, s48
    v_perm_b32 v17, v47, v43, s48
    v_mfma_f32_16x16x32_bf16 a[104:107], a[184:187], v[20:23], 0
    v_perm_b32 v18, v55, v51, s48
    v_perm_b32 v19, v63, v59, s48
    v_mfma_f32_16x16x32_bf16 a[108:111], a[188:191], v[20:23], 0
    ds_read_b128 a[212:215], v10 offset:8192
    v_mfma_f32_16x16x32_bf16 a[112:115], a[192:195], v[20:23], 0
    buffer_load_dwordx4 v[212:215], v6, s[40:43], s50 offen
    v_mfma_f32_16x16x32_bf16 a[120:123], a[180:183], v[16:19], 0
    v_perm_b32 v20, v39, v35, s49
    v_perm_b32 v21, v47, v43, s49
    v_mfma_f32_16x16x32_bf16 a[124:127], a[184:187], v[16:19], 0
    v_perm_b32 v22, v55, v51, s49
    v_perm_b32 v23, v63, v59, s49
    v_mfma_f32_16x16x32_bf16 a[128:131], a[188:191], v[16:19], 0
    v_mfma_f32_16x16x32_bf16 a[132:135], a[192:195], v[16:19], 0
    buffer_load_dwordx4 v[216:219], v7, s[40:43], s50 offen
    v_mfma_f32_16x16x32_bf16 a[140:143], a[180:183], v[20:23], 0
    s_add_u32 s55, s50, s51
    v_mfma_f32_16x16x32_bf16 a[144:147], a[184:187], v[20:23], 0
    s_add_u32 m0, s52, 24576
    v_mfma_f32_16x16x32_bf16 a[148:151], a[188:191], v[20:23], 0
    s_waitcnt vmcnt(25) lgkmcnt(0)
    s_barrier
    v_mfma_f32_16x16x32_bf16 a[152:155], a[192:195], v[20:23], 0
    buffer_load_dwordx4 v[220:223], v8, s[40:43], s50 offen
    v_mfma_f32_16x16x32_bf16 a[160:163], v[24:27], a[180:183], 0
    v_perm_b32 v16, v68, v64, s48
    v_perm_b32 v17, v76, v72, s48
    v_mfma_f32_16x16x32_bf16 a[164:167], v[24:27], a[184:187], 0
    v_perm_b32 v18, v84, v80, s48
    v_perm_b32 v19, v92, v88, s48
    v_mfma_f32_16x16x32_bf16 a[168:171], v[24:27], a[188:191], 0
    v_mfma_f32_16x16x32_bf16 a[172:175], v[24:27], a[192:195], 0
    buffer_load_dwordx4 v9, s[40:43], s50 offen lds
    s_branch L4_gemm_p1
    .p2alignl 6, 0xbf800000
L4_gemm_loop:
    v_mfma_f32_16x16x32_bf16 a[0:3], a[180:183], v[16:19], a[0:3]
    v_perm_b32 v20, v36, v32, s49
    v_perm_b32 v21, v44, v40, s49
    v_mfma_f32_16x16x32_bf16 a[4:7], a[184:187], v[16:19], a[4:7]
    v_perm_b32 v22, v52, v48, s49
    v_perm_b32 v23, v60, v56, s49
    v_mfma_f32_16x16x32_bf16 a[8:11], a[188:191], v[16:19], a[8:11]
    ds_read_b64_tr_b16 v[24:25], v11 offset:0
    v_mfma_f32_16x16x32_bf16 a[12:15], a[192:195], v[16:19], a[12:15]
    buffer_load_dwordx4 v[192:195], v1, s[40:43], s50 offen
    v_mfma_f32_16x16x32_bf16 a[20:23], a[180:183], v[20:23], a[20:23]
    v_perm_b32 v16, v37, v33, s48
    v_perm_b32 v17, v45, v41, s48
    v_mfma_f32_16x16x32_bf16 a[24:27], a[184:187], v[20:23], a[24:27]
    v_perm_b32 v18, v53, v49, s48
    v_perm_b32 v19, v61, v57, s48
    v_mfma_f32_16x16x32_bf16 a[28:31], a[188:191], v[20:23], a[28:31]
    ds_read_b64_tr_b16 v[26:27], v11 offset:2048
    v_mfma_f32_16x16x32_bf16 a[32:35], a[192:195], v[20:23], a[32:35]
    buffer_load_dwordx4 v[196:199], v2, s[40:43], s50 offen
    v_mfma_f32_16x16x32_bf16 a[40:43], a[180:183], v[16:19], a[40:43]
    v_perm_b32 v20, v37, v33, s49
    v_perm_b32 v21, v45, v41, s49
    v_mfma_f32_16x16x32_bf16 a[44:47], a[184:187], v[16:19], a[44:47]
    v_perm_b32 v22, v53, v49, s49
    v_perm_b32 v23, v61, v57, s49
    v_mfma_f32_16x16x32_bf16 a[48:51], a[188:191], v[16:19], a[48:51]
    ds_read_b128 a[200:203], v10 offset:5120
    v_mfma_f32_16x16x32_bf16 a[52:55], a[192:195], v[16:19], a[52:55]
    buffer_load_dwordx4 v[200:203], v3, s[40:43], s50 offen
    v_mfma_f32_16x16x32_bf16 a[60:63], a[180:183], v[20:23], a[60:63]
    v_perm_b32 v16, v38, v34, s48
    v_perm_b32 v17, v46, v42, s48
    v_mfma_f32_16x16x32_bf16 a[64:67], a[184:187], v[20:23], a[64:67]
    v_perm_b32 v18, v54, v50, s48
    v_perm_b32 v19, v62, v58, s48
    v_mfma_f32_16x16x32_bf16 a[68:71], a[188:191], v[20:23], a[68:71]
    ds_read_b128 a[204:207], v10 offset:6144
    v_mfma_f32_16x16x32_bf16 a[72:75], a[192:195], v[20:23], a[72:75]
    buffer_load_dwordx4 v[204:207], v4, s[40:43], s50 offen
    v_mfma_f32_16x16x32_bf16 a[80:83], a[180:183], v[16:19], a[80:83]
    v_perm_b32 v20, v38, v34, s49
    v_perm_b32 v21, v46, v42, s49
    v_mfma_f32_16x16x32_bf16 a[84:87], a[184:187], v[16:19], a[84:87]
    v_perm_b32 v22, v54, v50, s49
    v_perm_b32 v23, v62, v58, s49
    v_mfma_f32_16x16x32_bf16 a[88:91], a[188:191], v[16:19], a[88:91]
    ds_read_b128 a[208:211], v10 offset:7168
    v_mfma_f32_16x16x32_bf16 a[92:95], a[192:195], v[16:19], a[92:95]
    buffer_load_dwordx4 v[208:211], v5, s[40:43], s50 offen
    v_mfma_f32_16x16x32_bf16 a[100:103], a[180:183], v[20:23], a[100:103]
    v_perm_b32 v16, v39, v35, s48
    v_perm_b32 v17, v47, v43, s48
    v_mfma_f32_16x16x32_bf16 a[104:107], a[184:187], v[20:23], a[104:107]
    v_perm_b32 v18, v55, v51, s48
    v_perm_b32 v19, v63, v59, s48
    v_mfma_f32_16x16x32_bf16 a[108:111], a[188:191], v[20:23], a[108:111]
    ds_read_b128 a[212:215], v10 offset:8192
    v_mfma_f32_16x16x32_bf16 a[112:115], a[192:195], v[20:23], a[112:115]
    buffer_load_dwordx4 v[212:215], v6, s[40:43], s50 offen
    v_mfma_f32_16x16x32_bf16 a[120:123], a[180:183], v[16:19], a[120:123]
    v_perm_b32 v20, v39, v35, s49
    v_perm_b32 v21, v47, v43, s49
    v_mfma_f32_16x16x32_bf16 a[124:127], a[184:187], v[16:19], a[124:127]
    v_perm_b32 v22, v55, v51, s49
    v_perm_b32 v23, v63, v59, s49
    v_mfma_f32_16x16x32_bf16 a[128:131], a[188:191], v[16:19], a[128:131]
    v_mfma_f32_16x16x32_bf16 a[132:135], a[192:195], v[16:19], a[132:135]
    buffer_load_dwordx4 v[216:219], v7, s[40:43], s50 offen
    v_mfma_f32_16x16x32_bf16 a[140:143], a[180:183], v[20:23], a[140:143]
    s_add_u32 s55, s50, s51
    v_mfma_f32_16x16x32_bf16 a[144:147], a[184:187], v[20:23], a[144:147]
    s_add_u32 m0, s52, 24576
    v_mfma_f32_16x16x32_bf16 a[148:151], a[188:191], v[20:23], a[148:151]
    s_waitcnt vmcnt(25) lgkmcnt(0)
    s_barrier
    v_mfma_f32_16x16x32_bf16 a[152:155], a[192:195], v[20:23], a[152:155]
    buffer_load_dwordx4 v[220:223], v8, s[40:43], s50 offen
    v_mfma_f32_16x16x32_bf16 a[160:163], v[24:27], a[180:183], a[160:163]
    v_perm_b32 v16, v68, v64, s48
    v_perm_b32 v17, v76, v72, s48
    v_mfma_f32_16x16x32_bf16 a[164:167], v[24:27], a[184:187], a[164:167]
    v_perm_b32 v18, v84, v80, s48
    v_perm_b32 v19, v92, v88, s48
    v_mfma_f32_16x16x32_bf16 a[168:171], v[24:27], a[188:191], a[168:171]
    v_mfma_f32_16x16x32_bf16 a[172:175], v[24:27], a[192:195], a[172:175]
    buffer_load_dwordx4 v9, s[40:43], s50 offen lds
L4_gemm_p1:
    s_cmp_eq_u32 s53, 2
    s_cbranch_scc1 L4_switch
L4_sw_back:
    v_mfma_f32_16x16x32_bf16 a[0:3], a[200:203], v[16:19], a[0:3]
    v_perm_b32 v20, v68, v64, s49
    v_perm_b32 v21, v76, v72, s49
    v_mfma_f32_16x16x32_bf16 a[4:7], a[204:207], v[16:19], a[4:7]
    v_perm_b32 v22, v84, v80, s49
    v_perm_b32 v23, v92, v88, s49
    v_mfma_f32_16x16x32_bf16 a[8:11], a[208:211], v[16:19], a[8:11]
    ds_read_b64_tr_b16 v[24:25], v11 offset:4096
    v_mfma_f32_16x16x32_bf16 a[12:15], a[212:215], v[16:19], a[12:15]
    buffer_load_dwordx4 v[32:35], v1, s[40:43], s55 offen
    v_mfma_f32_16x16x32_bf16 a[20:23], a[200:203], v[20:23], a[20:23]
    v_perm_b32 v16, v69, v65, s48
    v_perm_b32 v17, v77, v73, s48
    v_mfma_f32_16x16x32_bf16 a[24:27], a[204:207], v[20:23], a[24:27]
    v_perm_b32 v18, v85, v81, s48
    v_perm_b32 v19, v93, v89, s48
    v_mfma_f32_16x16x32_bf16 a[28:31], a[208:211], v[20:23], a[28:31]
    ds_read_b64_tr_b16 v[26:27], v11 offset:6144
    v_mfma_f32_16x16x32_bf16 a[32:35], a[212:215], v[20:23], a[32:35]
    buffer_load_dwordx4 v[36:39], v2, s[40:43], s55 offen
    v_mfma_f32_16x16x32_bf16 a[40:43], a[200:203], v[16:19], a[40:43]
    v_perm_b32 v20, v69, v65, s49
    v_perm_b32 v21, v77, v73, s49
    v_mfma_f32_16x16x32_bf16 a[44:47], a[204:207], v[16:19], a[44:47]
    v_perm_b32 v22, v85, v81, s49
    v_perm_b32 v23, v93, v89, s49
    v_mfma_f32_16x16x32_bf16 a[48:51], a[208:211], v[16:19], a[48:51]
    ds_read_b128 a[180:183], v10 offset:10240
    v_mfma_f32_16x16x32_bf16 a[52:55], a[212:215], v[16:19], a[52:55]
    buffer_load_dwordx4 v[40:43], v3, s[40:43], s55 offen
    v_mfma_f32_16x16x32_bf16 a[60:63], a[200:203], v[20:23], a[60:63]
    v_perm_b32 v16, v70, v66, s48
    v_perm_b32 v17, v78, v74, s48
    v_mfma_f32_16x16x32_bf16 a[64:67], a[204:207], v[20:23], a[64:67]
    v_perm_b32 v18, v86, v82, s48
    v_perm_b32 v19, v94, v90, s48
    v_mfma_f32_16x16x32_bf16 a[68:71], a[208:211], v[20:23], a[68:71]
    ds_read_b128 a[184:187], v10 offset:11264
    v_mfma_f32_16x16x32_bf16 a[72:75], a[212:215], v[20:23], a[72:75]
    buffer_load_dwordx4 v[44:47], v4, s[40:43], s55 offen
    v_mfma_f32_16x16x32_bf16 a[80:83], a[200:203], v[16:19], a[80:83]
    v_perm_b32 v20, v70, v66, s49
    v_perm_b32 v21, v78, v74, s49
    v_mfma_f32_16x16x32_bf16 a[84:87], a[204:207], v[16:19], a[84:87]
    v_perm_b32 v22, v86, v82, s49
    v_perm_b32 v23, v94, v90, s49
    v_mfma_f32_16x16x32_bf16 a[88:91], a[208:211], v[16:19], a[88:91]
    ds_read_b128 a[188:191], v10 offset:12288
    v_mfma_f32_16x16x32_bf16 a[92:95], a[212:215], v[16:19], a[92:95]
    buffer_load_dwordx4 v[48:51], v5, s[40:43], s55 offen
    v_mfma_f32_16x16x32_bf16 a[100:103], a[200:203], v[20:23], a[100:103]
    v_perm_b32 v16, v71, v67, s48
    v_perm_b32 v17, v79, v75, s48
    v_mfma_f32_16x16x32_bf16 a[104:107], a[204:207], v[20:23], a[104:107]
    v_perm_b32 v18, v87, v83, s48
    v_perm_b32 v19, v95, v91, s48
    v_mfma_f32_16x16x32_bf16 a[108:111], a[208:211], v[20:23], a[108:111]
    ds_read_b128 a[192:195], v10 offset:13312
    v_mfma_f32_16x16x32_bf16 a[112:115], a[212:215], v[20:23], a[112:115]
    buffer_load_dwordx4 v[52:55], v6, s[40:43], s55 offen
    v_mfma_f32_16x16x32_bf16 a[120:123], a[200:203], v[16:19], a[120:123]
    v_perm_b32 v20, v71, v67, s49
    v_perm_b32 v21, v79, v75, s49
    v_mfma_f32_16x16x32_bf16 a[124:127], a[204:207], v[16:19], a[124:127]
    v_perm_b32 v22, v87, v83, s49
    v_perm_b32 v23, v95, v91, s49
    v_mfma_f32_16x16x32_bf16 a[128:131], a[208:211], v[16:19], a[128:131]
    v_mfma_f32_16x16x32_bf16 a[132:135], a[212:215], v[16:19], a[132:135]
    buffer_load_dwordx4 v[56:59], v7, s[40:43], s55 offen
    v_mfma_f32_16x16x32_bf16 a[140:143], a[200:203], v[20:23], a[140:143]
    s_add_u32 s50, s55, s51
    v_mfma_f32_16x16x32_bf16 a[144:147], a[204:207], v[20:23], a[144:147]
    s_add_u32 m0, s52, 4096
    v_mfma_f32_16x16x32_bf16 a[148:151], a[208:211], v[20:23], a[148:151]
    s_waitcnt vmcnt(34) lgkmcnt(0)
    v_mfma_f32_16x16x32_bf16 a[152:155], a[212:215], v[20:23], a[152:155]
    buffer_load_dwordx4 v[60:63], v8, s[40:43], s55 offen
    v_mfma_f32_16x16x32_bf16 a[160:163], v[24:27], a[200:203], a[160:163]
    v_perm_b32 v16, v100, v96, s48
    v_perm_b32 v17, v108, v104, s48
    v_mfma_f32_16x16x32_bf16 a[164:167], v[24:27], a[204:207], a[164:167]
    v_perm_b32 v18, v116, v112, s48
    v_perm_b32 v19, v124, v120, s48
    v_mfma_f32_16x16x32_bf16 a[168:171], v[24:27], a[208:211], a[168:171]
    v_mfma_f32_16x16x32_bf16 a[172:175], v[24:27], a[212:215], a[172:175]
    buffer_load_dwordx4 v9, s[40:43], s55 offen lds
    s_cmp_eq_u32 s53, 0
    s_cbranch_scc1 L4_signal
L4_sig_back:
    v_mfma_f32_16x16x32_bf16 a[0:3], a[180:183], v[16:19], a[0:3]
    v_perm_b32 v20, v100, v96, s49
    v_perm_b32 v21, v108, v104, s49
    v_mfma_f32_16x16x32_bf16 a[4:7], a[184:187], v[16:19], a[4:7]
    v_perm_b32 v22, v116, v112, s49
    v_perm_b32 v23, v124, v120, s49
    v_mfma_f32_16x16x32_bf16 a[8:11], a[188:191], v[16:19], a[8:11]
    ds_read_b64_tr_b16 v[24:25], v11 offset:8192
    v_mfma_f32_16x16x32_bf16 a[12:15], a[192:195], v[16:19], a[12:15]
    buffer_load_dwordx4 v[64:67], v1, s[40:43], s50 offen
    v_mfma_f32_16x16x32_bf16 a[20:23], a[180:183], v[20:23], a[20:23]
    v_perm_b32 v16, v101, v97, s48
    v_perm_b32 v17, v109, v105, s48
    v_mfma_f32_16x16x32_bf16 a[24:27], a[184:187], v[20:23], a[24:27]
    v_perm_b32 v18, v117, v113, s48
    v_perm_b32 v19, v125, v121, s48
    v_mfma_f32_16x16x32_bf16 a[28:31], a[188:191], v[20:23], a[28:31]
    ds_read_b64_tr_b16 v[26:27], v11 offset:10240
    v_mfma_f32_16x16x32_bf16 a[32:35], a[192:195], v[20:23], a[32:35]
    buffer_load_dwordx4 v[68:71], v2, s[40:43], s50 offen
    v_mfma_f32_16x16x32_bf16 a[40:43], a[180:183], v[16:19], a[40:43]
    v_perm_b32 v20, v101, v97, s49
    v_perm_b32 v21, v109, v105, s49
    v_mfma_f32_16x16x32_bf16 a[44:47], a[184:187], v[16:19], a[44:47]
    v_perm_b32 v22, v117, v113, s49
    v_perm_b32 v23, v125, v121, s49
    v_mfma_f32_16x16x32_bf16 a[48:51], a[188:191], v[16:19], a[48:51]
    ds_read_b128 a[200:203], v10 offset:15360
    v_mfma_f32_16x16x32_bf16 a[52:55], a[192:195], v[16:19], a[52:55]
    buffer_load_dwordx4 v[72:75], v3, s[40:43], s50 offen
    v_mfma_f32_16x16x32_bf16 a[60:63], a[180:183], v[20:23], a[60:63]
    v_perm_b32 v16, v102, v98, s48
    v_perm_b32 v17, v110, v106, s48
    v_mfma_f32_16x16x32_bf16 a[64:67], a[184:187], v[20:23], a[64:67]
    v_perm_b32 v18, v118, v114, s48
    v_perm_b32 v19, v126, v122, s48
    v_mfma_f32_16x16x32_bf16 a[68:71], a[188:191], v[20:23], a[68:71]
    ds_read_b128 a[204:207], v10 offset:16384
    v_mfma_f32_16x16x32_bf16 a[72:75], a[192:195], v[20:23], a[72:75]
    buffer_load_dwordx4 v[76:79], v4, s[40:43], s50 offen
    v_mfma_f32_16x16x32_bf16 a[80:83], a[180:183], v[16:19], a[80:83]
    v_perm_b32 v20, v102, v98, s49
    v_perm_b32 v21, v110, v106, s49
    v_mfma_f32_16x16x32_bf16 a[84:87], a[184:187], v[16:19], a[84:87]
    v_perm_b32 v22, v118, v114, s49
    v_perm_b32 v23, v126, v122, s49
    v_mfma_f32_16x16x32_bf16 a[88:91], a[188:191], v[16:19], a[88:91]
    ds_read_b128 a[208:211], v10 offset:17408
    v_mfma_f32_16x16x32_bf16 a[92:95], a[192:195], v[16:19], a[92:95]
    buffer_load_dwordx4 v[80:83], v5, s[40:43], s50 offen
    v_mfma_f32_16x16x32_bf16 a[100:103], a[180:183], v[20:23], a[100:103]
    v_perm_b32 v16, v103, v99, s48
    v_perm_b32 v17, v111, v107, s48
    v_mfma_f32_16x16x32_bf16 a[104:107], a[184:187], v[20:23], a[104:107]
    v_perm_b32 v18, v119, v115, s48
    v_perm_b32 v19, v127, v123, s48
    v_mfma_f32_16x16x32_bf16 a[108:111], a[188:191], v[20:23], a[108:111]
    ds_read_b128 a[212:215], v10 offset:18432
    v_mfma_f32_16x16x32_bf16 a[112:115], a[192:195], v[20:23], a[112:115]
    buffer_load_dwordx4 v[84:87], v6, s[40:43], s50 offen
    v_mfma_f32_16x16x32_bf16 a[120:123], a[180:183], v[16:19], a[120:123]
    v_perm_b32 v20, v103, v99, s49
    v_perm_b32 v21, v111, v107, s49
    v_mfma_f32_16x16x32_bf16 a[124:127], a[184:187], v[16:19], a[124:127]
    v_perm_b32 v22, v119, v115, s49
    v_perm_b32 v23, v127, v123, s49
    v_mfma_f32_16x16x32_bf16 a[128:131], a[188:191], v[16:19], a[128:131]
    v_mfma_f32_16x16x32_bf16 a[132:135], a[192:195], v[16:19], a[132:135]
    buffer_load_dwordx4 v[88:91], v7, s[40:43], s50 offen
    v_mfma_f32_16x16x32_bf16 a[140:143], a[180:183], v[20:23], a[140:143]
    s_add_u32 s55, s50, s51
    v_mfma_f32_16x16x32_bf16 a[144:147], a[184:187], v[20:23], a[144:147]
    s_add_u32 m0, s52, 8192
    v_mfma_f32_16x16x32_bf16 a[148:151], a[188:191], v[20:23], a[148:151]
    s_waitcnt vmcnt(25) lgkmcnt(0)
    s_barrier
    v_mfma_f32_16x16x32_bf16 a[152:155], a[192:195], v[20:23], a[152:155]
    buffer_load_dwordx4 v[92:95], v8, s[40:43], s50 offen
    v_mfma_f32_16x16x32_bf16 a[160:163], v[24:27], a[180:183], a[160:163]
    v_perm_b32 v16, v132, v128, s48
    v_perm_b32 v17, v140, v136, s48
    v_mfma_f32_16x16x32_bf16 a[164:167], v[24:27], a[184:187], a[164:167]
    v_perm_b32 v18, v148, v144, s48
    v_perm_b32 v19, v156, v152, s48
    v_mfma_f32_16x16x32_bf16 a[168:171], v[24:27], a[188:191], a[168:171]
    v_mfma_f32_16x16x32_bf16 a[172:175], v[24:27], a[192:195], a[172:175]
    buffer_load_dwordx4 v9, s[40:43], s50 offen lds
    v_mfma_f32_16x16x32_bf16 a[0:3], a[200:203], v[16:19], a[0:3]
    v_perm_b32 v20, v132, v128, s49
    v_perm_b32 v21, v140, v136, s49
    v_mfma_f32_16x16x32_bf16 a[4:7], a[204:207], v[16:19], a[4:7]
    v_perm_b32 v22, v148, v144, s49
    v_perm_b32 v23, v156, v152, s49
    v_mfma_f32_16x16x32_bf16 a[8:11], a[208:211], v[16:19], a[8:11]
    ds_read_b64_tr_b16 v[24:25], v11 offset:12288
    v_mfma_f32_16x16x32_bf16 a[12:15], a[212:215], v[16:19], a[12:15]
    buffer_load_dwordx4 v[96:99], v1, s[40:43], s55 offen
    v_mfma_f32_16x16x32_bf16 a[20:23], a[200:203], v[20:23], a[20:23]
    v_perm_b32 v16, v133, v129, s48
    v_perm_b32 v17, v141, v137, s48
    v_mfma_f32_16x16x32_bf16 a[24:27], a[204:207], v[20:23], a[24:27]
    v_perm_b32 v18, v149, v145, s48
    v_perm_b32 v19, v157, v153, s48
    v_mfma_f32_16x16x32_bf16 a[28:31], a[208:211], v[20:23], a[28:31]
    ds_read_b64_tr_b16 v[26:27], v11 offset:14336
    v_mfma_f32_16x16x32_bf16 a[32:35], a[212:215], v[20:23], a[32:35]
    buffer_load_dwordx4 v[100:103], v2, s[40:43], s55 offen
    v_mfma_f32_16x16x32_bf16 a[40:43], a[200:203], v[16:19], a[40:43]
    v_perm_b32 v20, v133, v129, s49
    v_perm_b32 v21, v141, v137, s49
    v_mfma_f32_16x16x32_bf16 a[44:47], a[204:207], v[16:19], a[44:47]
    v_perm_b32 v22, v149, v145, s49
    v_perm_b32 v23, v157, v153, s49
    v_mfma_f32_16x16x32_bf16 a[48:51], a[208:211], v[16:19], a[48:51]
    ds_read_b128 a[180:183], v10 offset:20480
    v_mfma_f32_16x16x32_bf16 a[52:55], a[212:215], v[16:19], a[52:55]
    buffer_load_dwordx4 v[104:107], v3, s[40:43], s55 offen
    v_mfma_f32_16x16x32_bf16 a[60:63], a[200:203], v[20:23], a[60:63]
    v_perm_b32 v16, v134, v130, s48
    v_perm_b32 v17, v142, v138, s48
    v_mfma_f32_16x16x32_bf16 a[64:67], a[204:207], v[20:23], a[64:67]
    v_perm_b32 v18, v150, v146, s48
    v_perm_b32 v19, v158, v154, s48
    v_mfma_f32_16x16x32_bf16 a[68:71], a[208:211], v[20:23], a[68:71]
    ds_read_b128 a[184:187], v10 offset:21504
    v_mfma_f32_16x16x32_bf16 a[72:75], a[212:215], v[20:23], a[72:75]
    buffer_load_dwordx4 v[108:111], v4, s[40:43], s55 offen
    v_mfma_f32_16x16x32_bf16 a[80:83], a[200:203], v[16:19], a[80:83]
    v_perm_b32 v20, v134, v130, s49
    v_perm_b32 v21, v142, v138, s49
    v_mfma_f32_16x16x32_bf16 a[84:87], a[204:207], v[16:19], a[84:87]
    v_perm_b32 v22, v150, v146, s49
    v_perm_b32 v23, v158, v154, s49
    v_mfma_f32_16x16x32_bf16 a[88:91], a[208:211], v[16:19], a[88:91]
    ds_read_b128 a[188:191], v10 offset:22528
    v_mfma_f32_16x16x32_bf16 a[92:95], a[212:215], v[16:19], a[92:95]
    buffer_load_dwordx4 v[112:115], v5, s[40:43], s55 offen
    v_mfma_f32_16x16x32_bf16 a[100:103], a[200:203], v[20:23], a[100:103]
    v_perm_b32 v16, v135, v131, s48
    v_perm_b32 v17, v143, v139, s48
    v_mfma_f32_16x16x32_bf16 a[104:107], a[204:207], v[20:23], a[104:107]
    v_perm_b32 v18, v151, v147, s48
    v_perm_b32 v19, v159, v155, s48
    v_mfma_f32_16x16x32_bf16 a[108:111], a[208:211], v[20:23], a[108:111]
    ds_read_b128 a[192:195], v10 offset:23552
    v_mfma_f32_16x16x32_bf16 a[112:115], a[212:215], v[20:23], a[112:115]
    buffer_load_dwordx4 v[116:119], v6, s[40:43], s55 offen
    v_mfma_f32_16x16x32_bf16 a[120:123], a[200:203], v[16:19], a[120:123]
    v_perm_b32 v20, v135, v131, s49
    v_perm_b32 v21, v143, v139, s49
    v_mfma_f32_16x16x32_bf16 a[124:127], a[204:207], v[16:19], a[124:127]
    v_perm_b32 v22, v151, v147, s49
    v_perm_b32 v23, v159, v155, s49
    v_mfma_f32_16x16x32_bf16 a[128:131], a[208:211], v[16:19], a[128:131]
    v_mfma_f32_16x16x32_bf16 a[132:135], a[212:215], v[16:19], a[132:135]
    buffer_load_dwordx4 v[120:123], v7, s[40:43], s55 offen
    v_mfma_f32_16x16x32_bf16 a[140:143], a[200:203], v[20:23], a[140:143]
    s_add_u32 s50, s55, s51
    v_mfma_f32_16x16x32_bf16 a[144:147], a[204:207], v[20:23], a[144:147]
    s_add_u32 m0, s52, 12288
    v_mfma_f32_16x16x32_bf16 a[148:151], a[208:211], v[20:23], a[148:151]
    s_waitcnt vmcnt(34) lgkmcnt(0)
    v_mfma_f32_16x16x32_bf16 a[152:155], a[212:215], v[20:23], a[152:155]
    buffer_load_dwordx4 v[124:127], v8, s[40:43], s55 offen
    v_mfma_f32_16x16x32_bf16 a[160:163], v[24:27], a[200:203], a[160:163]
    v_perm_b32 v16, v164, v160, s48
    v_perm_b32 v17, v172, v168, s48
    v_mfma_f32_16x16x32_bf16 a[164:167], v[24:27], a[204:207], a[164:167]
    v_perm_b32 v18, v180, v176, s48
    v_perm_b32 v19, v188, v184, s48
    v_mfma_f32_16x16x32_bf16 a[168:171], v[24:27], a[208:211], a[168:171]
    v_mfma_f32_16x16x32_bf16 a[172:175], v[24:27], a[212:215], a[172:175]
    buffer_load_dwordx4 v9, s[40:43], s55 offen lds
    v_mfma_f32_16x16x32_bf16 a[0:3], a[180:183], v[16:19], a[0:3]
    v_perm_b32 v20, v164, v160, s49
    v_perm_b32 v21, v172, v168, s49
    v_mfma_f32_16x16x32_bf16 a[4:7], a[184:187], v[16:19], a[4:7]
    v_perm_b32 v22, v180, v176, s49
    v_perm_b32 v23, v188, v184, s49
    v_mfma_f32_16x16x32_bf16 a[8:11], a[188:191], v[16:19], a[8:11]
    ds_read_b64_tr_b16 v[24:25], v11 offset:16384
    v_mfma_f32_16x16x32_bf16 a[12:15], a[192:195], v[16:19], a[12:15]
    buffer_load_dwordx4 v[128:131], v1, s[40:43], s50 offen
    v_mfma_f32_16x16x32_bf16 a[20:23], a[180:183], v[20:23], a[20:23]
    v_perm_b32 v16, v165, v161, s48
    v_perm_b32 v17, v173, v169, s48
    v_mfma_f32_16x16x32_bf16 a[24:27], a[184:187], v[20:23], a[24:27]
    v_perm_b32 v18, v181, v177, s48
    v_perm_b32 v19, v189, v185, s48
    v_mfma_f32_16x16x32_bf16 a[28:31], a[188:191], v[20:23], a[28:31]
    ds_read_b64_tr_b16 v[26:27], v11 offset:18432
    v_mfma_f32_16x16x32_bf16 a[32:35], a[192:195], v[20:23], a[32:35]
    buffer_load_dwordx4 v[132:135], v2, s[40:43], s50 offen
    v_mfma_f32_16x16x32_bf16 a[40:43], a[180:183], v[16:19], a[40:43]
    v_perm_b32 v20, v165, v161, s49
    v_perm_b32 v21, v173, v169, s49
    v_mfma_f32_16x16x32_bf16 a[44:47], a[184:187], v[16:19], a[44:47]
    v_perm_b32 v22, v181, v177, s49
    v_perm_b32 v23, v189, v185, s49
    v_mfma_f32_16x16x32_bf16 a[48:51], a[188:191], v[16:19], a[48:51]
    ds_read_b128 a[200:203], v10 offset:25600
    v_mfma_f32_16x16x32_bf16 a[52:55], a[192:195], v[16:19], a[52:55]
    buffer_load_dwordx4 v[136:139], v3, s[40:43], s50 offen
    v_mfma_f32_16x16x32_bf16 a[60:63], a[180:183], v[20:23], a[60:63]
    v_perm_b32 v16, v166, v162, s48
    v_perm_b32 v17, v174, v170, s48
    v_mfma_f32_16x16x32_bf16 a[64:67], a[184:187], v[20:23], a[64:67]
    v_perm_b32 v18, v182, v178, s48
    v_perm_b32 v19, v190, v186, s48
    v_mfma_f32_16x16x32_bf16 a[68:71], a[188:191], v[20:23], a[68:71]
    ds_read_b128 a[204:207], v10 offset:26624
    v_mfma_f32_16x16x32_bf16 a[72:75], a[192:195], v[20:23], a[72:75]
    buffer_load_dwordx4 v[140:143], v4, s[40:43], s50 offen
    v_mfma_f32_16x16x32_bf16 a[80:83], a[180:183], v[16:19], a[80:83]
    v_perm_b32 v20, v166, v162, s49
    v_perm_b32 v21, v174, v170, s49
    v_mfma_f32_16x16x32_bf16 a[84:87], a[184:187], v[16:19], a[84:87]
    v_perm_b32 v22, v182, v178, s49
    v_perm_b32 v23, v190, v186, s49
    v_mfma_f32_16x16x32_bf16 a[88:91], a[188:191], v[16:19], a[88:91]
    ds_read_b128 a[208:211], v10 offset:27648
    v_mfma_f32_16x16x32_bf16 a[92:95], a[192:195], v[16:19], a[92:95]
    buffer_load_dwordx4 v[144:147], v5, s[40:43], s50 offen
    v_mfma_f32_16x16x32_bf16 a[100:103], a[180:183], v[20:23], a[100:103]
    v_perm_b32 v16, v167, v163, s48
    v_perm_b32 v17, v175, v171, s48
    v_mfma_f32_16x16x32_bf16 a[104:107], a[184:187], v[20:23], a[104:107]
    v_perm_b32 v18, v183, v179, s48
    v_perm_b32 v19, v191, v187, s48
    v_mfma_f32_16x16x32_bf16 a[108:111], a[188:191], v[20:23], a[108:111]
    ds_read_b128 a[212:215], v10 offset:28672
    v_mfma_f32_16x16x32_bf16 a[112:115], a[192:195], v[20:23], a[112:115]
    buffer_load_dwordx4 v[148:151], v6, s[40:43], s50 offen
    v_mfma_f32_16x16x32_bf16 a[120:123], a[180:183], v[16:19], a[120:123]
    v_perm_b32 v20, v167, v163, s49
    v_perm_b32 v21, v175, v171, s49
    v_mfma_f32_16x16x32_bf16 a[124:127], a[184:187], v[16:19], a[124:127]
    v_perm_b32 v22, v183, v179, s49
    v_perm_b32 v23, v191, v187, s49
    v_mfma_f32_16x16x32_bf16 a[128:131], a[188:191], v[16:19], a[128:131]
    v_mfma_f32_16x16x32_bf16 a[132:135], a[192:195], v[16:19], a[132:135]
    buffer_load_dwordx4 v[152:155], v7, s[40:43], s50 offen
    v_mfma_f32_16x16x32_bf16 a[140:143], a[180:183], v[20:23], a[140:143]
    s_add_u32 s55, s50, s51
    v_mfma_f32_16x16x32_bf16 a[144:147], a[184:187], v[20:23], a[144:147]
    s_add_u32 m0, s52, 16384
    v_mfma_f32_16x16x32_bf16 a[148:151], a[188:191], v[20:23], a[148:151]
    s_waitcnt vmcnt(25) lgkmcnt(0)
    s_barrier
    v_mfma_f32_16x16x32_bf16 a[152:155], a[192:195], v[20:23], a[152:155]
    buffer_load_dwordx4 v[156:159], v8, s[40:43], s50 offen
    v_mfma_f32_16x16x32_bf16 a[160:163], v[24:27], a[180:183], a[160:163]
    v_perm_b32 v16, v196, v192, s48
    v_perm_b32 v17, v204, v200, s48
    v_mfma_f32_16x16x32_bf16 a[164:167], v[24:27], a[184:187], a[164:167]
    v_perm_b32 v18, v212, v208, s48
    v_perm_b32 v19, v220, v216, s48
    v_mfma_f32_16x16x32_bf16 a[168:171], v[24:27], a[188:191], a[168:171]
    v_mfma_f32_16x16x32_bf16 a[172:175], v[24:27], a[192:195], a[172:175]
    buffer_load_dwordx4 v9, s[40:43], s50 offen lds
    v_mfma_f32_16x16x32_bf16 a[0:3], a[200:203], v[16:19], a[0:3]
    v_perm_b32 v20, v196, v192, s49
    v_perm_b32 v21, v204, v200, s49
    v_mfma_f32_16x16x32_bf16 a[4:7], a[204:207], v[16:19], a[4:7]
    v_perm_b32 v22, v212, v208, s49
    v_perm_b32 v23, v220, v216, s49
    v_mfma_f32_16x16x32_bf16 a[8:11], a[208:211], v[16:19], a[8:11]
    ds_read_b64_tr_b16 v[24:25], v11 offset:20480
    v_mfma_f32_16x16x32_bf16 a[12:15], a[212:215], v[16:19], a[12:15]
    buffer_load_dwordx4 v[160:163], v1, s[40:43], s55 offen
    v_mfma_f32_16x16x32_bf16 a[20:23], a[200:203], v[20:23], a[20:23]
    v_perm_b32 v16, v197, v193, s48
    v_perm_b32 v17, v205, v201, s48
    v_mfma_f32_16x16x32_bf16 a[24:27], a[204:207], v[20:23], a[24:27]
    v_perm_b32 v18, v213, v209, s48
    v_perm_b32 v19, v221, v217, s48
    v_mfma_f32_16x16x32_bf16 a[28:31], a[208:211], v[20:23], a[28:31]
    ds_read_b64_tr_b16 v[26:27], v11 offset:22528
    v_mfma_f32_16x16x32_bf16 a[32:35], a[212:215], v[20:23], a[32:35]
    buffer_load_dwordx4 v[164:167], v2, s[40:43], s55 offen
    v_mfma_f32_16x16x32_bf16 a[40:43], a[200:203], v[16:19], a[40:43]
    v_perm_b32 v20, v197, v193, s49
    v_perm_b32 v21, v205, v201, s49
    v_mfma_f32_16x16x32_bf16 a[44:47], a[204:207], v[16:19], a[44:47]
    v_perm_b32 v22, v213, v209, s49
    v_perm_b32 v23, v221, v217, s49
    v_mfma_f32_16x16x32_bf16 a[48:51], a[208:211], v[16:19], a[48:51]
    ds_read_b128 a[180:183], v10 offset:30720
    v_mfma_f32_16x16x32_bf16 a[52:55], a[212:215], v[16:19], a[52:55]
    buffer_load_dwordx4 v[168:171], v3, s[40:43], s55 offen
    v_mfma_f32_16x16x32_bf16 a[60:63], a[200:203], v[20:23], a[60:63]
    v_perm_b32 v16, v198, v194, s48
    v_perm_b32 v17, v206, v202, s48
    v_mfma_f32_16x16x32_bf16 a[64:67], a[204:207], v[20:23], a[64:67]
    v_perm_b32 v18, v214, v210, s48
    v_perm_b32 v19, v222, v218, s48
    v_mfma_f32_16x16x32_bf16 a[68:71], a[208:211], v[20:23], a[68:71]
    ds_read_b128 a[184:187], v10 offset:31744
    v_mfma_f32_16x16x32_bf16 a[72:75], a[212:215], v[20:23], a[72:75]
    buffer_load_dwordx4 v[172:175], v4, s[40:43], s55 offen
    v_mfma_f32_16x16x32_bf16 a[80:83], a[200:203], v[16:19], a[80:83]
    v_perm_b32 v20, v198, v194, s49
    v_perm_b32 v21, v206, v202, s49
    v_mfma_f32_16x16x32_bf16 a[84:87], a[204:207], v[16:19], a[84:87]
    v_perm_b32 v22, v214, v210, s49
    v_perm_b32 v23, v222, v218, s49
    v_mfma_f32_16x16x32_bf16 a[88:91], a[208:211], v[16:19], a[88:91]
    ds_read_b128 a[188:191], v10 offset:32768
    v_mfma_f32_16x16x32_bf16 a[92:95], a[212:215], v[16:19], a[92:95]
    buffer_load_dwordx4 v[176:179], v5, s[40:43], s55 offen
    v_mfma_f32_16x16x32_bf16 a[100:103], a[200:203], v[20:23], a[100:103]
    v_perm_b32 v16, v199, v195, s48
    v_perm_b32 v17, v207, v203, s48
    v_mfma_f32_16x16x32_bf16 a[104:107], a[204:207], v[20:23], a[104:107]
    v_perm_b32 v18, v215, v211, s48
    v_perm_b32 v19, v223, v219, s48
    v_mfma_f32_16x16x32_bf16 a[108:111], a[208:211], v[20:23], a[108:111]
    ds_read_b128 a[192:195], v10 offset:33792
    v_mfma_f32_16x16x32_bf16 a[112:115], a[212:215], v[20:23], a[112:115]
    buffer_load_dwordx4 v[180:183], v6, s[40:43], s55 offen
    v_mfma_f32_16x16x32_bf16 a[120:123], a[200:203], v[16:19], a[120:123]
    v_perm_b32 v20, v199, v195, s49
    v_perm_b32 v21, v207, v203, s49
    v_mfma_f32_16x16x32_bf16 a[124:127], a[204:207], v[16:19], a[124:127]
    v_perm_b32 v22, v215, v211, s49
    v_perm_b32 v23, v223, v219, s49
    v_mfma_f32_16x16x32_bf16 a[128:131], a[208:211], v[16:19], a[128:131]
    v_add_u32 v10, 30720, v10
    v_mfma_f32_16x16x32_bf16 a[132:135], a[212:215], v[16:19], a[132:135]
    buffer_load_dwordx4 v[184:187], v7, s[40:43], s55 offen
    v_mfma_f32_16x16x32_bf16 a[140:143], a[200:203], v[20:23], a[140:143]
    s_add_u32 s50, s55, s51
    v_mfma_f32_16x16x32_bf16 a[144:147], a[204:207], v[20:23], a[144:147]
    s_add_u32 m0, s52, 20480
    v_mfma_f32_16x16x32_bf16 a[148:151], a[208:211], v[20:23], a[148:151]
    s_waitcnt vmcnt(34) lgkmcnt(0)
    v_mfma_f32_16x16x32_bf16 a[152:155], a[212:215], v[20:23], a[152:155]
    buffer_load_dwordx4 v[188:191], v8, s[40:43], s55 offen
    v_mfma_f32_16x16x32_bf16 a[160:163], v[24:27], a[200:203], a[160:163]
    v_perm_b32 v16, v36, v32, s48
    v_perm_b32 v17, v44, v40, s48
    v_mfma_f32_16x16x32_bf16 a[164:167], v[24:27], a[204:207], a[164:167]
    v_perm_b32 v18, v52, v48, s48
    v_perm_b32 v19, v60, v56, s48
    v_mfma_f32_16x16x32_bf16 a[168:171], v[24:27], a[208:211], a[168:171]
    s_add_u32 s53, s53, 1
    v_mfma_f32_16x16x32_bf16 a[172:175], v[24:27], a[212:215], a[172:175]
    s_bitcmp1_b32 22, s53
    buffer_load_dwordx4 v9, s[40:43], s55 offen lds
    s_cbranch_scc1 L4_gemm_loop
    s_cmp_eq_u32 s53, 3
    s_cbranch_scc1 L4_silu
L4_tail:
    v_mfma_f32_16x16x32_bf16 a[0:3], a[180:183], v[16:19], a[0:3]
    v_perm_b32 v20, v36, v32, s49
    v_perm_b32 v21, v44, v40, s49
    v_mfma_f32_16x16x32_bf16 a[4:7], a[184:187], v[16:19], a[4:7]
    v_perm_b32 v22, v52, v48, s49
    v_perm_b32 v23, v60, v56, s49
    v_mfma_f32_16x16x32_bf16 a[8:11], a[188:191], v[16:19], a[8:11]
    ds_read_b64_tr_b16 v[24:25], v11 offset:0
    v_accvgpr_read_b32 v28, a246
    v_mfma_f32_16x16x32_bf16 a[12:15], a[192:195], v[16:19], a[12:15]
    buffer_load_dwordx4 v[192:195], v1, s[40:43], s50 offen
    v_accvgpr_read_b32 v29, a247
    v_mfma_f32_16x16x32_bf16 a[20:23], a[180:183], v[20:23], a[20:23]
    v_perm_b32 v16, v37, v33, s48
    v_perm_b32 v17, v45, v41, s48
    v_mfma_f32_16x16x32_bf16 a[24:27], a[184:187], v[20:23], a[24:27]
    v_perm_b32 v18, v53, v49, s48
    v_perm_b32 v19, v61, v57, s48
    v_mfma_f32_16x16x32_bf16 a[28:31], a[188:191], v[20:23], a[28:31]
    ds_read_b64_tr_b16 v[26:27], v11 offset:2048
    v_accvgpr_read_b32 v30, a248
    v_mfma_f32_16x16x32_bf16 a[32:35], a[192:195], v[20:23], a[32:35]
    buffer_load_dwordx4 v[196:199], v2, s[40:43], s50 offen
    v_accvgpr_read_b32 v31, a249
    v_mfma_f32_16x16x32_bf16 a[40:43], a[180:183], v[16:19], a[40:43]
    v_perm_b32 v20, v37, v33, s49
    v_perm_b32 v21, v45, v41, s49
    v_mfma_f32_16x16x32_bf16 a[44:47], a[184:187], v[16:19], a[44:47]
    v_perm_b32 v22, v53, v49, s49
    v_perm_b32 v23, v61, v57, s49
    v_mfma_f32_16x16x32_bf16 a[48:51], a[188:191], v[16:19], a[48:51]
    ds_read_b128 a[200:203], v10 offset:5120
    v_accvgpr_read_b32 v250, a244
    v_mfma_f32_16x16x32_bf16 a[52:55], a[192:195], v[16:19], a[52:55]
    buffer_load_dwordx4 v[200:203], v3, s[40:43], s50 offen
    v_accvgpr_read_b32 v252, a245
    v_mfma_f32_16x16x32_bf16 a[60:63], a[180:183], v[20:23], a[60:63]
    v_perm_b32 v16, v38, v34, s48
    v_perm_b32 v17, v46, v42, s48
    v_mfma_f32_16x16x32_bf16 a[64:67], a[184:187], v[20:23], a[64:67]
    v_perm_b32 v18, v54, v50, s48
    v_perm_b32 v19, v62, v58, s48
    v_mfma_f32_16x16x32_bf16 a[68:71], a[188:191], v[20:23], a[68:71]
    ds_read_b128 a[204:207], v10 offset:6144
    v_add_u32 v251, 4096, v250
    v_mfma_f32_16x16x32_bf16 a[72:75], a[192:195], v[20:23], a[72:75]
    buffer_load_dwordx4 v[204:207], v4, s[40:43], s50 offen
    v_mov_b32 v253, 128
    v_mfma_f32_16x16x32_bf16 a[80:83], a[180:183], v[16:19], a[80:83]
    v_perm_b32 v20, v38, v34, s49
    v_perm_b32 v21, v46, v42, s49
    v_mfma_f32_16x16x32_bf16 a[84:87], a[184:187], v[16:19], a[84:87]
    v_perm_b32 v22, v54, v50, s49
    v_perm_b32 v23, v62, v58, s49
    v_mfma_f32_16x16x32_bf16 a[88:91], a[188:191], v[16:19], a[88:91]
    ds_read_b128 a[208:211], v10 offset:10240
    v_and_b32 v1, 7, v13
    v_mfma_f32_16x16x32_bf16 a[92:95], a[192:195], v[16:19], a[92:95]
    buffer_load_dwordx4 v[208:211], v5, s[40:43], s50 offen
    v_lshlrev_b32 v1, 7, v1
    v_mfma_f32_16x16x32_bf16 a[100:103], a[180:183], v[20:23], a[100:103]
    v_perm_b32 v16, v39, v35, s48
    v_perm_b32 v17, v47, v43, s48
    v_mfma_f32_16x16x32_bf16 a[104:107], a[184:187], v[20:23], a[104:107]
    v_perm_b32 v18, v55, v51, s48
    v_perm_b32 v19, v63, v59, s48
    v_mfma_f32_16x16x32_bf16 a[108:111], a[188:191], v[20:23], a[108:111]
    ds_read_b128 a[212:215], v10 offset:11264
    v_mfma_f32_16x16x32_bf16 a[112:115], a[192:195], v[20:23], a[112:115]
    buffer_load_dwordx4 v[212:215], v6, s[40:43], s50 offen
    s_mov_b32 s76, s97
    v_mfma_f32_16x16x32_bf16 a[120:123], a[180:183], v[16:19], a[120:123]
    v_perm_b32 v20, v39, v35, s49
    v_perm_b32 v21, v47, v43, s49
    v_mfma_f32_16x16x32_bf16 a[124:127], a[184:187], v[16:19], a[124:127]
    v_perm_b32 v22, v55, v51, s49
    v_perm_b32 v23, v63, v59, s49
    v_mfma_f32_16x16x32_bf16 a[128:131], a[188:191], v[16:19], a[128:131]
    ds_read_b128 a[216:219], v10 offset:15360
    v_mfma_f32_16x16x32_bf16 a[132:135], a[192:195], v[16:19], a[132:135]
    buffer_load_dwordx4 v[216:219], v7, s[40:43], s50 offen
    s_mov_b32 s96, 4194304
    v_mfma_f32_16x16x32_bf16 a[140:143], a[180:183], v[20:23], a[140:143]
    s_add_u32 s77, s97, 18432
    s_add_u32 s78, s97, 36864
    v_mfma_f32_16x16x32_bf16 a[144:147], a[184:187], v[20:23], a[144:147]
    s_add_u32 m0, s52, 24576
    s_add_u32 s79, s97, 55296
    v_mfma_f32_16x16x32_bf16 a[148:151], a[188:191], v[20:23], a[148:151]
    s_waitcnt vmcnt(25) lgkmcnt(0)
    s_barrier
    v_mfma_f32_16x16x32_bf16 a[152:155], a[192:195], v[20:23], a[152:155]
    v_perm_b32 v32, v68, v64, s48
    v_perm_b32 v33, v76, v72, s48
    buffer_load_dwordx4 v[220:223], v8, s[40:43], s50 offen
    v_mfma_f32_16x16x32_bf16 a[160:163], v[24:27], a[180:183], a[160:163]
    v_perm_b32 v34, v84, v80, s48
    v_perm_b32 v35, v92, v88, s48
    v_mfma_f32_16x16x32_bf16 a[164:167], v[24:27], a[184:187], a[164:167]
    v_perm_b32 v36, v68, v64, s49
    v_perm_b32 v37, v76, v72, s49
    v_mfma_f32_16x16x32_bf16 a[168:171], v[24:27], a[188:191], a[168:171]
    v_perm_b32 v38, v84, v80, s49
    v_perm_b32 v39, v92, v88, s49
    v_mfma_f32_16x16x32_bf16 a[172:175], v[24:27], a[192:195], a[172:175]
    buffer_load_dwordx4 v9, s[40:43], s50 offen lds
    global_load_dword v249, v1, s[100:101] offset:256 sc1
    v_mfma_f32_16x16x32_bf16 a[0:3], a[200:203], v[32:35], a[0:3]
    ds_read_b64_tr_b16 a[220:221], v11 offset:4096
    v_mfma_f32_16x16x32_bf16 a[4:7], a[204:207], v[32:35], a[4:7]
    v_perm_b32 v40, v69, v65, s48
    v_perm_b32 v41, v77, v73, s48
    v_mfma_f32_16x16x32_bf16 a[20:23], a[200:203], v[36:39], a[20:23]
    v_perm_b32 v42, v85, v81, s48
    v_perm_b32 v43, v93, v89, s48
    v_mfma_f32_16x16x32_bf16 a[24:27], a[204:207], v[36:39], a[24:27]
    v_perm_b32 v44, v69, v65, s49
    v_perm_b32 v45, v77, v73, s49
    v_mfma_f32_16x16x32_bf16 a[40:43], a[200:203], v[40:43], a[40:43]
    v_perm_b32 v46, v85, v81, s49
    v_perm_b32 v47, v93, v89, s49
    v_mfma_f32_16x16x32_bf16 a[44:47], a[204:207], v[40:43], a[44:47]
    v_perm_b32 v48, v70, v66, s48
    v_perm_b32 v49, v78, v74, s48
    v_mfma_f32_16x16x32_bf16 a[60:63], a[200:203], v[44:47], a[60:63]
    v_perm_b32 v50, v86, v82, s48
    v_perm_b32 v51, v94, v90, s48
    v_mfma_f32_16x16x32_bf16 a[64:67], a[204:207], v[44:47], a[64:67]
    v_perm_b32 v52, v70, v66, s49
    v_perm_b32 v53, v78, v74, s49
    v_mfma_f32_16x16x32_bf16 a[80:83], a[200:203], v[48:51], a[80:83]
    v_perm_b32 v54, v86, v82, s49
    v_perm_b32 v55, v94, v90, s49
    ds_read_b64_tr_b16 a[222:223], v11 offset:6144
    v_mfma_f32_16x16x32_bf16 a[84:87], a[204:207], v[48:51], a[84:87]
    v_perm_b32 v56, v71, v67, s48
    v_perm_b32 v57, v79, v75, s48
    v_mfma_f32_16x16x32_bf16 a[100:103], a[200:203], v[52:55], a[100:103]
    v_perm_b32 v58, v87, v83, s48
    v_perm_b32 v59, v95, v91, s48
    v_mfma_f32_16x16x32_bf16 a[104:107], a[204:207], v[52:55], a[104:107]
    v_perm_b32 v60, v71, v67, s49
    v_perm_b32 v61, v79, v75, s49
    v_mfma_f32_16x16x32_bf16 a[120:123], a[200:203], v[56:59], a[120:123]
    v_perm_b32 v62, v87, v83, s49
    v_perm_b32 v63, v95, v91, s49
    v_mfma_f32_16x16x32_bf16 a[124:127], a[204:207], v[56:59], a[124:127]
    ds_read_b128 a[240:243], v10 offset:16384
    v_mfma_f32_16x16x32_bf16 a[140:143], a[200:203], v[60:63], a[140:143]
    ds_read_b128 a[244:247], v10 offset:20480
    v_mfma_f32_16x16x32_bf16 a[144:147], a[204:207], v[60:63], a[144:147]
    s_waitcnt vmcnt(28)
    s_barrier
    v_perm_b32 v64, v100, v96, s48
    v_perm_b32 v65, v108, v104, s48
    s_waitcnt lgkmcnt(2)
    v_mfma_f32_16x16x32_bf16 a[160:163], a[220:223], a[200:203], a[160:163]
    v_perm_b32 v66, v116, v112, s48
    v_perm_b32 v67, v124, v120, s48
    v_mfma_f32_16x16x32_bf16 a[164:167], a[220:223], a[204:207], a[164:167]
    v_perm_b32 v68, v100, v96, s49
    v_perm_b32 v69, v108, v104, s49
    v_mfma_f32_16x16x32_bf16 a[0:3], a[208:211], v[64:67], a[0:3]
    v_perm_b32 v70, v116, v112, s49
    v_perm_b32 v71, v124, v120, s49
    v_mfma_f32_16x16x32_bf16 a[4:7], a[212:215], v[64:67], a[4:7]
    v_perm_b32 v72, v101, v97, s48
    v_perm_b32 v73, v109, v105, s48
    v_mfma_f32_16x16x32_bf16 a[20:23], a[208:211], v[68:71], a[20:23]
    v_perm_b32 v74, v117, v113, s48
    v_perm_b32 v75, v125, v121, s48
    v_mfma_f32_16x16x32_bf16 a[24:27], a[212:215], v[68:71], a[24:27]
    v_perm_b32 v76, v101, v97, s49
    v_perm_b32 v77, v109, v105, s49
    v_mfma_f32_16x16x32_bf16 a[40:43], a[208:211], v[72:75], a[40:43]
    v_perm_b32 v78, v117, v113, s49
    v_perm_b32 v79, v125, v121, s49
    v_mfma_f32_16x16x32_bf16 a[44:47], a[212:215], v[72:75], a[44:47]
    v_perm_b32 v80, v102, v98, s48
    v_perm_b32 v81, v110, v106, s48
    v_mfma_f32_16x16x32_bf16 a[60:63], a[208:211], v[76:79], a[60:63]
    v_perm_b32 v82, v118, v114, s48
    v_perm_b32 v83, v126, v122, s48
    v_mfma_f32_16x16x32_bf16 a[64:67], a[212:215], v[76:79], a[64:67]
    v_perm_b32 v84, v102, v98, s49
    v_perm_b32 v85, v110, v106, s49
    v_mfma_f32_16x16x32_bf16 a[80:83], a[208:211], v[80:83], a[80:83]
    v_perm_b32 v86, v118, v114, s49
    v_perm_b32 v87, v126, v122, s49
    ds_read_b64_tr_b16 a[224:225], v11 offset:8192
    v_mfma_f32_16x16x32_bf16 a[84:87], a[212:215], v[80:83], a[84:87]
    v_perm_b32 v88, v103, v99, s48
    v_perm_b32 v89, v111, v107, s48
    ds_read_b64_tr_b16 a[226:227], v11 offset:10240
    v_mfma_f32_16x16x32_bf16 a[100:103], a[208:211], v[84:87], a[100:103]
    v_perm_b32 v90, v119, v115, s48
    v_perm_b32 v91, v127, v123, s48
    v_mfma_f32_16x16x32_bf16 a[104:107], a[212:215], v[84:87], a[104:107]
    v_perm_b32 v92, v103, v99, s49
    v_perm_b32 v93, v111, v107, s49
    v_mfma_f32_16x16x32_bf16 a[120:123], a[208:211], v[88:91], a[120:123]
    v_perm_b32 v94, v119, v115, s49
    v_perm_b32 v95, v127, v123, s49
    v_mfma_f32_16x16x32_bf16 a[124:127], a[212:215], v[88:91], a[124:127]
    ds_read_b128 a[248:251], v10 offset:21504
    v_mfma_f32_16x16x32_bf16 a[140:143], a[208:211], v[92:95], a[140:143]
    ds_read_b128 a[252:255], v10 offset:25600
    v_mfma_f32_16x16x32_bf16 a[144:147], a[212:215], v[92:95], a[144:147]
    s_waitcnt vmcnt(19)
    s_barrier
    v_perm_b32 v96, v132, v128, s48
    v_perm_b32 v97, v140, v136, s48
    s_waitcnt lgkmcnt(2)
    v_mfma_f32_16x16x32_bf16 a[160:163], a[224:227], a[208:211], a[160:163]
    v_perm_b32 v98, v148, v144, s48
    v_perm_b32 v99, v156, v152, s48
    v_mfma_f32_16x16x32_bf16 a[164:167], a[224:227], a[212:215], a[164:167]
    v_perm_b32 v100, v132, v128, s49
    v_perm_b32 v101, v140, v136, s49
    v_mfma_f32_16x16x32_bf16 a[0:3], a[216:219], v[96:99], a[0:3]
    v_perm_b32 v102, v148, v144, s49
    v_perm_b32 v103, v156, v152, s49
    s_waitcnt lgkmcnt(5)
    v_mfma_f32_16x16x32_bf16 a[4:7], a[240:243], v[96:99], a[4:7]
    v_perm_b32 v104, v133, v129, s48
    v_perm_b32 v105, v141, v137, s48
    v_mfma_f32_16x16x32_bf16 a[20:23], a[216:219], v[100:103], a[20:23]
    v_perm_b32 v106, v149, v145, s48
    v_perm_b32 v107, v157, v153, s48
    v_mfma_f32_16x16x32_bf16 a[24:27], a[240:243], v[100:103], a[24:27]
    v_perm_b32 v108, v133, v129, s49
    v_perm_b32 v109, v141, v137, s49
    v_mfma_f32_16x16x32_bf16 a[40:43], a[216:219], v[104:107], a[40:43]
    v_perm_b32 v110, v149, v145, s49
    v_perm_b32 v111, v157, v153, s49
    v_mfma_f32_16x16x32_bf16 a[44:47], a[240:243], v[104:107], a[44:47]
    v_perm_b32 v112, v134, v130, s48
    v_perm_b32 v113, v142, v138, s48
    v_mfma_f32_16x16x32_bf16 a[60:63], a[216:219], v[108:111], a[60:63]
    v_perm_b32 v114, v150, v146, s48
    v_perm_b32 v115, v158, v154, s48
    v_mfma_f32_16x16x32_bf16 a[64:67], a[240:243], v[108:111], a[64:67]
    v_perm_b32 v116, v134, v130, s49
    v_perm_b32 v117, v142, v138, s49
    v_mfma_f32_16x16x32_bf16 a[80:83], a[216:219], v[112:115], a[80:83]
    v_perm_b32 v118, v150, v146, s49
    v_perm_b32 v119, v158, v154, s49
    ds_read_b64_tr_b16 a[228:229], v11 offset:12288
    v_mfma_f32_16x16x32_bf16 a[84:87], a[240:243], v[112:115], a[84:87]
    v_perm_b32 v120, v135, v131, s48
    v_perm_b32 v121, v143, v139, s48
    ds_read_b64_tr_b16 a[230:231], v11 offset:14336
    v_mfma_f32_16x16x32_bf16 a[100:103], a[216:219], v[116:119], a[100:103]
    v_perm_b32 v122, v151, v147, s48
    v_perm_b32 v123, v159, v155, s48
    v_mfma_f32_16x16x32_bf16 a[104:107], a[240:243], v[116:119], a[104:107]
    v_perm_b32 v124, v135, v131, s49
    v_perm_b32 v125, v143, v139, s49
    v_mfma_f32_16x16x32_bf16 a[120:123], a[216:219], v[120:123], a[120:123]
    v_perm_b32 v126, v151, v147, s49
    v_perm_b32 v127, v159, v155, s49
    v_mfma_f32_16x16x32_bf16 a[124:127], a[240:243], v[120:123], a[124:127]
    ds_read_b128 a[180:183], v10 offset:26624
    v_mfma_f32_16x16x32_bf16 a[140:143], a[216:219], v[124:127], a[140:143]
    ds_read_b128 a[184:187], v10 offset:7168
    v_mfma_f32_16x16x32_bf16 a[144:147], a[240:243], v[124:127], a[144:147]
    s_waitcnt vmcnt(10)
    s_barrier
    v_perm_b32 v128, v164, v160, s48
    v_perm_b32 v129, v172, v168, s48
    s_waitcnt lgkmcnt(2)
    v_mfma_f32_16x16x32_bf16 a[160:163], a[228:231], a[216:219], a[160:163]
    v_perm_b32 v130, v180, v176, s48
    v_perm_b32 v131, v188, v184, s48
    v_mfma_f32_16x16x32_bf16 a[164:167], a[228:231], a[240:243], a[164:167]
    v_perm_b32 v132, v164, v160, s49
    v_perm_b32 v133, v172, v168, s49
    s_waitcnt lgkmcnt(8)
    v_mfma_f32_16x16x32_bf16 a[0:3], a[244:247], v[128:131], a[0:3]
    v_perm_b32 v134, v180, v176, s49
    v_perm_b32 v135, v188, v184, s49
    s_waitcnt lgkmcnt(5)
    v_mfma_f32_16x16x32_bf16 a[4:7], a[248:251], v[128:131], a[4:7]
    v_perm_b32 v136, v165, v161, s48
    v_perm_b32 v137, v173, v169, s48
    v_mfma_f32_16x16x32_bf16 a[20:23], a[244:247], v[132:135], a[20:23]
    v_perm_b32 v138, v181, v177, s48
    v_perm_b32 v139, v189, v185, s48
    v_mfma_f32_16x16x32_bf16 a[24:27], a[248:251], v[132:135], a[24:27]
    v_perm_b32 v140, v165, v161, s49
    v_perm_b32 v141, v173, v169, s49
    v_mfma_f32_16x16x32_bf16 a[40:43], a[244:247], v[136:139], a[40:43]
    v_perm_b32 v142, v181, v177, s49
    v_perm_b32 v143, v189, v185, s49
    v_mfma_f32_16x16x32_bf16 a[44:47], a[248:251], v[136:139], a[44:47]
    v_perm_b32 v144, v166, v162, s48
    v_perm_b32 v145, v174, v170, s48
    v_mfma_f32_16x16x32_bf16 a[60:63], a[244:247], v[140:143], a[60:63]
    v_perm_b32 v146, v182, v178, s48
    v_perm_b32 v147, v190, v186, s48
    v_mfma_f32_16x16x32_bf16 a[64:67], a[248:251], v[140:143], a[64:67]
    v_perm_b32 v148, v166, v162, s49
    v_perm_b32 v149, v174, v170, s49
    v_mfma_f32_16x16x32_bf16 a[80:83], a[244:247], v[144:147], a[80:83]
    v_perm_b32 v150, v182, v178, s49
    v_perm_b32 v151, v190, v186, s49
    ds_read_b64_tr_b16 a[232:233], v11 offset:16384
    v_mfma_f32_16x16x32_bf16 a[84:87], a[248:251], v[144:147], a[84:87]
    v_perm_b32 v152, v167, v163, s48
    v_perm_b32 v153, v175, v171, s48
    ds_read_b64_tr_b16 a[234:235], v11 offset:18432
    v_mfma_f32_16x16x32_bf16 a[100:103], a[244:247], v[148:151], a[100:103]
    v_perm_b32 v154, v183, v179, s48
    v_perm_b32 v155, v191, v187, s48
    v_mfma_f32_16x16x32_bf16 a[104:107], a[248:251], v[148:151], a[104:107]
    v_perm_b32 v156, v167, v163, s49
    v_perm_b32 v157, v175, v171, s49
    v_mfma_f32_16x16x32_bf16 a[120:123], a[244:247], v[152:155], a[120:123]
    v_perm_b32 v158, v183, v179, s49
    v_perm_b32 v159, v191, v187, s49
    v_mfma_f32_16x16x32_bf16 a[124:127], a[248:251], v[152:155], a[124:127]
    ds_read_b128 a[188:191], v10 offset:12288
    v_mfma_f32_16x16x32_bf16 a[140:143], a[244:247], v[156:159], a[140:143]
    ds_read_b128 a[192:195], v10 offset:17408
    v_mfma_f32_16x16x32_bf16 a[144:147], a[248:251], v[156:159], a[144:147]
    s_waitcnt vmcnt(1)
    s_barrier
    v_perm_b32 v160, v196, v192, s48
    v_perm_b32 v161, v204, v200, s48
    s_waitcnt lgkmcnt(2)
    v_mfma_f32_16x16x32_bf16 a[160:163], a[232:235], a[244:247], a[160:163]
    v_perm_b32 v162, v212, v208, s48
    v_perm_b32 v163, v220, v216, s48
    v_mfma_f32_16x16x32_bf16 a[164:167], a[232:235], a[248:251], a[164:167]
    v_perm_b32 v164, v196, v192, s49
    v_perm_b32 v165, v204, v200, s49
    s_waitcnt lgkmcnt(8)
    v_mfma_f32_16x16x32_bf16 a[0:3], a[252:255], v[160:163], a[0:3]
    v_perm_b32 v166, v212, v208, s49
    v_perm_b32 v167, v220, v216, s49
    s_waitcnt lgkmcnt(5)
    v_mfma_f32_16x16x32_bf16 a[4:7], a[180:183], v[160:163], a[4:7]
    v_perm_b32 v168, v197, v193, s48
    v_perm_b32 v169, v205, v201, s48
    v_mfma_f32_16x16x32_bf16 a[20:23], a[252:255], v[164:167], a[20:23]
    v_perm_b32 v170, v213, v209, s48
    v_perm_b32 v171, v221, v217, s48
    v_mfma_f32_16x16x32_bf16 a[24:27], a[180:183], v[164:167], a[24:27]
    v_perm_b32 v172, v197, v193, s49
    v_perm_b32 v173, v205, v201, s49
    v_mfma_f32_16x16x32_bf16 a[40:43], a[252:255], v[168:171], a[40:43]
    v_perm_b32 v174, v213, v209, s49
    v_perm_b32 v175, v221, v217, s49
    v_mfma_f32_16x16x32_bf16 a[44:47], a[180:183], v[168:171], a[44:47]
    v_perm_b32 v176, v198, v194, s48
    v_perm_b32 v177, v206, v202, s48
    v_mfma_f32_16x16x32_bf16 a[60:63], a[252:255], v[172:175], a[60:63]
    v_perm_b32 v178, v214, v210, s48
    v_perm_b32 v179, v222, v218, s48
    v_mfma_f32_16x16x32_bf16 a[64:67], a[180:183], v[172:175], a[64:67]
    v_perm_b32 v180, v198, v194, s49
    v_perm_b32 v181, v206, v202, s49
    v_mfma_f32_16x16x32_bf16 a[80:83], a[252:255], v[176:179], a[80:83]
    v_perm_b32 v182, v214, v210, s49
    v_perm_b32 v183, v222, v218, s49
    ds_read_b64_tr_b16 a[236:237], v11 offset:20480
    v_mfma_f32_16x16x32_bf16 a[84:87], a[180:183], v[176:179], a[84:87]
    v_perm_b32 v184, v199, v195, s48
    v_perm_b32 v185, v207, v203, s48
    ds_read_b64_tr_b16 a[238:239], v11 offset:22528
    v_mfma_f32_16x16x32_bf16 a[100:103], a[252:255], v[180:183], a[100:103]
    v_perm_b32 v186, v215, v211, s48
    v_perm_b32 v187, v223, v219, s48
    v_mfma_f32_16x16x32_bf16 a[104:107], a[180:183], v[180:183], a[104:107]
    v_perm_b32 v188, v199, v195, s49
    v_perm_b32 v189, v207, v203, s49
    v_mfma_f32_16x16x32_bf16 a[120:123], a[252:255], v[184:187], a[120:123]
    v_perm_b32 v190, v215, v211, s49
    v_perm_b32 v191, v223, v219, s49
    v_mfma_f32_16x16x32_bf16 a[124:127], a[180:183], v[184:187], a[124:127]
    ds_read_b128 a[196:199], v10 offset:22528
    v_mfma_f32_16x16x32_bf16 a[140:143], a[252:255], v[188:191], a[140:143]
    ds_read_b128 a[200:203], v10 offset:27648
    v_mfma_f32_16x16x32_bf16 a[144:147], a[180:183], v[188:191], a[144:147]
    s_waitcnt lgkmcnt(2)
    v_mfma_f32_16x16x32_bf16 a[160:163], a[236:239], a[252:255], a[160:163]
    v_mfma_f32_16x16x32_bf16 a[164:167], a[236:239], a[180:183], a[164:167]
    s_waitcnt lgkmcnt(8)
    v_mfma_f32_16x16x32_bf16 a[8:11], a[184:187], v[32:35], a[8:11]
    v_mfma_f32_16x16x32_bf16 a[28:31], a[184:187], v[36:39], a[28:31]
    v_mfma_f32_16x16x32_bf16 a[48:51], a[184:187], v[40:43], a[48:51]
    v_mfma_f32_16x16x32_bf16 a[68:71], a[184:187], v[44:47], a[68:71]
    v_mfma_f32_16x16x32_bf16 a[88:91], a[184:187], v[48:51], a[88:91]
    v_accvgpr_read_b32 v240, a0
    v_accvgpr_read_b32 v241, a20
    v_mfma_f32_16x16x32_bf16 a[108:111], a[184:187], v[52:55], a[108:111]
    ds_read_b128 a[204:207], v10 offset:8192
    v_mfma_f32_16x16x32_bf16 a[128:131], a[184:187], v[56:59], a[128:131]
    v_accvgpr_read_b32 v242, a40
    v_accvgpr_read_b32 v243, a60
    v_mfma_f32_16x16x32_bf16 a[148:151], a[184:187], v[60:63], a[148:151]
    v_accvgpr_read_b32 v244, a80
    v_accvgpr_read_b32 v245, a100
    v_mfma_f32_16x16x32_bf16 a[168:171], a[220:223], a[184:187], a[168:171]
    v_accvgpr_read_b32 v246, a120
    v_accvgpr_read_b32 v247, a140
    s_waitcnt lgkmcnt(6)
    v_mfma_f32_16x16x32_bf16 a[8:11], a[188:191], v[64:67], a[8:11]
    v_cvt_pk_bf16_f32 v16, v240, v241
    v_cvt_pk_bf16_f32 v17, v242, v243
    v_mfma_f32_16x16x32_bf16 a[28:31], a[188:191], v[68:71], a[28:31]
    v_cvt_pk_bf16_f32 v18, v244, v245
    v_cvt_pk_bf16_f32 v19, v246, v247
    v_mfma_f32_16x16x32_bf16 a[48:51], a[188:191], v[72:75], a[48:51]
    buffer_store_dwordx4 v[16:19], v28, s[44:47], s76 offen offset:0 sc0 sc1
    v_mfma_f32_16x16x32_bf16 a[68:71], a[188:191], v[76:79], a[68:71]
    v_accvgpr_read_b32 v240, a1
    v_accvgpr_read_b32 v241, a21
    v_mfma_f32_16x16x32_bf16 a[88:91], a[188:191], v[80:83], a[88:91]
    v_accvgpr_read_b32 v242, a41
    v_accvgpr_read_b32 v243, a61
    v_mfma_f32_16x16x32_bf16 a[108:111], a[188:191], v[84:87], a[108:111]
    ds_read_b128 a[208:211], v10 offset:13312
    v_mfma_f32_16x16x32_bf16 a[128:131], a[188:191], v[88:91], a[128:131]
    v_accvgpr_read_b32 v244, a81
    v_accvgpr_read_b32 v245, a101
    v_mfma_f32_16x16x32_bf16 a[148:151], a[188:191], v[92:95], a[148:151]
    v_accvgpr_read_b32 v246, a121
    v_accvgpr_read_b32 v247, a141
    v_mfma_f32_16x16x32_bf16 a[168:171], a[224:227], a[188:191], a[168:171]
    v_cvt_pk_bf16_f32 v20, v240, v241
    v_cvt_pk_bf16_f32 v21, v242, v243
    s_waitcnt lgkmcnt(6)
    v_mfma_f32_16x16x32_bf16 a[8:11], a[192:195], v[96:99], a[8:11]
    v_cvt_pk_bf16_f32 v22, v244, v245
    v_cvt_pk_bf16_f32 v23, v246, v247
    v_mfma_f32_16x16x32_bf16 a[28:31], a[192:195], v[100:103], a[28:31]
    buffer_store_dwordx4 v[20:23], v28, s[44:47], s76 offen offset:1152 sc0 sc1
    v_mfma_f32_16x16x32_bf16 a[48:51], a[192:195], v[104:107], a[48:51]
    v_accvgpr_read_b32 v240, a2
    v_accvgpr_read_b32 v241, a22
    v_mfma_f32_16x16x32_bf16 a[68:71], a[192:195], v[108:111], a[68:71]
    v_accvgpr_read_b32 v242, a42
    v_accvgpr_read_b32 v243, a62
    v_mfma_f32_16x16x32_bf16 a[88:91], a[192:195], v[112:115], a[88:91]
    v_accvgpr_read_b32 v244, a82
    v_accvgpr_read_b32 v245, a102
    v_mfma_f32_16x16x32_bf16 a[108:111], a[192:195], v[116:119], a[108:111]
    ds_read_b128 a[212:215], v10 offset:18432
    v_mfma_f32_16x16x32_bf16 a[128:131], a[192:195], v[120:123], a[128:131]
    v_accvgpr_read_b32 v246, a122
    v_accvgpr_read_b32 v247, a142
    v_mfma_f32_16x16x32_bf16 a[148:151], a[192:195], v[124:127], a[148:151]
    v_cvt_pk_bf16_f32 v24, v240, v241
    v_cvt_pk_bf16_f32 v25, v242, v243
    v_mfma_f32_16x16x32_bf16 a[168:171], a[228:231], a[192:195], a[168:171]
    v_cvt_pk_bf16_f32 v26, v244, v245
    v_cvt_pk_bf16_f32 v27, v246, v247
    s_waitcnt lgkmcnt(4)
    v_mfma_f32_16x16x32_bf16 a[8:11], a[196:199], v[128:131], a[8:11]
    buffer_store_dwordx4 v[24:27], v28, s[44:47], s76 offen offset:2304 sc0 sc1
    v_mfma_f32_16x16x32_bf16 a[28:31], a[196:199], v[132:135], a[28:31]
    v_accvgpr_read_b32 v240, a3
    v_accvgpr_read_b32 v241, a23
    v_mfma_f32_16x16x32_bf16 a[48:51], a[196:199], v[136:139], a[48:51]
    v_accvgpr_read_b32 v242, a43
    v_accvgpr_read_b32 v243, a63
    v_mfma_f32_16x16x32_bf16 a[68:71], a[196:199], v[140:143], a[68:71]
    buffer_load_dword v249, v30, s[44:47], s96 offen offset:0 sc1
    v_mfma_f32_16x16x32_bf16 a[88:91], a[196:199], v[144:147], a[88:91]
    v_accvgpr_read_b32 v244, a83
    v_accvgpr_read_b32 v245, a103
    v_mfma_f32_16x16x32_bf16 a[108:111], a[196:199], v[148:151], a[108:111]
    ds_read_b128 a[216:219], v10 offset:23552
    v_mfma_f32_16x16x32_bf16 a[128:131], a[196:199], v[152:155], a[128:131]
    buffer_load_dword v249, v30, s[44:47], s96 offen offset:128 sc1
    v_mfma_f32_16x16x32_bf16 a[148:151], a[196:199], v[156:159], a[148:151]
    v_accvgpr_read_b32 v246, a123
    v_accvgpr_read_b32 v247, a143
    v_mfma_f32_16x16x32_bf16 a[168:171], a[232:235], a[196:199], a[168:171]
    v_cvt_pk_bf16_f32 v16, v240, v241
    v_cvt_pk_bf16_f32 v17, v242, v243
    s_waitcnt lgkmcnt(4)
    v_mfma_f32_16x16x32_bf16 a[8:11], a[200:203], v[160:163], a[8:11]
    buffer_load_dword v249, v30, s[44:47], s96 offen offset:256 sc1
    v_mfma_f32_16x16x32_bf16 a[28:31], a[200:203], v[164:167], a[28:31]
    v_cvt_pk_bf16_f32 v18, v244, v245
    v_cvt_pk_bf16_f32 v19, v246, v247
    v_mfma_f32_16x16x32_bf16 a[48:51], a[200:203], v[168:171], a[48:51]
    buffer_store_dwordx4 v[16:19], v28, s[44:47], s76 offen offset:3456 sc0 sc1
    v_mfma_f32_16x16x32_bf16 a[68:71], a[200:203], v[172:175], a[68:71]
    v_accvgpr_read_b32 v240, a160
    v_accvgpr_read_b32 v241, a161
    v_mfma_f32_16x16x32_bf16 a[88:91], a[200:203], v[176:179], a[88:91]
    v_accvgpr_read_b32 v242, a162
    v_accvgpr_read_b32 v243, a163
    v_mfma_f32_16x16x32_bf16 a[108:111], a[200:203], v[180:183], a[108:111]
    ds_read_b128 a[240:243], v10 offset:28672
    v_mfma_f32_16x16x32_bf16 a[128:131], a[200:203], v[184:187], a[128:131]
    v_cvt_pk_bf16_f32 v20, v240, v241
    v_cvt_pk_bf16_f32 v21, v242, v243
    v_mfma_f32_16x16x32_bf16 a[148:151], a[200:203], v[188:191], a[148:151]
    buffer_store_dwordx2 v[20:21], v29, s[44:47], s76 offen sc0 sc1
    v_mfma_f32_16x16x32_bf16 a[168:171], a[236:239], a[200:203], a[168:171]
    v_accvgpr_read_b32 v240, a4
    v_accvgpr_read_b32 v241, a24
    s_waitcnt lgkmcnt(4)
    v_mfma_f32_16x16x32_bf16 a[12:15], a[204:207], v[32:35], a[12:15]
    v_accvgpr_read_b32 v242, a44
    v_accvgpr_read_b32 v243, a64
    v_mfma_f32_16x16x32_bf16 a[32:35], a[204:207], v[36:39], a[32:35]
    v_accvgpr_read_b32 v244, a84
    v_accvgpr_read_b32 v245, a104
    v_mfma_f32_16x16x32_bf16 a[52:55], a[204:207], v[40:43], a[52:55]
    v_accvgpr_read_b32 v246, a124
    v_accvgpr_read_b32 v247, a144
    v_mfma_f32_16x16x32_bf16 a[72:75], a[204:207], v[44:47], a[72:75]
    v_cvt_pk_bf16_f32 v24, v240, v241
    v_cvt_pk_bf16_f32 v25, v242, v243
    v_mfma_f32_16x16x32_bf16 a[92:95], a[204:207], v[48:51], a[92:95]
    v_cvt_pk_bf16_f32 v26, v244, v245
    v_cvt_pk_bf16_f32 v27, v246, v247
    v_mfma_f32_16x16x32_bf16 a[112:115], a[204:207], v[52:55], a[112:115]
    buffer_store_dwordx4 v[24:27], v28, s[44:47], s77 offen offset:0 sc0 sc1
    v_mfma_f32_16x16x32_bf16 a[132:135], a[204:207], v[56:59], a[132:135]
    v_accvgpr_read_b32 v240, a5
    v_accvgpr_read_b32 v241, a25
    v_mfma_f32_16x16x32_bf16 a[152:155], a[204:207], v[60:63], a[152:155]
    v_accvgpr_read_b32 v242, a45
    v_accvgpr_read_b32 v243, a65
    v_mfma_f32_16x16x32_bf16 a[172:175], a[220:223], a[204:207], a[172:175]
    v_accvgpr_read_b32 v244, a85
    v_accvgpr_read_b32 v245, a105
    s_waitcnt lgkmcnt(3)
    v_mfma_f32_16x16x32_bf16 a[12:15], a[208:211], v[64:67], a[12:15]
    v_accvgpr_read_b32 v246, a125
    v_accvgpr_read_b32 v247, a145
    v_mfma_f32_16x16x32_bf16 a[32:35], a[208:211], v[68:71], a[32:35]
    v_cvt_pk_bf16_f32 v16, v240, v241
    v_cvt_pk_bf16_f32 v17, v242, v243
    v_mfma_f32_16x16x32_bf16 a[52:55], a[208:211], v[72:75], a[52:55]
    v_cvt_pk_bf16_f32 v18, v244, v245
    v_cvt_pk_bf16_f32 v19, v246, v247
    v_mfma_f32_16x16x32_bf16 a[72:75], a[208:211], v[76:79], a[72:75]
    buffer_store_dwordx4 v[16:19], v28, s[44:47], s77 offen offset:1152 sc0 sc1
    v_mfma_f32_16x16x32_bf16 a[92:95], a[208:211], v[80:83], a[92:95]
    v_accvgpr_read_b32 v240, a6
    v_accvgpr_read_b32 v241, a26
    v_mfma_f32_16x16x32_bf16 a[112:115], a[208:211], v[84:87], a[112:115]
    v_accvgpr_read_b32 v242, a46
    v_accvgpr_read_b32 v243, a66
    v_mfma_f32_16x16x32_bf16 a[132:135], a[208:211], v[88:91], a[132:135]
    v_accvgpr_read_b32 v244, a86
    v_accvgpr_read_b32 v245, a106
    v_mfma_f32_16x16x32_bf16 a[152:155], a[208:211], v[92:95], a[152:155]
    v_accvgpr_read_b32 v246, a126
    v_accvgpr_read_b32 v247, a146
    v_mfma_f32_16x16x32_bf16 a[172:175], a[224:227], a[208:211], a[172:175]
    v_cvt_pk_bf16_f32 v20, v240, v241
    v_cvt_pk_bf16_f32 v21, v242, v243
    s_waitcnt lgkmcnt(2)
    v_mfma_f32_16x16x32_bf16 a[12:15], a[212:215], v[96:99], a[12:15]
    v_cvt_pk_bf16_f32 v22, v244, v245
    v_cvt_pk_bf16_f32 v23, v246, v247
    v_mfma_f32_16x16x32_bf16 a[32:35], a[212:215], v[100:103], a[32:35]
    buffer_store_dwordx4 v[20:23], v28, s[44:47], s77 offen offset:2304 sc0 sc1
    v_mfma_f32_16x16x32_bf16 a[52:55], a[212:215], v[104:107], a[52:55]
    v_accvgpr_read_b32 v240, a7
    v_accvgpr_read_b32 v241, a27
    v_mfma_f32_16x16x32_bf16 a[72:75], a[212:215], v[108:111], a[72:75]
    v_accvgpr_read_b32 v242, a47
    v_accvgpr_read_b32 v243, a67
    v_mfma_f32_16x16x32_bf16 a[92:95], a[212:215], v[112:115], a[92:95]
    v_accvgpr_read_b32 v244, a87
    v_accvgpr_read_b32 v245, a107
    v_mfma_f32_16x16x32_bf16 a[112:115], a[212:215], v[116:119], a[112:115]
    v_accvgpr_read_b32 v246, a127
    v_accvgpr_read_b32 v247, a147
    v_mfma_f32_16x16x32_bf16 a[132:135], a[212:215], v[120:123], a[132:135]
    v_cvt_pk_bf16_f32 v24, v240, v241
    v_cvt_pk_bf16_f32 v25, v242, v243
    v_mfma_f32_16x16x32_bf16 a[152:155], a[212:215], v[124:127], a[152:155]
    v_cvt_pk_bf16_f32 v26, v244, v245
    v_cvt_pk_bf16_f32 v27, v246, v247
    v_mfma_f32_16x16x32_bf16 a[172:175], a[228:231], a[212:215], a[172:175]
    buffer_store_dwordx4 v[24:27], v28, s[44:47], s77 offen offset:3456 sc0 sc1
    s_waitcnt lgkmcnt(1)
    v_mfma_f32_16x16x32_bf16 a[12:15], a[216:219], v[128:131], a[12:15]
    v_accvgpr_read_b32 v240, a164
    v_accvgpr_read_b32 v241, a165
    v_mfma_f32_16x16x32_bf16 a[32:35], a[216:219], v[132:135], a[32:35]
    v_accvgpr_read_b32 v242, a166
    v_accvgpr_read_b32 v243, a167
    v_mfma_f32_16x16x32_bf16 a[52:55], a[216:219], v[136:139], a[52:55]
    v_cvt_pk_bf16_f32 v16, v240, v241
    v_cvt_pk_bf16_f32 v17, v242, v243
    v_mfma_f32_16x16x32_bf16 a[72:75], a[216:219], v[140:143], a[72:75]
    buffer_store_dwordx2 v[16:17], v29, s[44:47], s77 offen sc0 sc1
    v_mfma_f32_16x16x32_bf16 a[92:95], a[216:219], v[144:147], a[92:95]
    v_accvgpr_read_b32 v240, a8
    v_accvgpr_read_b32 v241, a28
    v_mfma_f32_16x16x32_bf16 a[112:115], a[216:219], v[148:151], a[112:115]
    v_accvgpr_read_b32 v242, a48
    v_accvgpr_read_b32 v243, a68
    v_mfma_f32_16x16x32_bf16 a[132:135], a[216:219], v[152:155], a[132:135]
    v_accvgpr_read_b32 v244, a88
    v_accvgpr_read_b32 v245, a108
    v_mfma_f32_16x16x32_bf16 a[152:155], a[216:219], v[156:159], a[152:155]
    v_accvgpr_read_b32 v246, a128
    v_accvgpr_read_b32 v247, a148
    v_mfma_f32_16x16x32_bf16 a[172:175], a[232:235], a[216:219], a[172:175]
    v_cvt_pk_bf16_f32 v20, v240, v241
    v_cvt_pk_bf16_f32 v21, v242, v243
    s_waitcnt lgkmcnt(0)
    v_mfma_f32_16x16x32_bf16 a[12:15], a[240:243], v[160:163], a[12:15]
    v_cvt_pk_bf16_f32 v22, v244, v245
    v_cvt_pk_bf16_f32 v23, v246, v247
    v_mfma_f32_16x16x32_bf16 a[32:35], a[240:243], v[164:167], a[32:35]
    buffer_store_dwordx4 v[20:23], v28, s[44:47], s78 offen offset:0 sc0 sc1
    v_mfma_f32_16x16x32_bf16 a[52:55], a[240:243], v[168:171], a[52:55]
    v_accvgpr_read_b32 v240, a9
    v_accvgpr_read_b32 v241, a29
    v_mfma_f32_16x16x32_bf16 a[72:75], a[240:243], v[172:175], a[72:75]
    v_accvgpr_read_b32 v242, a49
    v_accvgpr_read_b32 v243, a69
    v_mfma_f32_16x16x32_bf16 a[92:95], a[240:243], v[176:179], a[92:95]
    v_accvgpr_read_b32 v244, a89
    v_accvgpr_read_b32 v245, a109
    v_mfma_f32_16x16x32_bf16 a[112:115], a[240:243], v[180:183], a[112:115]
    v_accvgpr_read_b32 v246, a129
    v_accvgpr_read_b32 v247, a149
    v_mfma_f32_16x16x32_bf16 a[132:135], a[240:243], v[184:187], a[132:135]
    v_cvt_pk_bf16_f32 v24, v240, v241
    v_cvt_pk_bf16_f32 v25, v242, v243
    v_mfma_f32_16x16x32_bf16 a[152:155], a[240:243], v[188:191], a[152:155]
    v_cvt_pk_bf16_f32 v26, v244, v245
    v_cvt_pk_bf16_f32 v27, v246, v247
    v_mfma_f32_16x16x32_bf16 a[172:175], a[236:239], a[240:243], a[172:175]
    buffer_store_dwordx4 v[24:27], v28, s[44:47], s78 offen offset:1152 sc0 sc1
    s_nop 7
    v_accvgpr_read_b32 v240, a10
    v_accvgpr_read_b32 v241, a30
    v_accvgpr_read_b32 v242, a50
    v_accvgpr_read_b32 v243, a70
    v_accvgpr_read_b32 v244, a90
    v_accvgpr_read_b32 v245, a110
    v_accvgpr_read_b32 v246, a130
    v_accvgpr_read_b32 v247, a150
    v_cvt_pk_bf16_f32 v16, v240, v241
    v_cvt_pk_bf16_f32 v17, v242, v243
    v_cvt_pk_bf16_f32 v18, v244, v245
    v_cvt_pk_bf16_f32 v19, v246, v247
    buffer_store_dwordx4 v[16:19], v28, s[44:47], s78 offen offset:2304 sc0 sc1
    v_accvgpr_read_b32 v240, a11
    v_accvgpr_read_b32 v241, a31
    v_accvgpr_read_b32 v242, a51
    v_accvgpr_read_b32 v243, a71
    v_accvgpr_read_b32 v244, a91
    v_accvgpr_read_b32 v245, a111
    v_accvgpr_read_b32 v246, a131
    v_accvgpr_read_b32 v247, a151
    v_cvt_pk_bf16_f32 v20, v240, v241
    v_cvt_pk_bf16_f32 v21, v242, v243
    v_cvt_pk_bf16_f32 v22, v244, v245
    v_cvt_pk_bf16_f32 v23, v246, v247
    buffer_store_dwordx4 v[20:23], v28, s[44:47], s78 offen offset:3456 sc0 sc1
    v_accvgpr_read_b32 v240, a168
    v_accvgpr_read_b32 v241, a169
    v_accvgpr_read_b32 v242, a170
    v_accvgpr_read_b32 v243, a171
    v_cvt_pk_bf16_f32 v24, v240, v241
    v_cvt_pk_bf16_f32 v25, v242, v243
    buffer_store_dwordx2 v[24:25], v29, s[44:47], s78 offen sc0 sc1
    v_accvgpr_read_b32 v240, a12
    v_accvgpr_read_b32 v241, a32
    v_accvgpr_read_b32 v242, a52
    v_accvgpr_read_b32 v243, a72
    v_accvgpr_read_b32 v244, a92
    v_accvgpr_read_b32 v245, a112
    v_accvgpr_read_b32 v246, a132
    v_accvgpr_read_b32 v247, a152
    v_cvt_pk_bf16_f32 v16, v240, v241
    v_cvt_pk_bf16_f32 v17, v242, v243
    v_cvt_pk_bf16_f32 v18, v244, v245
    v_cvt_pk_bf16_f32 v19, v246, v247
    buffer_store_dwordx4 v[16:19], v28, s[44:47], s79 offen offset:0 sc0 sc1
    v_accvgpr_read_b32 v240, a13
    v_accvgpr_read_b32 v241, a33
    v_accvgpr_read_b32 v242, a53
    v_accvgpr_read_b32 v243, a73
    v_accvgpr_read_b32 v244, a93
    v_accvgpr_read_b32 v245, a113
    v_accvgpr_read_b32 v246, a133
    v_accvgpr_read_b32 v247, a153
    v_cvt_pk_bf16_f32 v20, v240, v241
    v_cvt_pk_bf16_f32 v21, v242, v243
    v_cvt_pk_bf16_f32 v22, v244, v245
    v_cvt_pk_bf16_f32 v23, v246, v247
    buffer_store_dwordx4 v[20:23], v28, s[44:47], s79 offen offset:1152 sc0 sc1
    v_accvgpr_read_b32 v240, a14
    v_accvgpr_read_b32 v241, a34
    v_accvgpr_read_b32 v242, a54
    v_accvgpr_read_b32 v243, a74
    v_accvgpr_read_b32 v244, a94
    v_accvgpr_read_b32 v245, a114
    v_accvgpr_read_b32 v246, a134
    v_accvgpr_read_b32 v247, a154
    v_cvt_pk_bf16_f32 v24, v240, v241
    v_cvt_pk_bf16_f32 v25, v242, v243
    v_cvt_pk_bf16_f32 v26, v244, v245
    v_cvt_pk_bf16_f32 v27, v246, v247
    buffer_store_dwordx4 v[24:27], v28, s[44:47], s79 offen offset:2304 sc0 sc1
    v_accvgpr_read_b32 v240, a15
    v_accvgpr_read_b32 v241, a35
    v_accvgpr_read_b32 v242, a55
    v_accvgpr_read_b32 v243, a75
    v_accvgpr_read_b32 v244, a95
    v_accvgpr_read_b32 v245, a115
    v_accvgpr_read_b32 v246, a135
    v_accvgpr_read_b32 v247, a155
    v_cvt_pk_bf16_f32 v16, v240, v241
    v_cvt_pk_bf16_f32 v17, v242, v243
    v_cvt_pk_bf16_f32 v18, v244, v245
    v_cvt_pk_bf16_f32 v19, v246, v247
    buffer_store_dwordx4 v[16:19], v28, s[44:47], s79 offen offset:3456 sc0 sc1
    v_accvgpr_read_b32 v240, a172
    v_accvgpr_read_b32 v241, a173
    v_accvgpr_read_b32 v242, a174
    v_accvgpr_read_b32 v243, a175
    v_cvt_pk_bf16_f32 v20, v240, v241
    v_cvt_pk_bf16_f32 v21, v242, v243
    buffer_store_dwordx2 v[20:21], v29, s[44:47], s79 offen sc0 sc1
L4_final:
    global_load_dword v253, v253, s[100:101] sc1
    v_mov_b32 v16, s32
    v_lshlrev_b32 v16, 7, v16
    v_mov_b32 v17, 1
    v_lshlrev_b32 v19, 7, v13
    v_add_u32 v12, 122880, v250
    s_mov_b32 s60, s24
    s_and_b32 s61, s25, 0xffff
    s_mov_b32 s62, 2359296
    s_mov_b32 s63, 0x20000
    s_mul_i32 s62, s83, 1152
    s_waitcnt vmcnt(0)
    s_barrier
    v_readfirstlane_b32 s87, v253
    s_cmp_lg_u32 s30, 0
    s_cbranch_scc1 L4_sync_issued
    s_mov_b64 exec, 1
    s_cmp_eq_u32 s84, 0
    s_cbranch_scc0 L4_flag_wt
    global_store_dword v16, v17, s[100:101] offset:256
L4_flag_done:
    s_mov_b64 exec, -1
L4_sync_issued:
    s_cmp_eq_u32 s87, 48
    s_cbranch_scc0 L4_a4_poll
L4_a4_go:
    s_mov_b32 s35, 4194304
    buffer_load_dwordx4 v[192:195], v30, s[44:47], s35 offen offset:0 sc1
    buffer_load_dwordx4 v[196:199], v30, s[44:47], s35 offen offset:128 sc1
    buffer_load_dwordx4 v[200:203], v30, s[44:47], s35 offen offset:256 sc1
    s_mul_i32 s33, s31, 80
    s_mul_i32 s34, s32, 8
    s_add_u32 s33, s33, s34
    s_mul_i32 s68, s33, 1152
    s_add_u32 s68, s68, 8388608
    s_add_u32 s69, s68, 2396160
    s_add_u32 s70, s68, 4792320
    s_add_u32 s71, s68, 7188480
    s_add_u32 s72, s68, 9584640
    s_add_u32 s73, s68, 11980800
    s_add_u32 s74, s68, 14376960
    s_add_u32 s75, s68, 16773120
    s_mov_b32 s33, 0x00003f80
    s_mov_b32 s34, 0x3f800000
    s_mov_b32 s94, 3207688728
    s_mov_b32 s95, 3207688728
    s_waitcnt vmcnt(0)
    ds_write2_b64 v31, v[192:193], v[194:195] offset0:0 offset1:144
    ds_write2_b64 v31, v[196:197], v[198:199] offset0:1 offset1:145
    ds_write2_b64 v31, v[200:201], v[202:203] offset0:2 offset1:146
    s_waitcnt lgkmcnt(0)
    s_cmp_lg_u32 s30, 0
    s_cbranch_scc1 L4_sync_done
    s_mov_b32 s35, 0
    s_mov_b64 exec, 0xff
L4_sync_poll:
    global_load_dword v17, v19, s[100:101] offset:256 sc1
    s_add_u32 s35, s35, 1
    s_waitcnt vmcnt(0)
    v_cmp_eq_u32 vcc, 1, v17
    s_nop 1
    s_cmp_eq_u32 vcc_lo, 0xff
    s_cbranch_scc1 L4_sync_got
    s_sleep 0
    s_cmp_eq_u32 s84, 0
    s_cbranch_scc1 L4_sync_short
    s_sleep 8
L4_sync_short:
    s_cmp_lt_u32 s35, 0x4000
    s_cbranch_scc1 L4_sync_poll
L4_sync_got:
    s_mov_b64 exec, -1
L4_sync_done:
    s_barrier
    buffer_load_dwordx4 v[32:35], v250, s[44:47], s68 offen sc1
    buffer_load_dwordx4 v[36:39], v250, s[44:47], s69 offen sc1
    buffer_load_dwordx4 v[40:43], v250, s[44:47], s70 offen sc1
    buffer_load_dwordx4 v[44:47], v250, s[44:47], s71 offen sc1
    ds_read_b128 v[140:143], v12 offset:0
    ds_read_b128 v[144:147], v12 offset:4096
    ds_read_b128 v[148:151], v12 offset:8192
    buffer_load_dwordx4 v[48:51], v250, s[44:47], s72 offen sc1
    buffer_load_dwordx4 v[52:55], v250, s[44:47], s73 offen sc1
    buffer_load_dwordx4 v[56:59], v250, s[44:47], s74 offen sc1
    buffer_load_dwordx4 v[60:63], v250, s[44:47], s75 offen sc1
    buffer_load_dwordx4 v[64:67], v251, s[44:47], s68 offen sc1
    buffer_load_dwordx4 v[68:71], v251, s[44:47], s69 offen sc1
    buffer_load_dwordx4 v[72:75], v251, s[44:47], s70 offen sc1
    buffer_load_dwordx4 v[76:79], v251, s[44:47], s71 offen sc1
    buffer_load_dwordx4 v[80:83], v251, s[44:47], s72 offen sc1
    buffer_load_dwordx4 v[84:87], v251, s[44:47], s73 offen sc1
    buffer_load_dwordx4 v[88:91], v251, s[44:47], s74 offen sc1
    buffer_load_dwordx4 v[92:95], v251, s[44:47], s75 offen sc1
    buffer_load_dwordx4 v[96:99], v252, s[44:47], s68 offen sc1
    buffer_load_dwordx4 v[100:103], v252, s[44:47], s69 offen sc1
    buffer_load_dwordx4 v[104:107], v252, s[44:47], s70 offen sc1
    buffer_load_dwordx4 v[108:111], v252, s[44:47], s71 offen sc1
    buffer_load_dwordx4 v[112:115], v252, s[44:47], s72 offen sc1
    buffer_load_dwordx4 v[116:119], v252, s[44:47], s73 offen sc1
    buffer_load_dwordx4 v[120:123], v252, s[44:47], s74 offen sc1
    buffer_load_dwordx4 v[124:127], v252, s[44:47], s75 offen sc1
    s_waitcnt lgkmcnt(0)
    v_lshlrev_b32 v160, 16, v224
    v_lshlrev_b32 v162, 16, v225
    v_lshlrev_b32 v164, 16, v226
    v_lshlrev_b32 v166, 16, v227
    v_and_b32 v161, 0xffff0000, v224
    v_and_b32 v163, 0xffff0000, v225
    v_and_b32 v165, 0xffff0000, v226
    v_and_b32 v167, 0xffff0000, v227
    v_dot2_f32_bf16 v160, v140, s33, v160
    v_dot2_f32_bf16 v162, v141, s33, v162
    v_dot2_f32_bf16 v164, v142, s33, v164
    v_dot2_f32_bf16 v166, v143, s33, v166
    v_dot2_f32_bf16 v161, v140, s34, v161
    v_dot2_f32_bf16 v163, v141, s34, v163
    v_dot2_f32_bf16 v165, v142, s34, v165
    v_dot2_f32_bf16 v167, v143, s34, v167
    v_cvt_pk_bf16_f32 v224, v160, v161
    v_cvt_pk_bf16_f32 v225, v162, v163
    v_cvt_pk_bf16_f32 v226, v164, v165
    v_cvt_pk_bf16_f32 v227, v166, v167
    v_lshlrev_b32 v160, 16, v228
    v_lshlrev_b32 v162, 16, v229
    v_lshlrev_b32 v164, 16, v230
    v_lshlrev_b32 v166, 16, v231
    v_and_b32 v161, 0xffff0000, v228
    v_and_b32 v163, 0xffff0000, v229
    v_and_b32 v165, 0xffff0000, v230
    v_and_b32 v167, 0xffff0000, v231
    v_dot2_f32_bf16 v160, v144, s33, v160
    v_dot2_f32_bf16 v162, v145, s33, v162
    v_dot2_f32_bf16 v164, v146, s33, v164
    v_dot2_f32_bf16 v166, v147, s33, v166
    v_dot2_f32_bf16 v161, v144, s34, v161
    v_dot2_f32_bf16 v163, v145, s34, v163
    v_dot2_f32_bf16 v165, v146, s34, v165
    v_dot2_f32_bf16 v167, v147, s34, v167
    v_cvt_pk_bf16_f32 v228, v160, v161
    v_cvt_pk_bf16_f32 v229, v162, v163
    v_cvt_pk_bf16_f32 v230, v164, v165
    v_cvt_pk_bf16_f32 v231, v166, v167
    v_lshlrev_b32 v160, 16, v232
    v_lshlrev_b32 v162, 16, v233
    v_lshlrev_b32 v164, 16, v234
    v_lshlrev_b32 v166, 16, v235
    v_and_b32 v161, 0xffff0000, v232
    v_and_b32 v163, 0xffff0000, v233
    v_and_b32 v165, 0xffff0000, v234
    v_and_b32 v167, 0xffff0000, v235
    v_dot2_f32_bf16 v160, v148, s33, v160
    v_dot2_f32_bf16 v162, v149, s33, v162
    v_dot2_f32_bf16 v164, v150, s33, v164
    v_dot2_f32_bf16 v166, v151, s33, v166
    v_dot2_f32_bf16 v161, v148, s34, v161
    v_dot2_f32_bf16 v163, v149, s34, v163
    v_dot2_f32_bf16 v165, v150, s34, v165
    v_dot2_f32_bf16 v167, v151, s34, v167
    v_cvt_pk_bf16_f32 v232, v160, v161
    v_cvt_pk_bf16_f32 v233, v162, v163
    v_cvt_pk_bf16_f32 v234, v164, v165
    v_cvt_pk_bf16_f32 v235, v166, v167
    s_waitcnt vmcnt(23)
    v_dot2_f32_bf16 v152, v32, s33, 0
    v_dot2_f32_bf16 v153, v32, s34, 0
    v_dot2_f32_bf16 v154, v33, s33, 0
    v_dot2_f32_bf16 v155, v33, s34, 0
    v_dot2_f32_bf16 v156, v34, s33, 0
    v_dot2_f32_bf16 v157, v34, s34, 0
    v_dot2_f32_bf16 v158, v35, s33, 0
    v_dot2_f32_bf16 v159, v35, s34, 0
    s_waitcnt vmcnt(22)
    v_dot2_f32_bf16 v152, v36, s33, v152
    v_dot2_f32_bf16 v153, v36, s34, v153
    v_dot2_f32_bf16 v154, v37, s33, v154
    v_dot2_f32_bf16 v155, v37, s34, v155
    v_dot2_f32_bf16 v156, v38, s33, v156
    v_dot2_f32_bf16 v157, v38, s34, v157
    v_dot2_f32_bf16 v158, v39, s33, v158
    v_dot2_f32_bf16 v159, v39, s34, v159
    s_waitcnt vmcnt(21)
    v_dot2_f32_bf16 v152, v40, s33, v152
    v_dot2_f32_bf16 v153, v40, s34, v153
    v_dot2_f32_bf16 v154, v41, s33, v154
    v_dot2_f32_bf16 v155, v41, s34, v155
    v_dot2_f32_bf16 v156, v42, s33, v156
    v_dot2_f32_bf16 v157, v42, s34, v157
    v_dot2_f32_bf16 v158, v43, s33, v158
    v_dot2_f32_bf16 v159, v43, s34, v159
    s_waitcnt vmcnt(20)
    v_dot2_f32_bf16 v152, v44, s33, v152
    v_dot2_f32_bf16 v153, v44, s34, v153
    v_dot2_f32_bf16 v154, v45, s33, v154
    v_dot2_f32_bf16 v155, v45, s34, v155
    v_dot2_f32_bf16 v156, v46, s33, v156
    v_dot2_f32_bf16 v157, v46, s34, v157
    v_dot2_f32_bf16 v158, v47, s33, v158
    v_dot2_f32_bf16 v159, v47, s34, v159
    s_waitcnt vmcnt(19)
    v_dot2_f32_bf16 v152, v48, s33, v152
    v_dot2_f32_bf16 v153, v48, s34, v153
    v_dot2_f32_bf16 v154, v49, s33, v154
    v_dot2_f32_bf16 v155, v49, s34, v155
    v_dot2_f32_bf16 v156, v50, s33, v156
    v_dot2_f32_bf16 v157, v50, s34, v157
    v_dot2_f32_bf16 v158, v51, s33, v158
    v_dot2_f32_bf16 v159, v51, s34, v159
    s_waitcnt vmcnt(18)
    v_dot2_f32_bf16 v152, v52, s33, v152
    v_dot2_f32_bf16 v153, v52, s34, v153
    v_dot2_f32_bf16 v154, v53, s33, v154
    v_dot2_f32_bf16 v155, v53, s34, v155
    v_dot2_f32_bf16 v156, v54, s33, v156
    v_dot2_f32_bf16 v157, v54, s34, v157
    v_dot2_f32_bf16 v158, v55, s33, v158
    v_dot2_f32_bf16 v159, v55, s34, v159
    s_waitcnt vmcnt(17)
    v_dot2_f32_bf16 v152, v56, s33, v152
    v_dot2_f32_bf16 v153, v56, s34, v153
    v_dot2_f32_bf16 v154, v57, s33, v154
    v_dot2_f32_bf16 v155, v57, s34, v155
    v_dot2_f32_bf16 v156, v58, s33, v156
    v_dot2_f32_bf16 v157, v58, s34, v157
    v_dot2_f32_bf16 v158, v59, s33, v158
    v_dot2_f32_bf16 v159, v59, s34, v159
    s_waitcnt vmcnt(16)
    v_dot2_f32_bf16 v152, v60, s33, v152
    v_dot2_f32_bf16 v153, v60, s34, v153
    v_dot2_f32_bf16 v154, v61, s33, v154
    v_dot2_f32_bf16 v155, v61, s34, v155
    v_dot2_f32_bf16 v156, v62, s33, v156
    v_dot2_f32_bf16 v157, v62, s34, v157
    v_dot2_f32_bf16 v158, v63, s33, v158
    v_dot2_f32_bf16 v159, v63, s34, v159
    s_nop 1
    v_pk_mul_f32 v[152:153], v[152:153], s[94:95]
    v_pk_mul_f32 v[154:155], v[154:155], s[94:95]
    v_pk_mul_f32 v[156:157], v[156:157], s[94:95]
    v_pk_mul_f32 v[158:159], v[158:159], s[94:95]
    v_cvt_pk_bf16_f32 v24, v152, v153
    v_cvt_pk_bf16_f32 v25, v154, v155
    v_cvt_pk_bf16_f32 v26, v156, v157
    v_cvt_pk_bf16_f32 v27, v158, v159
    v_lshlrev_b32 v160, 16, v224
    v_lshlrev_b32 v162, 16, v225
    v_lshlrev_b32 v164, 16, v226
    v_lshlrev_b32 v166, 16, v227
    v_and_b32 v161, 0xffff0000, v224
    v_and_b32 v163, 0xffff0000, v225
    v_and_b32 v165, 0xffff0000, v226
    v_and_b32 v167, 0xffff0000, v227
    v_dot2_f32_bf16 v160, v24, s33, v160
    v_dot2_f32_bf16 v162, v25, s33, v162
    v_dot2_f32_bf16 v164, v26, s33, v164
    v_dot2_f32_bf16 v166, v27, s33, v166
    v_dot2_f32_bf16 v161, v24, s34, v161
    v_dot2_f32_bf16 v163, v25, s34, v163
    v_dot2_f32_bf16 v165, v26, s34, v165
    v_dot2_f32_bf16 v167, v27, s34, v167
    v_cvt_pk_bf16_f32 v224, v160, v161
    v_cvt_pk_bf16_f32 v225, v162, v163
    v_cvt_pk_bf16_f32 v226, v164, v165
    v_cvt_pk_bf16_f32 v227, v166, v167
    buffer_store_dwordx4 v[224:227], v250, s[60:63], s86 offen
    s_waitcnt vmcnt(16)
    v_dot2_f32_bf16 v152, v64, s33, 0
    v_dot2_f32_bf16 v153, v64, s34, 0
    v_dot2_f32_bf16 v154, v65, s33, 0
    v_dot2_f32_bf16 v155, v65, s34, 0
    v_dot2_f32_bf16 v156, v66, s33, 0
    v_dot2_f32_bf16 v157, v66, s34, 0
    v_dot2_f32_bf16 v158, v67, s33, 0
    v_dot2_f32_bf16 v159, v67, s34, 0
    s_waitcnt vmcnt(15)
    v_dot2_f32_bf16 v152, v68, s33, v152
    v_dot2_f32_bf16 v153, v68, s34, v153
    v_dot2_f32_bf16 v154, v69, s33, v154
    v_dot2_f32_bf16 v155, v69, s34, v155
    v_dot2_f32_bf16 v156, v70, s33, v156
    v_dot2_f32_bf16 v157, v70, s34, v157
    v_dot2_f32_bf16 v158, v71, s33, v158
    v_dot2_f32_bf16 v159, v71, s34, v159
    s_waitcnt vmcnt(14)
    v_dot2_f32_bf16 v152, v72, s33, v152
    v_dot2_f32_bf16 v153, v72, s34, v153
    v_dot2_f32_bf16 v154, v73, s33, v154
    v_dot2_f32_bf16 v155, v73, s34, v155
    v_dot2_f32_bf16 v156, v74, s33, v156
    v_dot2_f32_bf16 v157, v74, s34, v157
    v_dot2_f32_bf16 v158, v75, s33, v158
    v_dot2_f32_bf16 v159, v75, s34, v159
    s_waitcnt vmcnt(13)
    v_dot2_f32_bf16 v152, v76, s33, v152
    v_dot2_f32_bf16 v153, v76, s34, v153
    v_dot2_f32_bf16 v154, v77, s33, v154
    v_dot2_f32_bf16 v155, v77, s34, v155
    v_dot2_f32_bf16 v156, v78, s33, v156
    v_dot2_f32_bf16 v157, v78, s34, v157
    v_dot2_f32_bf16 v158, v79, s33, v158
    v_dot2_f32_bf16 v159, v79, s34, v159
    s_waitcnt vmcnt(12)
    v_dot2_f32_bf16 v152, v80, s33, v152
    v_dot2_f32_bf16 v153, v80, s34, v153
    v_dot2_f32_bf16 v154, v81, s33, v154
    v_dot2_f32_bf16 v155, v81, s34, v155
    v_dot2_f32_bf16 v156, v82, s33, v156
    v_dot2_f32_bf16 v157, v82, s34, v157
    v_dot2_f32_bf16 v158, v83, s33, v158
    v_dot2_f32_bf16 v159, v83, s34, v159
    s_waitcnt vmcnt(11)
    v_dot2_f32_bf16 v152, v84, s33, v152
    v_dot2_f32_bf16 v153, v84, s34, v153
    v_dot2_f32_bf16 v154, v85, s33, v154
    v_dot2_f32_bf16 v155, v85, s34, v155
    v_dot2_f32_bf16 v156, v86, s33, v156
    v_dot2_f32_bf16 v157, v86, s34, v157
    v_dot2_f32_bf16 v158, v87, s33, v158
    v_dot2_f32_bf16 v159, v87, s34, v159
    s_waitcnt vmcnt(10)
    v_dot2_f32_bf16 v152, v88, s33, v152
    v_dot2_f32_bf16 v153, v88, s34, v153
    v_dot2_f32_bf16 v154, v89, s33, v154
    v_dot2_f32_bf16 v155, v89, s34, v155
    v_dot2_f32_bf16 v156, v90, s33, v156
    v_dot2_f32_bf16 v157, v90, s34, v157
    v_dot2_f32_bf16 v158, v91, s33, v158
    v_dot2_f32_bf16 v159, v91, s34, v159
    s_waitcnt vmcnt(9)
    v_dot2_f32_bf16 v152, v92, s33, v152
    v_dot2_f32_bf16 v153, v92, s34, v153
    v_dot2_f32_bf16 v154, v93, s33, v154
    v_dot2_f32_bf16 v155, v93, s34, v155
    v_dot2_f32_bf16 v156, v94, s33, v156
    v_dot2_f32_bf16 v157, v94, s34, v157
    v_dot2_f32_bf16 v158, v95, s33, v158
    v_dot2_f32_bf16 v159, v95, s34, v159
    s_nop 1
    v_pk_mul_f32 v[152:153], v[152:153], s[94:95]
    v_pk_mul_f32 v[154:155], v[154:155], s[94:95]
    v_pk_mul_f32 v[156:157], v[156:157], s[94:95]
    v_pk_mul_f32 v[158:159], v[158:159], s[94:95]
    v_cvt_pk_bf16_f32 v24, v152, v153
    v_cvt_pk_bf16_f32 v25, v154, v155
    v_cvt_pk_bf16_f32 v26, v156, v157
    v_cvt_pk_bf16_f32 v27, v158, v159
    v_lshlrev_b32 v160, 16, v228
    v_lshlrev_b32 v162, 16, v229
    v_lshlrev_b32 v164, 16, v230
    v_lshlrev_b32 v166, 16, v231
    v_and_b32 v161, 0xffff0000, v228
    v_and_b32 v163, 0xffff0000, v229
    v_and_b32 v165, 0xffff0000, v230
    v_and_b32 v167, 0xffff0000, v231
    v_dot2_f32_bf16 v160, v24, s33, v160
    v_dot2_f32_bf16 v162, v25, s33, v162
    v_dot2_f32_bf16 v164, v26, s33, v164
    v_dot2_f32_bf16 v166, v27, s33, v166
    v_dot2_f32_bf16 v161, v24, s34, v161
    v_dot2_f32_bf16 v163, v25, s34, v163
    v_dot2_f32_bf16 v165, v26, s34, v165
    v_dot2_f32_bf16 v167, v27, s34, v167
    v_cvt_pk_bf16_f32 v228, v160, v161
    v_cvt_pk_bf16_f32 v229, v162, v163
    v_cvt_pk_bf16_f32 v230, v164, v165
    v_cvt_pk_bf16_f32 v231, v166, v167
    buffer_store_dwordx4 v[228:231], v251, s[60:63], s86 offen
    s_waitcnt vmcnt(9)
    v_dot2_f32_bf16 v152, v96, s33, 0
    v_dot2_f32_bf16 v153, v96, s34, 0
    v_dot2_f32_bf16 v154, v97, s33, 0
    v_dot2_f32_bf16 v155, v97, s34, 0
    v_dot2_f32_bf16 v156, v98, s33, 0
    v_dot2_f32_bf16 v157, v98, s34, 0
    v_dot2_f32_bf16 v158, v99, s33, 0
    v_dot2_f32_bf16 v159, v99, s34, 0
    s_waitcnt vmcnt(8)
    v_dot2_f32_bf16 v152, v100, s33, v152
    v_dot2_f32_bf16 v153, v100, s34, v153
    v_dot2_f32_bf16 v154, v101, s33, v154
    v_dot2_f32_bf16 v155, v101, s34, v155
    v_dot2_f32_bf16 v156, v102, s33, v156
    v_dot2_f32_bf16 v157, v102, s34, v157
    v_dot2_f32_bf16 v158, v103, s33, v158
    v_dot2_f32_bf16 v159, v103, s34, v159
    s_waitcnt vmcnt(7)
    v_dot2_f32_bf16 v152, v104, s33, v152
    v_dot2_f32_bf16 v153, v104, s34, v153
    v_dot2_f32_bf16 v154, v105, s33, v154
    v_dot2_f32_bf16 v155, v105, s34, v155
    v_dot2_f32_bf16 v156, v106, s33, v156
    v_dot2_f32_bf16 v157, v106, s34, v157
    v_dot2_f32_bf16 v158, v107, s33, v158
    v_dot2_f32_bf16 v159, v107, s34, v159
    s_waitcnt vmcnt(6)
    v_dot2_f32_bf16 v152, v108, s33, v152
    v_dot2_f32_bf16 v153, v108, s34, v153
    v_dot2_f32_bf16 v154, v109, s33, v154
    v_dot2_f32_bf16 v155, v109, s34, v155
    v_dot2_f32_bf16 v156, v110, s33, v156
    v_dot2_f32_bf16 v157, v110, s34, v157
    v_dot2_f32_bf16 v158, v111, s33, v158
    v_dot2_f32_bf16 v159, v111, s34, v159
    s_waitcnt vmcnt(5)
    v_dot2_f32_bf16 v152, v112, s33, v152
    v_dot2_f32_bf16 v153, v112, s34, v153
    v_dot2_f32_bf16 v154, v113, s33, v154
    v_dot2_f32_bf16 v155, v113, s34, v155
    v_dot2_f32_bf16 v156, v114, s33, v156
    v_dot2_f32_bf16 v157, v114, s34, v157
    v_dot2_f32_bf16 v158, v115, s33, v158
    v_dot2_f32_bf16 v159, v115, s34, v159
    s_waitcnt vmcnt(4)
    v_dot2_f32_bf16 v152, v116, s33, v152
    v_dot2_f32_bf16 v153, v116, s34, v153
    v_dot2_f32_bf16 v154, v117, s33, v154
    v_dot2_f32_bf16 v155, v117, s34, v155
    v_dot2_f32_bf16 v156, v118, s33, v156
    v_dot2_f32_bf16 v157, v118, s34, v157
    v_dot2_f32_bf16 v158, v119, s33, v158
    v_dot2_f32_bf16 v159, v119, s34, v159
    s_waitcnt vmcnt(3)
    v_dot2_f32_bf16 v152, v120, s33, v152
    v_dot2_f32_bf16 v153, v120, s34, v153
    v_dot2_f32_bf16 v154, v121, s33, v154
    v_dot2_f32_bf16 v155, v121, s34, v155
    v_dot2_f32_bf16 v156, v122, s33, v156
    v_dot2_f32_bf16 v157, v122, s34, v157
    v_dot2_f32_bf16 v158, v123, s33, v158
    v_dot2_f32_bf16 v159, v123, s34, v159
    s_waitcnt vmcnt(2)
    v_dot2_f32_bf16 v152, v124, s33, v152
    v_dot2_f32_bf16 v153, v124, s34, v153
    v_dot2_f32_bf16 v154, v125, s33, v154
    v_dot2_f32_bf16 v155, v125, s34, v155
    v_dot2_f32_bf16 v156, v126, s33, v156
    v_dot2_f32_bf16 v157, v126, s34, v157
    v_dot2_f32_bf16 v158, v127, s33, v158
    v_dot2_f32_bf16 v159, v127, s34, v159
    s_nop 1
    v_pk_mul_f32 v[152:153], v[152:153], s[94:95]
    v_pk_mul_f32 v[154:155], v[154:155], s[94:95]
    v_pk_mul_f32 v[156:157], v[156:157], s[94:95]
    v_pk_mul_f32 v[158:159], v[158:159], s[94:95]
    v_cvt_pk_bf16_f32 v24, v152, v153
    v_cvt_pk_bf16_f32 v25, v154, v155
    v_cvt_pk_bf16_f32 v26, v156, v157
    v_cvt_pk_bf16_f32 v27, v158, v159
    v_lshlrev_b32 v160, 16, v232
    v_lshlrev_b32 v162, 16, v233
    v_lshlrev_b32 v164, 16, v234
    v_lshlrev_b32 v166, 16, v235
    v_and_b32 v161, 0xffff0000, v232
    v_and_b32 v163, 0xffff0000, v233
    v_and_b32 v165, 0xffff0000, v234
    v_and_b32 v167, 0xffff0000, v235
    v_dot2_f32_bf16 v160, v24, s33, v160
    v_dot2_f32_bf16 v162, v25, s33, v162
    v_dot2_f32_bf16 v164, v26, s33, v164
    v_dot2_f32_bf16 v166, v27, s33, v166
    v_dot2_f32_bf16 v161, v24, s34, v161
    v_dot2_f32_bf16 v163, v25, s34, v163
    v_dot2_f32_bf16 v165, v26, s34, v165
    v_dot2_f32_bf16 v167, v27, s34, v167
    v_cvt_pk_bf16_f32 v232, v160, v161
    v_cvt_pk_bf16_f32 v233, v162, v163
    v_cvt_pk_bf16_f32 v234, v164, v165
    v_cvt_pk_bf16_f32 v235, v166, v167
    buffer_store_dwordx4 v[232:235], v252, s[60:63], s86 offen
    s_endpgm
L4_a4_poll:
    s_mov_b32 s33, 0
    v_mov_b32 v18, 128
L4_a4_poll2:
    s_sleep 16
    global_load_dword v20, v18, s[100:101] sc1
    s_add_u32 s33, s33, 1
    s_waitcnt vmcnt(0)
    v_readfirstlane_b32 s87, v20
    s_cmp_eq_u32 s87, 48
    s_cbranch_scc1 L4_a4_go
    s_cmp_lt_u32 s33, 0x4000
    s_cbranch_scc1 L4_a4_poll2
    s_branch L4_a4_go
L4_reg_check:
    v_mov_b32 v248, s81
    v_readfirstlane_b32 s33, v239
    s_mov_b32 s87, 0
L4_reg_wait:
    s_lshr_b32 s35, s33, 4
    s_and_b32 s35, s35, 0x0f0f0f0f
    s_and_b32 s96, s33, 0x0f0f0f0f
    s_add_u32 s35, s35, s96
    s_mul_i32 s35, s35, 0x01010101
    s_lshr_b32 s35, s35, 24
    s_cmp_eq_u32 s35, 8
    s_cbranch_scc1 L4_reg_ok
    s_sleep 16
    global_load_dword v239, v248, s[26:27] sc1
    s_add_u32 s87, s87, 1
    s_waitcnt vmcnt(0)
    v_readfirstlane_b32 s33, v239
    s_cmp_lt_u32 s87, 0x4000
    s_cbranch_scc1 L4_reg_wait
    s_branch L4_reg_ok
L4_flag_wt:
    global_store_dword v16, v17, s[100:101] offset:256 sc0 sc1
    s_branch L4_flag_done
L4_signal:
    s_waitcnt vmcnt(21)
    s_barrier
    s_cmp_lg_u32 s30, 0
    s_cbranch_scc1 L4_sig_back
    s_getreg_b32 s34, hwreg(HW_REG_XCC_ID)
    s_and_b32 s34, s34, 7
    s_lshl_b32 s34, s34, 2
    s_lshl_b32 s34, 1, s34
    v_mov_b32 v28, s81
    v_mov_b32 v29, s34
    s_mov_b64 exec, 1
    global_atomic_add v28, v29, s[26:27] sc1
    s_mov_b64 exec, -1
    s_branch L4_sig_back
L4_switch:
    v_mov_b32 v1, v12
    v_mov_b32 v9, v31
    v_add_u32 v2, 1152, v12
    v_add_u32 v3, 2304, v12
    v_add_u32 v4, 3456, v12
    v_add_u32 v5, 4608, v12
    v_add_u32 v6, 5760, v12
    v_add_u32 v7, 6912, v12
    v_add_u32 v8, 8064, v12
    s_mov_b32 s40, s22
    s_and_b32 s41, s23, 0xffff
    s_mul_i32 s55, s32, 663552
    s_mov_b32 s51, 36864
    v_mov_b32 v248, s81
    global_load_dword v239, v248, s[26:27] sc1
    s_lshl_b32 s33, s30, 12
    s_add_u32 s33, s33, L4_silu - L_pc0
    v_lshl_add_u32 v28, v13, 7, s33
    v_min_u32 v28, L_main_end - L_pc0, v28
    s_mov_b32 exec_hi, 0
    global_load_dword v249, v28, s[94:95]
    s_mov_b64 exec, -1
    s_branch L4_sw_back
    .p2alignl 6, 0xbf800000
L4_silu:
    v_accvgpr_read_b32 v250, a244
    v_accvgpr_read_b32 v28, a240
    v_accvgpr_read_b32 v29, a241
    v_readfirstlane_b32 s84, v239
    s_getreg_b32 s34, hwreg(HW_REG_XCC_ID)
    s_and_b32 s34, s34, 7
    s_lshl_b32 s34, s34, 2
    s_lshl_b32 s34, 8, s34
    s_cmp_eq_u32 s84, s34
    s_cselect_b32 s84, 1073741824, 0x40000000
    s_cbranch_scc0 L4_reg_check
L4_reg_ok:
    s_or_b32 s99, s97, s84
    s_cmp_lt_u32 s30, 3
    s_cselect_b32 s99, s99, 0x40000000
    v_lshlrev_b32 v236, 3, v250
    v_subrev_u32 v10, 92160, v10
    s_barrier
    .p2alignl 3, 0xbf800000
    v_accvgpr_read_b32 v240, a0
    v_accvgpr_read_b32 v241, a20
    v_accvgpr_read_b32 v242, a40
    v_accvgpr_read_b32 v243, a60
    v_accvgpr_read_b32 v244, a80
    v_accvgpr_read_b32 v245, a100
    v_accvgpr_read_b32 v246, a120
    v_accvgpr_read_b32 v247, a140
    v_exp_f32 v30, v240
    v_exp_f32 v31, v241
    v_exp_f32 v238, v242
    v_exp_f32 v239, v243
    v_exp_f32 v250, v244
    v_exp_f32 v251, v245
    v_exp_f32 v252, v246
    v_exp_f32 v253, v247
    v_pk_add_f32 v[30:31], v[30:31], 1.0 op_sel_hi:[1,0]
    v_pk_add_f32 v[238:239], v[238:239], 1.0 op_sel_hi:[1,0]
    v_pk_add_f32 v[250:251], v[250:251], 1.0 op_sel_hi:[1,0]
    v_pk_add_f32 v[252:253], v[252:253], 1.0 op_sel_hi:[1,0]
    v_rcp_f32 v30, v30
    v_rcp_f32 v31, v31
    v_rcp_f32 v238, v238
    v_rcp_f32 v239, v239
    v_rcp_f32 v250, v250
    v_rcp_f32 v251, v251
    v_rcp_f32 v252, v252
    v_rcp_f32 v253, v253
    v_pk_mul_f32 v[30:31], v[240:241], v[30:31]
    v_pk_mul_f32 v[238:239], v[242:243], v[238:239]
    v_pk_mul_f32 v[250:251], v[244:245], v[250:251]
    v_pk_mul_f32 v[252:253], v[246:247], v[252:253]
    v_cvt_pk_bf16_f32 v20, v30, v31
    v_cvt_pk_bf16_f32 v21, v238, v239
    v_cvt_pk_bf16_f32 v22, v250, v251
    v_cvt_pk_bf16_f32 v23, v252, v253
    v_accvgpr_read_b32 v240, a1
    v_accvgpr_read_b32 v241, a21
    v_accvgpr_read_b32 v242, a41
    v_accvgpr_read_b32 v243, a61
    v_accvgpr_read_b32 v244, a81
    v_accvgpr_read_b32 v245, a101
    v_accvgpr_read_b32 v246, a121
    v_accvgpr_read_b32 v247, a141
    v_exp_f32 v30, v240
    v_exp_f32 v31, v241
    v_exp_f32 v238, v242
    v_exp_f32 v239, v243
    v_exp_f32 v250, v244
    v_exp_f32 v251, v245
    v_exp_f32 v252, v246
    v_exp_f32 v253, v247
    v_pk_add_f32 v[30:31], v[30:31], 1.0 op_sel_hi:[1,0]
    v_pk_add_f32 v[238:239], v[238:239], 1.0 op_sel_hi:[1,0]
    v_pk_add_f32 v[250:251], v[250:251], 1.0 op_sel_hi:[1,0]
    v_pk_add_f32 v[252:253], v[252:253], 1.0 op_sel_hi:[1,0]
    v_rcp_f32 v30, v30
    v_rcp_f32 v31, v31
    v_rcp_f32 v238, v238
    v_rcp_f32 v239, v239
    v_rcp_f32 v250, v250
    v_rcp_f32 v251, v251
    v_rcp_f32 v252, v252
    v_rcp_f32 v253, v253
    v_pk_mul_f32 v[30:31], v[240:241], v[30:31]
    v_pk_mul_f32 v[238:239], v[242:243], v[238:239]
    v_pk_mul_f32 v[250:251], v[244:245], v[250:251]
    v_pk_mul_f32 v[252:253], v[246:247], v[252:253]
    v_cvt_pk_bf16_f32 v24, v30, v31
    v_cvt_pk_bf16_f32 v25, v238, v239
    v_cvt_pk_bf16_f32 v26, v250, v251
    v_cvt_pk_bf16_f32 v27, v252, v253
    ds_write_b128 v28, v[20:23] offset:0
    ds_write_b128 v28, v[24:27] offset:64
    v_accvgpr_read_b32 v240, a2
    v_accvgpr_read_b32 v241, a22
    v_accvgpr_read_b32 v242, a42
    v_accvgpr_read_b32 v243, a62
    v_accvgpr_read_b32 v244, a82
    v_accvgpr_read_b32 v245, a102
    v_accvgpr_read_b32 v246, a122
    v_accvgpr_read_b32 v247, a142
    v_exp_f32 v30, v240
    v_exp_f32 v31, v241
    v_exp_f32 v238, v242
    v_exp_f32 v239, v243
    v_exp_f32 v250, v244
    v_exp_f32 v251, v245
    v_exp_f32 v252, v246
    v_exp_f32 v253, v247
    v_pk_add_f32 v[30:31], v[30:31], 1.0 op_sel_hi:[1,0]
    v_pk_add_f32 v[238:239], v[238:239], 1.0 op_sel_hi:[1,0]
    v_pk_add_f32 v[250:251], v[250:251], 1.0 op_sel_hi:[1,0]
    v_pk_add_f32 v[252:253], v[252:253], 1.0 op_sel_hi:[1,0]
    v_rcp_f32 v30, v30
    v_rcp_f32 v31, v31
    v_rcp_f32 v238, v238
    v_rcp_f32 v239, v239
    v_rcp_f32 v250, v250
    v_rcp_f32 v251, v251
    v_rcp_f32 v252, v252
    v_rcp_f32 v253, v253
    v_pk_mul_f32 v[30:31], v[240:241], v[30:31]
    v_pk_mul_f32 v[238:239], v[242:243], v[238:239]
    v_pk_mul_f32 v[250:251], v[244:245], v[250:251]
    v_pk_mul_f32 v[252:253], v[246:247], v[252:253]
    v_cvt_pk_bf16_f32 v20, v30, v31
    v_cvt_pk_bf16_f32 v21, v238, v239
    v_cvt_pk_bf16_f32 v22, v250, v251
    v_cvt_pk_bf16_f32 v23, v252, v253
    v_accvgpr_read_b32 v240, a3
    v_accvgpr_read_b32 v241, a23
    v_accvgpr_read_b32 v242, a43
    v_accvgpr_read_b32 v243, a63
    v_accvgpr_read_b32 v244, a83
    v_accvgpr_read_b32 v245, a103
    v_accvgpr_read_b32 v246, a123
    v_accvgpr_read_b32 v247, a143
    v_exp_f32 v30, v240
    v_exp_f32 v31, v241
    v_exp_f32 v238, v242
    v_exp_f32 v239, v243
    v_exp_f32 v250, v244
    v_exp_f32 v251, v245
    v_exp_f32 v252, v246
    v_exp_f32 v253, v247
    v_pk_add_f32 v[30:31], v[30:31], 1.0 op_sel_hi:[1,0]
    v_pk_add_f32 v[238:239], v[238:239], 1.0 op_sel_hi:[1,0]
    v_pk_add_f32 v[250:251], v[250:251], 1.0 op_sel_hi:[1,0]
    v_pk_add_f32 v[252:253], v[252:253], 1.0 op_sel_hi:[1,0]
    v_rcp_f32 v30, v30
    v_rcp_f32 v31, v31
    v_rcp_f32 v238, v238
    v_rcp_f32 v239, v239
    v_rcp_f32 v250, v250
    v_rcp_f32 v251, v251
    v_rcp_f32 v252, v252
    v_rcp_f32 v253, v253
    v_pk_mul_f32 v[30:31], v[240:241], v[30:31]
    v_pk_mul_f32 v[238:239], v[242:243], v[238:239]
    v_pk_mul_f32 v[250:251], v[244:245], v[250:251]
    v_pk_mul_f32 v[252:253], v[246:247], v[252:253]
    v_cvt_pk_bf16_f32 v24, v30, v31
    v_cvt_pk_bf16_f32 v25, v238, v239
    v_cvt_pk_bf16_f32 v26, v250, v251
    v_cvt_pk_bf16_f32 v27, v252, v253
    ds_write_b128 v28, v[20:23] offset:128
    ds_write_b128 v28, v[24:27] offset:192
    v_accvgpr_read_b32 v240, a4
    v_accvgpr_read_b32 v241, a24
    v_accvgpr_read_b32 v242, a44
    v_accvgpr_read_b32 v243, a64
    v_accvgpr_read_b32 v244, a84
    v_accvgpr_read_b32 v245, a104
    v_accvgpr_read_b32 v246, a124
    v_accvgpr_read_b32 v247, a144
    v_exp_f32 v30, v240
    v_exp_f32 v31, v241
    v_exp_f32 v238, v242
    v_exp_f32 v239, v243
    v_exp_f32 v250, v244
    v_exp_f32 v251, v245
    v_exp_f32 v252, v246
    v_exp_f32 v253, v247
    v_pk_add_f32 v[30:31], v[30:31], 1.0 op_sel_hi:[1,0]
    v_pk_add_f32 v[238:239], v[238:239], 1.0 op_sel_hi:[1,0]
    v_pk_add_f32 v[250:251], v[250:251], 1.0 op_sel_hi:[1,0]
    v_pk_add_f32 v[252:253], v[252:253], 1.0 op_sel_hi:[1,0]
    v_rcp_f32 v30, v30
    v_rcp_f32 v31, v31
    v_rcp_f32 v238, v238
    v_rcp_f32 v239, v239
    v_rcp_f32 v250, v250
    v_rcp_f32 v251, v251
    v_rcp_f32 v252, v252
    v_rcp_f32 v253, v253
    v_pk_mul_f32 v[30:31], v[240:241], v[30:31]
    v_pk_mul_f32 v[238:239], v[242:243], v[238:239]
    v_pk_mul_f32 v[250:251], v[244:245], v[250:251]
    v_pk_mul_f32 v[252:253], v[246:247], v[252:253]
    v_cvt_pk_bf16_f32 v20, v30, v31
    v_cvt_pk_bf16_f32 v21, v238, v239
    v_cvt_pk_bf16_f32 v22, v250, v251
    v_cvt_pk_bf16_f32 v23, v252, v253
    v_accvgpr_read_b32 v240, a5
    v_accvgpr_read_b32 v241, a25
    v_accvgpr_read_b32 v242, a45
    v_accvgpr_read_b32 v243, a65
    v_accvgpr_read_b32 v244, a85
    v_accvgpr_read_b32 v245, a105
    v_accvgpr_read_b32 v246, a125
    v_accvgpr_read_b32 v247, a145
    v_exp_f32 v30, v240
    v_exp_f32 v31, v241
    v_exp_f32 v238, v242
    v_exp_f32 v239, v243
    v_exp_f32 v250, v244
    v_exp_f32 v251, v245
    v_exp_f32 v252, v246
    v_exp_f32 v253, v247
    v_pk_add_f32 v[30:31], v[30:31], 1.0 op_sel_hi:[1,0]
    v_pk_add_f32 v[238:239], v[238:239], 1.0 op_sel_hi:[1,0]
    v_pk_add_f32 v[250:251], v[250:251], 1.0 op_sel_hi:[1,0]
    v_pk_add_f32 v[252:253], v[252:253], 1.0 op_sel_hi:[1,0]
    v_rcp_f32 v30, v30
    v_rcp_f32 v31, v31
    v_rcp_f32 v238, v238
    v_rcp_f32 v239, v239
    v_rcp_f32 v250, v250
    v_rcp_f32 v251, v251
    v_rcp_f32 v252, v252
    v_rcp_f32 v253, v253
    v_pk_mul_f32 v[30:31], v[240:241], v[30:31]
    v_pk_mul_f32 v[238:239], v[242:243], v[238:239]
    v_pk_mul_f32 v[250:251], v[244:245], v[250:251]
    v_pk_mul_f32 v[252:253], v[246:247], v[252:253]
    v_cvt_pk_bf16_f32 v24, v30, v31
    v_cvt_pk_bf16_f32 v25, v238, v239
    v_cvt_pk_bf16_f32 v26, v250, v251
    v_cvt_pk_bf16_f32 v27, v252, v253
    ds_write_b128 v28, v[20:23] offset:1024
    ds_write_b128 v28, v[24:27] offset:1088
    v_accvgpr_read_b32 v240, a6
    v_accvgpr_read_b32 v241, a26
    v_accvgpr_read_b32 v242, a46
    v_accvgpr_read_b32 v243, a66
    v_accvgpr_read_b32 v244, a86
    v_accvgpr_read_b32 v245, a106
    v_accvgpr_read_b32 v246, a126
    v_accvgpr_read_b32 v247, a146
    v_exp_f32 v30, v240
    v_exp_f32 v31, v241
    v_exp_f32 v238, v242
    v_exp_f32 v239, v243
    v_exp_f32 v250, v244
    v_exp_f32 v251, v245
    v_exp_f32 v252, v246
    v_exp_f32 v253, v247
    v_pk_add_f32 v[30:31], v[30:31], 1.0 op_sel_hi:[1,0]
    v_pk_add_f32 v[238:239], v[238:239], 1.0 op_sel_hi:[1,0]
    v_pk_add_f32 v[250:251], v[250:251], 1.0 op_sel_hi:[1,0]
    v_pk_add_f32 v[252:253], v[252:253], 1.0 op_sel_hi:[1,0]
    v_rcp_f32 v30, v30
    v_rcp_f32 v31, v31
    v_rcp_f32 v238, v238
    v_rcp_f32 v239, v239
    v_rcp_f32 v250, v250
    v_rcp_f32 v251, v251
    v_rcp_f32 v252, v252
    v_rcp_f32 v253, v253
    v_pk_mul_f32 v[30:31], v[240:241], v[30:31]
    v_pk_mul_f32 v[238:239], v[242:243], v[238:239]
    v_pk_mul_f32 v[250:251], v[244:245], v[250:251]
    v_pk_mul_f32 v[252:253], v[246:247], v[252:253]
    v_cvt_pk_bf16_f32 v20, v30, v31
    v_cvt_pk_bf16_f32 v21, v238, v239
    v_cvt_pk_bf16_f32 v22, v250, v251
    v_cvt_pk_bf16_f32 v23, v252, v253
    v_accvgpr_read_b32 v240, a7
    v_accvgpr_read_b32 v241, a27
    v_accvgpr_read_b32 v242, a47
    v_accvgpr_read_b32 v243, a67
    v_accvgpr_read_b32 v244, a87
    v_accvgpr_read_b32 v245, a107
    v_accvgpr_read_b32 v246, a127
    v_accvgpr_read_b32 v247, a147
    v_exp_f32 v30, v240
    v_exp_f32 v31, v241
    v_exp_f32 v238, v242
    v_exp_f32 v239, v243
    v_exp_f32 v250, v244
    v_exp_f32 v251, v245
    v_exp_f32 v252, v246
    v_exp_f32 v253, v247
    v_pk_add_f32 v[30:31], v[30:31], 1.0 op_sel_hi:[1,0]
    v_pk_add_f32 v[238:239], v[238:239], 1.0 op_sel_hi:[1,0]
    v_pk_add_f32 v[250:251], v[250:251], 1.0 op_sel_hi:[1,0]
    v_pk_add_f32 v[252:253], v[252:253], 1.0 op_sel_hi:[1,0]
    v_rcp_f32 v30, v30
    v_rcp_f32 v31, v31
    v_rcp_f32 v238, v238
    v_rcp_f32 v239, v239
    v_rcp_f32 v250, v250
    v_rcp_f32 v251, v251
    v_rcp_f32 v252, v252
    v_rcp_f32 v253, v253
    v_pk_mul_f32 v[30:31], v[240:241], v[30:31]
    v_pk_mul_f32 v[238:239], v[242:243], v[238:239]
    v_pk_mul_f32 v[250:251], v[244:245], v[250:251]
    v_pk_mul_f32 v[252:253], v[246:247], v[252:253]
    v_cvt_pk_bf16_f32 v24, v30, v31
    v_cvt_pk_bf16_f32 v25, v238, v239
    v_cvt_pk_bf16_f32 v26, v250, v251
    v_cvt_pk_bf16_f32 v27, v252, v253
    ds_write_b128 v28, v[20:23] offset:1152
    ds_write_b128 v28, v[24:27] offset:1216
    v_accvgpr_read_b32 v240, a8
    v_accvgpr_read_b32 v241, a28
    v_accvgpr_read_b32 v242, a48
    v_accvgpr_read_b32 v243, a68
    v_accvgpr_read_b32 v244, a88
    v_accvgpr_read_b32 v245, a108
    v_accvgpr_read_b32 v246, a128
    v_accvgpr_read_b32 v247, a148
    v_exp_f32 v30, v240
    v_exp_f32 v31, v241
    v_exp_f32 v238, v242
    v_exp_f32 v239, v243
    v_exp_f32 v250, v244
    v_exp_f32 v251, v245
    v_exp_f32 v252, v246
    v_exp_f32 v253, v247
    v_pk_add_f32 v[30:31], v[30:31], 1.0 op_sel_hi:[1,0]
    v_pk_add_f32 v[238:239], v[238:239], 1.0 op_sel_hi:[1,0]
    v_pk_add_f32 v[250:251], v[250:251], 1.0 op_sel_hi:[1,0]
    v_pk_add_f32 v[252:253], v[252:253], 1.0 op_sel_hi:[1,0]
    v_rcp_f32 v30, v30
    v_rcp_f32 v31, v31
    v_rcp_f32 v238, v238
    v_rcp_f32 v239, v239
    v_rcp_f32 v250, v250
    v_rcp_f32 v251, v251
    v_rcp_f32 v252, v252
    v_rcp_f32 v253, v253
    v_pk_mul_f32 v[30:31], v[240:241], v[30:31]
    v_pk_mul_f32 v[238:239], v[242:243], v[238:239]
    v_pk_mul_f32 v[250:251], v[244:245], v[250:251]
    v_pk_mul_f32 v[252:253], v[246:247], v[252:253]
    v_cvt_pk_bf16_f32 v20, v30, v31
    v_cvt_pk_bf16_f32 v21, v238, v239
    v_cvt_pk_bf16_f32 v22, v250, v251
    v_cvt_pk_bf16_f32 v23, v252, v253
    v_accvgpr_read_b32 v240, a9
    v_accvgpr_read_b32 v241, a29
    v_accvgpr_read_b32 v242, a49
    v_accvgpr_read_b32 v243, a69
    v_accvgpr_read_b32 v244, a89
    v_accvgpr_read_b32 v245, a109
    v_accvgpr_read_b32 v246, a129
    v_accvgpr_read_b32 v247, a149
    v_exp_f32 v30, v240
    v_exp_f32 v31, v241
    v_exp_f32 v238, v242
    v_exp_f32 v239, v243
    v_exp_f32 v250, v244
    v_exp_f32 v251, v245
    v_exp_f32 v252, v246
    v_exp_f32 v253, v247
    v_pk_add_f32 v[30:31], v[30:31], 1.0 op_sel_hi:[1,0]
    v_pk_add_f32 v[238:239], v[238:239], 1.0 op_sel_hi:[1,0]
    v_pk_add_f32 v[250:251], v[250:251], 1.0 op_sel_hi:[1,0]
    v_pk_add_f32 v[252:253], v[252:253], 1.0 op_sel_hi:[1,0]
    v_rcp_f32 v30, v30
    v_rcp_f32 v31, v31
    v_rcp_f32 v238, v238
    v_rcp_f32 v239, v239
    v_rcp_f32 v250, v250
    v_rcp_f32 v251, v251
    v_rcp_f32 v252, v252
    v_rcp_f32 v253, v253
    v_pk_mul_f32 v[30:31], v[240:241], v[30:31]
    v_pk_mul_f32 v[238:239], v[242:243], v[238:239]
    v_pk_mul_f32 v[250:251], v[244:245], v[250:251]
    v_pk_mul_f32 v[252:253], v[246:247], v[252:253]
    v_cvt_pk_bf16_f32 v24, v30, v31
    v_cvt_pk_bf16_f32 v25, v238, v239
    v_cvt_pk_bf16_f32 v26, v250, v251
    v_cvt_pk_bf16_f32 v27, v252, v253
    ds_write_b128 v28, v[20:23] offset:2048
    ds_write_b128 v28, v[24:27] offset:2112
    v_accvgpr_read_b32 v240, a10
    v_accvgpr_read_b32 v241, a30
    v_accvgpr_read_b32 v242, a50
    v_accvgpr_read_b32 v243, a70
    v_accvgpr_read_b32 v244, a90
    v_accvgpr_read_b32 v245, a110
    v_accvgpr_read_b32 v246, a130
    v_accvgpr_read_b32 v247, a150
    v_exp_f32 v30, v240
    v_exp_f32 v31, v241
    v_exp_f32 v238, v242
    v_exp_f32 v239, v243
    v_exp_f32 v250, v244
    v_exp_f32 v251, v245
    v_exp_f32 v252, v246
    v_exp_f32 v253, v247
    v_pk_add_f32 v[30:31], v[30:31], 1.0 op_sel_hi:[1,0]
    v_pk_add_f32 v[238:239], v[238:239], 1.0 op_sel_hi:[1,0]
    v_pk_add_f32 v[250:251], v[250:251], 1.0 op_sel_hi:[1,0]
    v_pk_add_f32 v[252:253], v[252:253], 1.0 op_sel_hi:[1,0]
    v_rcp_f32 v30, v30
    v_rcp_f32 v31, v31
    v_rcp_f32 v238, v238
    v_rcp_f32 v239, v239
    v_rcp_f32 v250, v250
    v_rcp_f32 v251, v251
    v_rcp_f32 v252, v252
    v_rcp_f32 v253, v253
    v_pk_mul_f32 v[30:31], v[240:241], v[30:31]
    v_pk_mul_f32 v[238:239], v[242:243], v[238:239]
    v_pk_mul_f32 v[250:251], v[244:245], v[250:251]
    v_pk_mul_f32 v[252:253], v[246:247], v[252:253]
    v_cvt_pk_bf16_f32 v20, v30, v31
    v_cvt_pk_bf16_f32 v21, v238, v239
    v_cvt_pk_bf16_f32 v22, v250, v251
    v_cvt_pk_bf16_f32 v23, v252, v253
    v_accvgpr_read_b32 v240, a11
    v_accvgpr_read_b32 v241, a31
    v_accvgpr_read_b32 v242, a51
    v_accvgpr_read_b32 v243, a71
    v_accvgpr_read_b32 v244, a91
    v_accvgpr_read_b32 v245, a111
    v_accvgpr_read_b32 v246, a131
    v_accvgpr_read_b32 v247, a151
    v_exp_f32 v30, v240
    v_exp_f32 v31, v241
    v_exp_f32 v238, v242
    v_exp_f32 v239, v243
    v_exp_f32 v250, v244
    v_exp_f32 v251, v245
    v_exp_f32 v252, v246
    v_exp_f32 v253, v247
    v_pk_add_f32 v[30:31], v[30:31], 1.0 op_sel_hi:[1,0]
    v_pk_add_f32 v[238:239], v[238:239], 1.0 op_sel_hi:[1,0]
    v_pk_add_f32 v[250:251], v[250:251], 1.0 op_sel_hi:[1,0]
    v_pk_add_f32 v[252:253], v[252:253], 1.0 op_sel_hi:[1,0]
    v_rcp_f32 v30, v30
    v_rcp_f32 v31, v31
    v_rcp_f32 v238, v238
    v_rcp_f32 v239, v239
    v_rcp_f32 v250, v250
    v_rcp_f32 v251, v251
    v_rcp_f32 v252, v252
    v_rcp_f32 v253, v253
    v_pk_mul_f32 v[30:31], v[240:241], v[30:31]
    v_pk_mul_f32 v[238:239], v[242:243], v[238:239]
    v_pk_mul_f32 v[250:251], v[244:245], v[250:251]
    v_pk_mul_f32 v[252:253], v[246:247], v[252:253]
    v_cvt_pk_bf16_f32 v24, v30, v31
    v_cvt_pk_bf16_f32 v25, v238, v239
    v_cvt_pk_bf16_f32 v26, v250, v251
    v_cvt_pk_bf16_f32 v27, v252, v253
    ds_write_b128 v28, v[20:23] offset:2176
    ds_write_b128 v28, v[24:27] offset:2240
    v_accvgpr_read_b32 v240, a12
    v_accvgpr_read_b32 v241, a32
    v_accvgpr_read_b32 v242, a52
    v_accvgpr_read_b32 v243, a72
    v_accvgpr_read_b32 v244, a92
    v_accvgpr_read_b32 v245, a112
    v_accvgpr_read_b32 v246, a132
    v_accvgpr_read_b32 v247, a152
    v_exp_f32 v30, v240
    v_exp_f32 v31, v241
    v_exp_f32 v238, v242
    v_exp_f32 v239, v243
    v_exp_f32 v250, v244
    v_exp_f32 v251, v245
    v_exp_f32 v252, v246
    v_exp_f32 v253, v247
    v_pk_add_f32 v[30:31], v[30:31], 1.0 op_sel_hi:[1,0]
    v_pk_add_f32 v[238:239], v[238:239], 1.0 op_sel_hi:[1,0]
    v_pk_add_f32 v[250:251], v[250:251], 1.0 op_sel_hi:[1,0]
    v_pk_add_f32 v[252:253], v[252:253], 1.0 op_sel_hi:[1,0]
    v_rcp_f32 v30, v30
    v_rcp_f32 v31, v31
    v_rcp_f32 v238, v238
    v_rcp_f32 v239, v239
    v_rcp_f32 v250, v250
    v_rcp_f32 v251, v251
    v_rcp_f32 v252, v252
    v_rcp_f32 v253, v253
    v_pk_mul_f32 v[30:31], v[240:241], v[30:31]
    v_pk_mul_f32 v[238:239], v[242:243], v[238:239]
    v_pk_mul_f32 v[250:251], v[244:245], v[250:251]
    v_pk_mul_f32 v[252:253], v[246:247], v[252:253]
    v_cvt_pk_bf16_f32 v20, v30, v31
    v_cvt_pk_bf16_f32 v21, v238, v239
    v_cvt_pk_bf16_f32 v22, v250, v251
    v_cvt_pk_bf16_f32 v23, v252, v253
    v_accvgpr_read_b32 v240, a13
    v_accvgpr_read_b32 v241, a33
    v_accvgpr_read_b32 v242, a53
    v_accvgpr_read_b32 v243, a73
    v_accvgpr_read_b32 v244, a93
    v_accvgpr_read_b32 v245, a113
    v_accvgpr_read_b32 v246, a133
    v_accvgpr_read_b32 v247, a153
    v_exp_f32 v30, v240
    v_exp_f32 v31, v241
    v_exp_f32 v238, v242
    v_exp_f32 v239, v243
    v_exp_f32 v250, v244
    v_exp_f32 v251, v245
    v_exp_f32 v252, v246
    v_exp_f32 v253, v247
    v_pk_add_f32 v[30:31], v[30:31], 1.0 op_sel_hi:[1,0]
    v_pk_add_f32 v[238:239], v[238:239], 1.0 op_sel_hi:[1,0]
    v_pk_add_f32 v[250:251], v[250:251], 1.0 op_sel_hi:[1,0]
    v_pk_add_f32 v[252:253], v[252:253], 1.0 op_sel_hi:[1,0]
    v_rcp_f32 v30, v30
    v_rcp_f32 v31, v31
    v_rcp_f32 v238, v238
    v_rcp_f32 v239, v239
    v_rcp_f32 v250, v250
    v_rcp_f32 v251, v251
    v_rcp_f32 v252, v252
    v_rcp_f32 v253, v253
    v_pk_mul_f32 v[30:31], v[240:241], v[30:31]
    v_pk_mul_f32 v[238:239], v[242:243], v[238:239]
    v_pk_mul_f32 v[250:251], v[244:245], v[250:251]
    v_pk_mul_f32 v[252:253], v[246:247], v[252:253]
    v_cvt_pk_bf16_f32 v24, v30, v31
    v_cvt_pk_bf16_f32 v25, v238, v239
    v_cvt_pk_bf16_f32 v26, v250, v251
    v_cvt_pk_bf16_f32 v27, v252, v253
    ds_write_b128 v28, v[20:23] offset:3072
    ds_write_b128 v28, v[24:27] offset:3136
    v_accvgpr_read_b32 v240, a14
    v_accvgpr_read_b32 v241, a34
    v_accvgpr_read_b32 v242, a54
    v_accvgpr_read_b32 v243, a74
    v_accvgpr_read_b32 v244, a94
    v_accvgpr_read_b32 v245, a114
    v_accvgpr_read_b32 v246, a134
    v_accvgpr_read_b32 v247, a154
    v_exp_f32 v30, v240
    v_exp_f32 v31, v241
    v_exp_f32 v238, v242
    v_exp_f32 v239, v243
    v_exp_f32 v250, v244
    v_exp_f32 v251, v245
    v_exp_f32 v252, v246
    v_exp_f32 v253, v247
    v_pk_add_f32 v[30:31], v[30:31], 1.0 op_sel_hi:[1,0]
    v_pk_add_f32 v[238:239], v[238:239], 1.0 op_sel_hi:[1,0]
    v_pk_add_f32 v[250:251], v[250:251], 1.0 op_sel_hi:[1,0]
    v_pk_add_f32 v[252:253], v[252:253], 1.0 op_sel_hi:[1,0]
    v_rcp_f32 v30, v30
    v_rcp_f32 v31, v31
    v_rcp_f32 v238, v238
    v_rcp_f32 v239, v239
    v_rcp_f32 v250, v250
    v_rcp_f32 v251, v251
    v_rcp_f32 v252, v252
    v_rcp_f32 v253, v253
    v_pk_mul_f32 v[30:31], v[240:241], v[30:31]
    v_pk_mul_f32 v[238:239], v[242:243], v[238:239]
    v_pk_mul_f32 v[250:251], v[244:245], v[250:251]
    v_pk_mul_f32 v[252:253], v[246:247], v[252:253]
    v_cvt_pk_bf16_f32 v20, v30, v31
    v_cvt_pk_bf16_f32 v21, v238, v239
    v_cvt_pk_bf16_f32 v22, v250, v251
    v_cvt_pk_bf16_f32 v23, v252, v253
    v_accvgpr_read_b32 v240, a15
    v_accvgpr_read_b32 v241, a35
    v_accvgpr_read_b32 v242, a55
    v_accvgpr_read_b32 v243, a75
    v_accvgpr_read_b32 v244, a95
    v_accvgpr_read_b32 v245, a115
    v_accvgpr_read_b32 v246, a135
    v_accvgpr_read_b32 v247, a155
    v_exp_f32 v30, v240
    v_exp_f32 v31, v241
    v_exp_f32 v238, v242
    v_exp_f32 v239, v243
    v_exp_f32 v250, v244
    v_exp_f32 v251, v245
    v_exp_f32 v252, v246
    v_exp_f32 v253, v247
    v_pk_add_f32 v[30:31], v[30:31], 1.0 op_sel_hi:[1,0]
    v_pk_add_f32 v[238:239], v[238:239], 1.0 op_sel_hi:[1,0]
    v_pk_add_f32 v[250:251], v[250:251], 1.0 op_sel_hi:[1,0]
    v_pk_add_f32 v[252:253], v[252:253], 1.0 op_sel_hi:[1,0]
    v_rcp_f32 v30, v30
    v_rcp_f32 v31, v31
    v_rcp_f32 v238, v238
    v_rcp_f32 v239, v239
    v_rcp_f32 v250, v250
    v_rcp_f32 v251, v251
    v_rcp_f32 v252, v252
    v_rcp_f32 v253, v253
    v_pk_mul_f32 v[30:31], v[240:241], v[30:31]
    v_pk_mul_f32 v[238:239], v[242:243], v[238:239]
    v_pk_mul_f32 v[250:251], v[244:245], v[250:251]
    v_pk_mul_f32 v[252:253], v[246:247], v[252:253]
    v_cvt_pk_bf16_f32 v24, v30, v31
    v_cvt_pk_bf16_f32 v25, v238, v239
    v_cvt_pk_bf16_f32 v26, v250, v251
    v_cvt_pk_bf16_f32 v27, v252, v253
    ds_write_b128 v28, v[20:23] offset:3200
    ds_write_b128 v28, v[24:27] offset:3264
    s_lshl_b32 s33, s30, 12
    s_add_u32 s33, s33, L4_tail - L_pc0
    v_lshl_add_u32 v12, v13, 7, s33
    v_min_u32 v12, L_main_end - L_pc0, v12
    s_mov_b32 exec_hi, 0
    global_load_dword v249, v12, s[94:95]
    s_mov_b64 exec, -1
    .p2alignl 3, 0xbf800000
    v_accvgpr_read_b32 v240, a160
    v_accvgpr_read_b32 v241, a161
    v_accvgpr_read_b32 v242, a162
    v_accvgpr_read_b32 v243, a163
    v_accvgpr_read_b32 v244, a164
    v_accvgpr_read_b32 v245, a165
    v_accvgpr_read_b32 v246, a166
    v_accvgpr_read_b32 v247, a167
    v_exp_f32 v30, v240
    v_exp_f32 v31, v241
    v_exp_f32 v238, v242
    v_exp_f32 v239, v243
    v_exp_f32 v250, v244
    v_exp_f32 v251, v245
    v_exp_f32 v252, v246
    v_exp_f32 v253, v247
    v_pk_add_f32 v[30:31], v[30:31], 1.0 op_sel_hi:[1,0]
    v_pk_add_f32 v[238:239], v[238:239], 1.0 op_sel_hi:[1,0]
    v_pk_add_f32 v[250:251], v[250:251], 1.0 op_sel_hi:[1,0]
    v_pk_add_f32 v[252:253], v[252:253], 1.0 op_sel_hi:[1,0]
    v_rcp_f32 v30, v30
    v_rcp_f32 v31, v31
    v_rcp_f32 v238, v238
    v_rcp_f32 v239, v239
    v_rcp_f32 v250, v250
    v_rcp_f32 v251, v251
    v_rcp_f32 v252, v252
    v_rcp_f32 v253, v253
    v_pk_mul_f32 v[30:31], v[240:241], v[30:31]
    v_pk_mul_f32 v[238:239], v[242:243], v[238:239]
    v_pk_mul_f32 v[250:251], v[244:245], v[250:251]
    v_pk_mul_f32 v[252:253], v[246:247], v[252:253]
    v_cvt_pk_bf16_f32 v20, v30, v31
    v_cvt_pk_bf16_f32 v21, v238, v239
    v_cvt_pk_bf16_f32 v22, v250, v251
    v_cvt_pk_bf16_f32 v23, v252, v253
    ds_write_b64 v29, v[20:21] offset:0
    ds_write_b64 v29, v[22:23] offset:1024
    v_accvgpr_read_b32 v240, a168
    v_accvgpr_read_b32 v241, a169
    v_accvgpr_read_b32 v242, a170
    v_accvgpr_read_b32 v243, a171
    v_accvgpr_read_b32 v244, a172
    v_accvgpr_read_b32 v245, a173
    v_accvgpr_read_b32 v246, a174
    v_accvgpr_read_b32 v247, a175
    v_exp_f32 v30, v240
    v_exp_f32 v31, v241
    v_exp_f32 v238, v242
    v_exp_f32 v239, v243
    v_exp_f32 v250, v244
    v_exp_f32 v251, v245
    v_exp_f32 v252, v246
    v_exp_f32 v253, v247
    v_pk_add_f32 v[30:31], v[30:31], 1.0 op_sel_hi:[1,0]
    v_pk_add_f32 v[238:239], v[238:239], 1.0 op_sel_hi:[1,0]
    v_pk_add_f32 v[250:251], v[250:251], 1.0 op_sel_hi:[1,0]
    v_pk_add_f32 v[252:253], v[252:253], 1.0 op_sel_hi:[1,0]
    v_rcp_f32 v30, v30
    v_rcp_f32 v31, v31
    v_rcp_f32 v238, v238
    v_rcp_f32 v239, v239
    v_rcp_f32 v250, v250
    v_rcp_f32 v251, v251
    v_rcp_f32 v252, v252
    v_rcp_f32 v253, v253
    v_pk_mul_f32 v[30:31], v[240:241], v[30:31]
    v_pk_mul_f32 v[238:239], v[242:243], v[238:239]
    v_pk_mul_f32 v[250:251], v[244:245], v[250:251]
    v_pk_mul_f32 v[252:253], v[246:247], v[252:253]
    v_cvt_pk_bf16_f32 v24, v30, v31
    v_cvt_pk_bf16_f32 v25, v238, v239
    v_cvt_pk_bf16_f32 v26, v250, v251
    v_cvt_pk_bf16_f32 v27, v252, v253
    ds_write_b64 v29, v[24:25] offset:2048
    ds_write_b64 v29, v[26:27] offset:3072
    s_waitcnt lgkmcnt(0)
    s_barrier
    ds_read_b128 a[180:183], v10 offset:0
    ds_read_b128 a[184:187], v10 offset:1024
    ds_read_b128 a[188:191], v10 offset:2048
    ds_read_b128 a[192:195], v10 offset:3072
    s_waitcnt lgkmcnt(0)
    s_branch L4_gemm_zero
L_tail_wt:
    global_load_dword v249, v1, s[100:101] offset:256 sc1
    v_mfma_f32_16x16x32_bf16 a[0:3], a[200:203], v[32:35], a[0:3]
    ds_read_b64_tr_b16 a[220:221], v11 offset:4096
    v_mfma_f32_16x16x32_bf16 a[4:7], a[204:207], v[32:35], a[4:7]
    v_perm_b32 v40, v69, v65, s48
    v_perm_b32 v41, v77, v73, s48
    v_mfma_f32_16x16x32_bf16 a[20:23], a[200:203], v[36:39], a[20:23]
    v_perm_b32 v42, v85, v81, s48
    v_perm_b32 v43, v93, v89, s48
    v_mfma_f32_16x16x32_bf16 a[24:27], a[204:207], v[36:39], a[24:27]
    v_perm_b32 v44, v69, v65, s49
    v_perm_b32 v45, v77, v73, s49
    v_mfma_f32_16x16x32_bf16 a[40:43], a[200:203], v[40:43], a[40:43]
    v_perm_b32 v46, v85, v81, s49
    v_perm_b32 v47, v93, v89, s49
    v_mfma_f32_16x16x32_bf16 a[44:47], a[204:207], v[40:43], a[44:47]
    v_perm_b32 v48, v70, v66, s48
    v_perm_b32 v49, v78, v74, s48
    v_mfma_f32_16x16x32_bf16 a[60:63], a[200:203], v[44:47], a[60:63]
    v_perm_b32 v50, v86, v82, s48
    v_perm_b32 v51, v94, v90, s48
    v_mfma_f32_16x16x32_bf16 a[64:67], a[204:207], v[44:47], a[64:67]
    v_perm_b32 v52, v70, v66, s49
    v_perm_b32 v53, v78, v74, s49
    v_mfma_f32_16x16x32_bf16 a[80:83], a[200:203], v[48:51], a[80:83]
    v_perm_b32 v54, v86, v82, s49
    v_perm_b32 v55, v94, v90, s49
    ds_read_b64_tr_b16 a[222:223], v11 offset:6144
    v_mfma_f32_16x16x32_bf16 a[84:87], a[204:207], v[48:51], a[84:87]
    v_perm_b32 v56, v71, v67, s48
    v_perm_b32 v57, v79, v75, s48
    v_mfma_f32_16x16x32_bf16 a[100:103], a[200:203], v[52:55], a[100:103]
    v_perm_b32 v58, v87, v83, s48
    v_perm_b32 v59, v95, v91, s48
    v_mfma_f32_16x16x32_bf16 a[104:107], a[204:207], v[52:55], a[104:107]
    v_perm_b32 v60, v71, v67, s49
    v_perm_b32 v61, v79, v75, s49
    v_mfma_f32_16x16x32_bf16 a[120:123], a[200:203], v[56:59], a[120:123]
    v_perm_b32 v62, v87, v83, s49
    v_perm_b32 v63, v95, v91, s49
    v_mfma_f32_16x16x32_bf16 a[124:127], a[204:207], v[56:59], a[124:127]
    buffer_load_dword v249, v236, s[44:47], s99 offen sc1
    v_mfma_f32_16x16x32_bf16 a[140:143], a[200:203], v[60:63], a[140:143]
    ds_read_b128 a[240:243], v10 offset:16384
    v_mfma_f32_16x16x32_bf16 a[144:147], a[204:207], v[60:63], a[144:147]
    s_waitcnt vmcnt(29)
    s_barrier
    v_perm_b32 v64, v100, v96, s48
    v_perm_b32 v65, v108, v104, s48
    s_waitcnt lgkmcnt(1)
    v_mfma_f32_16x16x32_bf16 a[160:163], a[220:223], a[200:203], a[160:163]
    v_perm_b32 v66, v116, v112, s48
    v_perm_b32 v67, v124, v120, s48
    v_mfma_f32_16x16x32_bf16 a[164:167], a[220:223], a[204:207], a[164:167]
    v_perm_b32 v68, v100, v96, s49
    v_perm_b32 v69, v108, v104, s49
    v_mfma_f32_16x16x32_bf16 a[0:3], a[208:211], v[64:67], a[0:3]
    v_perm_b32 v70, v116, v112, s49
    v_perm_b32 v71, v124, v120, s49
    v_mfma_f32_16x16x32_bf16 a[4:7], a[212:215], v[64:67], a[4:7]
    v_perm_b32 v72, v101, v97, s48
    v_perm_b32 v73, v109, v105, s48
    v_mfma_f32_16x16x32_bf16 a[20:23], a[208:211], v[68:71], a[20:23]
    v_perm_b32 v74, v117, v113, s48
    v_perm_b32 v75, v125, v121, s48
    v_mfma_f32_16x16x32_bf16 a[24:27], a[212:215], v[68:71], a[24:27]
    v_perm_b32 v76, v101, v97, s49
    v_perm_b32 v77, v109, v105, s49
    v_mfma_f32_16x16x32_bf16 a[40:43], a[208:211], v[72:75], a[40:43]
    v_perm_b32 v78, v117, v113, s49
    v_perm_b32 v79, v125, v121, s49
    v_mfma_f32_16x16x32_bf16 a[44:47], a[212:215], v[72:75], a[44:47]
    v_perm_b32 v80, v102, v98, s48
    v_perm_b32 v81, v110, v106, s48
    v_mfma_f32_16x16x32_bf16 a[60:63], a[208:211], v[76:79], a[60:63]
    v_perm_b32 v82, v118, v114, s48
    v_perm_b32 v83, v126, v122, s48
    v_mfma_f32_16x16x32_bf16 a[64:67], a[212:215], v[76:79], a[64:67]
    v_perm_b32 v84, v102, v98, s49
    v_perm_b32 v85, v110, v106, s49
    v_mfma_f32_16x16x32_bf16 a[80:83], a[208:211], v[80:83], a[80:83]
    v_perm_b32 v86, v118, v114, s49
    v_perm_b32 v87, v126, v122, s49
    ds_read_b64_tr_b16 a[224:225], v11 offset:8192
    v_mfma_f32_16x16x32_bf16 a[84:87], a[212:215], v[80:83], a[84:87]
    v_perm_b32 v88, v103, v99, s48
    v_perm_b32 v89, v111, v107, s48
    ds_read_b64_tr_b16 a[226:227], v11 offset:10240
    v_mfma_f32_16x16x32_bf16 a[100:103], a[208:211], v[84:87], a[100:103]
    v_perm_b32 v90, v119, v115, s48
    v_perm_b32 v91, v127, v123, s48
    v_mfma_f32_16x16x32_bf16 a[104:107], a[212:215], v[84:87], a[104:107]
    v_perm_b32 v92, v103, v99, s49
    v_perm_b32 v93, v111, v107, s49
    v_mfma_f32_16x16x32_bf16 a[120:123], a[208:211], v[88:91], a[120:123]
    v_perm_b32 v94, v119, v115, s49
    v_perm_b32 v95, v127, v123, s49
    v_mfma_f32_16x16x32_bf16 a[124:127], a[212:215], v[88:91], a[124:127]
    ds_read_b128 a[244:247], v10 offset:20480
    v_mfma_f32_16x16x32_bf16 a[140:143], a[208:211], v[92:95], a[140:143]
    ds_read_b128 a[248:251], v10 offset:21504
    v_mfma_f32_16x16x32_bf16 a[144:147], a[212:215], v[92:95], a[144:147]
    s_waitcnt vmcnt(20)
    s_barrier
    v_perm_b32 v96, v132, v128, s48
    v_perm_b32 v97, v140, v136, s48
    s_waitcnt lgkmcnt(2)
    v_mfma_f32_16x16x32_bf16 a[160:163], a[224:227], a[208:211], a[160:163]
    v_perm_b32 v98, v148, v144, s48
    v_perm_b32 v99, v156, v152, s48
    v_mfma_f32_16x16x32_bf16 a[164:167], a[224:227], a[212:215], a[164:167]
    v_perm_b32 v100, v132, v128, s49
    v_perm_b32 v101, v140, v136, s49
    v_mfma_f32_16x16x32_bf16 a[0:3], a[216:219], v[96:99], a[0:3]
    v_perm_b32 v102, v148, v144, s49
    v_perm_b32 v103, v156, v152, s49
    s_waitcnt lgkmcnt(4)
    v_mfma_f32_16x16x32_bf16 a[4:7], a[240:243], v[96:99], a[4:7]
    v_perm_b32 v104, v133, v129, s48
    v_perm_b32 v105, v141, v137, s48
    v_mfma_f32_16x16x32_bf16 a[20:23], a[216:219], v[100:103], a[20:23]
    v_perm_b32 v106, v149, v145, s48
    v_perm_b32 v107, v157, v153, s48
    v_mfma_f32_16x16x32_bf16 a[24:27], a[240:243], v[100:103], a[24:27]
    v_perm_b32 v108, v133, v129, s49
    v_perm_b32 v109, v141, v137, s49
    v_mfma_f32_16x16x32_bf16 a[40:43], a[216:219], v[104:107], a[40:43]
    v_perm_b32 v110, v149, v145, s49
    v_perm_b32 v111, v157, v153, s49
    v_mfma_f32_16x16x32_bf16 a[44:47], a[240:243], v[104:107], a[44:47]
    v_perm_b32 v112, v134, v130, s48
    v_perm_b32 v113, v142, v138, s48
    v_mfma_f32_16x16x32_bf16 a[60:63], a[216:219], v[108:111], a[60:63]
    v_perm_b32 v114, v150, v146, s48
    v_perm_b32 v115, v158, v154, s48
    v_mfma_f32_16x16x32_bf16 a[64:67], a[240:243], v[108:111], a[64:67]
    v_perm_b32 v116, v134, v130, s49
    v_perm_b32 v117, v142, v138, s49
    v_mfma_f32_16x16x32_bf16 a[80:83], a[216:219], v[112:115], a[80:83]
    v_perm_b32 v118, v150, v146, s49
    v_perm_b32 v119, v158, v154, s49
    ds_read_b64_tr_b16 a[228:229], v11 offset:12288
    v_mfma_f32_16x16x32_bf16 a[84:87], a[240:243], v[112:115], a[84:87]
    v_perm_b32 v120, v135, v131, s48
    v_perm_b32 v121, v143, v139, s48
    ds_read_b64_tr_b16 a[230:231], v11 offset:14336
    v_mfma_f32_16x16x32_bf16 a[100:103], a[216:219], v[116:119], a[100:103]
    v_perm_b32 v122, v151, v147, s48
    v_perm_b32 v123, v159, v155, s48
    v_mfma_f32_16x16x32_bf16 a[104:107], a[240:243], v[116:119], a[104:107]
    v_perm_b32 v124, v135, v131, s49
    v_perm_b32 v125, v143, v139, s49
    v_mfma_f32_16x16x32_bf16 a[120:123], a[216:219], v[120:123], a[120:123]
    v_perm_b32 v126, v151, v147, s49
    v_perm_b32 v127, v159, v155, s49
    v_mfma_f32_16x16x32_bf16 a[124:127], a[240:243], v[120:123], a[124:127]
    ds_read_b128 a[252:255], v10 offset:25600
    v_mfma_f32_16x16x32_bf16 a[140:143], a[216:219], v[124:127], a[140:143]
    ds_read_b128 a[180:183], v10 offset:26624
    v_mfma_f32_16x16x32_bf16 a[144:147], a[240:243], v[124:127], a[144:147]
    s_waitcnt vmcnt(11)
    s_barrier
    v_perm_b32 v128, v164, v160, s48
    v_perm_b32 v129, v172, v168, s48
    s_waitcnt lgkmcnt(2)
    v_mfma_f32_16x16x32_bf16 a[160:163], a[228:231], a[216:219], a[160:163]
    v_perm_b32 v130, v180, v176, s48
    v_perm_b32 v131, v188, v184, s48
    v_mfma_f32_16x16x32_bf16 a[164:167], a[228:231], a[240:243], a[164:167]
    v_perm_b32 v132, v164, v160, s49
    v_perm_b32 v133, v172, v168, s49
    s_waitcnt lgkmcnt(5)
    v_mfma_f32_16x16x32_bf16 a[0:3], a[244:247], v[128:131], a[0:3]
    v_perm_b32 v134, v180, v176, s49
    v_perm_b32 v135, v188, v184, s49
    s_waitcnt lgkmcnt(4)
    v_mfma_f32_16x16x32_bf16 a[4:7], a[248:251], v[128:131], a[4:7]
    v_perm_b32 v136, v165, v161, s48
    v_perm_b32 v137, v173, v169, s48
    v_mfma_f32_16x16x32_bf16 a[20:23], a[244:247], v[132:135], a[20:23]
    v_perm_b32 v138, v181, v177, s48
    v_perm_b32 v139, v189, v185, s48
    v_mfma_f32_16x16x32_bf16 a[24:27], a[248:251], v[132:135], a[24:27]
    v_perm_b32 v140, v165, v161, s49
    v_perm_b32 v141, v173, v169, s49
    v_mfma_f32_16x16x32_bf16 a[40:43], a[244:247], v[136:139], a[40:43]
    v_perm_b32 v142, v181, v177, s49
    v_perm_b32 v143, v189, v185, s49
    v_mfma_f32_16x16x32_bf16 a[44:47], a[248:251], v[136:139], a[44:47]
    v_perm_b32 v144, v166, v162, s48
    v_perm_b32 v145, v174, v170, s48
    v_mfma_f32_16x16x32_bf16 a[60:63], a[244:247], v[140:143], a[60:63]
    v_perm_b32 v146, v182, v178, s48
    v_perm_b32 v147, v190, v186, s48
    v_mfma_f32_16x16x32_bf16 a[64:67], a[248:251], v[140:143], a[64:67]
    v_perm_b32 v148, v166, v162, s49
    v_perm_b32 v149, v174, v170, s49
    v_mfma_f32_16x16x32_bf16 a[80:83], a[244:247], v[144:147], a[80:83]
    v_perm_b32 v150, v182, v178, s49
    v_perm_b32 v151, v190, v186, s49
    ds_read_b64_tr_b16 a[232:233], v11 offset:16384
    v_mfma_f32_16x16x32_bf16 a[84:87], a[248:251], v[144:147], a[84:87]
    v_perm_b32 v152, v167, v163, s48
    v_perm_b32 v153, v175, v171, s48
    ds_read_b64_tr_b16 a[234:235], v11 offset:18432
    v_mfma_f32_16x16x32_bf16 a[100:103], a[244:247], v[148:151], a[100:103]
    v_perm_b32 v154, v183, v179, s48
    v_perm_b32 v155, v191, v187, s48
    v_mfma_f32_16x16x32_bf16 a[104:107], a[248:251], v[148:151], a[104:107]
    v_perm_b32 v156, v167, v163, s49
    v_perm_b32 v157, v175, v171, s49
    v_mfma_f32_16x16x32_bf16 a[120:123], a[244:247], v[152:155], a[120:123]
    v_perm_b32 v158, v183, v179, s49
    v_perm_b32 v159, v191, v187, s49
    v_mfma_f32_16x16x32_bf16 a[124:127], a[248:251], v[152:155], a[124:127]
    ds_read_b128 a[184:187], v10 offset:7168
    v_mfma_f32_16x16x32_bf16 a[140:143], a[244:247], v[156:159], a[140:143]
    ds_read_b128 a[188:191], v10 offset:12288
    v_mfma_f32_16x16x32_bf16 a[144:147], a[248:251], v[156:159], a[144:147]
    s_waitcnt vmcnt(2)
    s_barrier
    v_perm_b32 v160, v196, v192, s48
    v_perm_b32 v161, v204, v200, s48
    s_waitcnt lgkmcnt(2)
    v_mfma_f32_16x16x32_bf16 a[160:163], a[232:235], a[244:247], a[160:163]
    v_perm_b32 v162, v212, v208, s48
    v_perm_b32 v163, v220, v216, s48
    v_mfma_f32_16x16x32_bf16 a[164:167], a[232:235], a[248:251], a[164:167]
    v_perm_b32 v164, v196, v192, s49
    v_perm_b32 v165, v204, v200, s49
    s_waitcnt lgkmcnt(5)
    v_mfma_f32_16x16x32_bf16 a[0:3], a[252:255], v[160:163], a[0:3]
    v_perm_b32 v166, v212, v208, s49
    v_perm_b32 v167, v220, v216, s49
    s_waitcnt lgkmcnt(4)
    v_mfma_f32_16x16x32_bf16 a[4:7], a[180:183], v[160:163], a[4:7]
    v_perm_b32 v168, v197, v193, s48
    v_perm_b32 v169, v205, v201, s48
    v_mfma_f32_16x16x32_bf16 a[20:23], a[252:255], v[164:167], a[20:23]
    v_perm_b32 v170, v213, v209, s48
    v_perm_b32 v171, v221, v217, s48
    v_mfma_f32_16x16x32_bf16 a[24:27], a[180:183], v[164:167], a[24:27]
    v_perm_b32 v172, v197, v193, s49
    v_perm_b32 v173, v205, v201, s49
    v_mfma_f32_16x16x32_bf16 a[40:43], a[252:255], v[168:171], a[40:43]
    v_perm_b32 v174, v213, v209, s49
    v_perm_b32 v175, v221, v217, s49
    v_mfma_f32_16x16x32_bf16 a[44:47], a[180:183], v[168:171], a[44:47]
    v_perm_b32 v176, v198, v194, s48
    v_perm_b32 v177, v206, v202, s48
    v_mfma_f32_16x16x32_bf16 a[60:63], a[252:255], v[172:175], a[60:63]
    v_perm_b32 v178, v214, v210, s48
    v_perm_b32 v179, v222, v218, s48
    v_mfma_f32_16x16x32_bf16 a[64:67], a[180:183], v[172:175], a[64:67]
    v_perm_b32 v180, v198, v194, s49
    v_perm_b32 v181, v206, v202, s49
    v_mfma_f32_16x16x32_bf16 a[80:83], a[252:255], v[176:179], a[80:83]
    v_perm_b32 v182, v214, v210, s49
    v_perm_b32 v183, v222, v218, s49
    ds_read_b64_tr_b16 a[236:237], v11 offset:20480
    v_mfma_f32_16x16x32_bf16 a[84:87], a[180:183], v[176:179], a[84:87]
    v_perm_b32 v184, v199, v195, s48
    v_perm_b32 v185, v207, v203, s48
    ds_read_b64_tr_b16 a[238:239], v11 offset:22528
    v_mfma_f32_16x16x32_bf16 a[100:103], a[252:255], v[180:183], a[100:103]
    v_perm_b32 v186, v215, v211, s48
    v_perm_b32 v187, v223, v219, s48
    v_mfma_f32_16x16x32_bf16 a[104:107], a[180:183], v[180:183], a[104:107]
    v_perm_b32 v188, v199, v195, s49
    v_perm_b32 v189, v207, v203, s49
    v_mfma_f32_16x16x32_bf16 a[120:123], a[252:255], v[184:187], a[120:123]
    v_perm_b32 v190, v215, v211, s49
    v_perm_b32 v191, v223, v219, s49
    v_mfma_f32_16x16x32_bf16 a[124:127], a[180:183], v[184:187], a[124:127]
    ds_read_b128 a[192:195], v10 offset:17408
    v_mfma_f32_16x16x32_bf16 a[140:143], a[252:255], v[188:191], a[140:143]
    ds_read_b128 a[196:199], v10 offset:22528
    v_mfma_f32_16x16x32_bf16 a[144:147], a[180:183], v[188:191], a[144:147]
    ds_read_b128 a[200:203], v10 offset:27648
    s_waitcnt lgkmcnt(3)
    v_mfma_f32_16x16x32_bf16 a[160:163], a[236:239], a[252:255], a[160:163]
    v_mfma_f32_16x16x32_bf16 a[164:167], a[236:239], a[180:183], a[164:167]
    s_waitcnt lgkmcnt(6)
    v_mfma_f32_16x16x32_bf16 a[8:11], a[184:187], v[32:35], a[8:11]
    v_mfma_f32_16x16x32_bf16 a[28:31], a[184:187], v[36:39], a[28:31]
    v_mfma_f32_16x16x32_bf16 a[48:51], a[184:187], v[40:43], a[48:51]
    v_mfma_f32_16x16x32_bf16 a[68:71], a[184:187], v[44:47], a[68:71]
    v_mfma_f32_16x16x32_bf16 a[88:91], a[184:187], v[48:51], a[88:91]
    v_accvgpr_read_b32 v240, a0
    v_accvgpr_read_b32 v241, a20
    v_mfma_f32_16x16x32_bf16 a[108:111], a[184:187], v[52:55], a[108:111]
    ds_read_b128 a[204:207], v10 offset:8192
    v_mfma_f32_16x16x32_bf16 a[128:131], a[184:187], v[56:59], a[128:131]
    v_accvgpr_read_b32 v242, a40
    v_accvgpr_read_b32 v243, a60
    v_mfma_f32_16x16x32_bf16 a[148:151], a[184:187], v[60:63], a[148:151]
    v_accvgpr_read_b32 v244, a80
    v_accvgpr_read_b32 v245, a100
    v_mfma_f32_16x16x32_bf16 a[168:171], a[220:223], a[184:187], a[168:171]
    v_accvgpr_read_b32 v246, a120
    v_accvgpr_read_b32 v247, a140
    s_waitcnt lgkmcnt(6)
    v_mfma_f32_16x16x32_bf16 a[8:11], a[188:191], v[64:67], a[8:11]
    v_cvt_pk_bf16_f32 v16, v240, v241
    v_cvt_pk_bf16_f32 v17, v242, v243
    v_mfma_f32_16x16x32_bf16 a[28:31], a[188:191], v[68:71], a[28:31]
    v_cvt_pk_bf16_f32 v18, v244, v245
    v_cvt_pk_bf16_f32 v19, v246, v247
    v_mfma_f32_16x16x32_bf16 a[48:51], a[188:191], v[72:75], a[48:51]
    buffer_store_dwordx4 v[16:19], v28, s[44:47], s76 offen offset:0 sc0 sc1
    v_mfma_f32_16x16x32_bf16 a[68:71], a[188:191], v[76:79], a[68:71]
    v_accvgpr_read_b32 v240, a1
    v_accvgpr_read_b32 v241, a21
    v_mfma_f32_16x16x32_bf16 a[88:91], a[188:191], v[80:83], a[88:91]
    v_accvgpr_read_b32 v242, a41
    v_accvgpr_read_b32 v243, a61
    v_mfma_f32_16x16x32_bf16 a[108:111], a[188:191], v[84:87], a[108:111]
    ds_read_b128 a[208:211], v10 offset:13312
    v_mfma_f32_16x16x32_bf16 a[128:131], a[188:191], v[88:91], a[128:131]
    v_accvgpr_read_b32 v244, a81
    v_accvgpr_read_b32 v245, a101
    v_mfma_f32_16x16x32_bf16 a[148:151], a[188:191], v[92:95], a[148:151]
    v_accvgpr_read_b32 v246, a121
    v_accvgpr_read_b32 v247, a141
    v_mfma_f32_16x16x32_bf16 a[168:171], a[224:227], a[188:191], a[168:171]
    v_cvt_pk_bf16_f32 v20, v240, v241
    v_cvt_pk_bf16_f32 v21, v242, v243
    s_waitcnt lgkmcnt(4)
    v_mfma_f32_16x16x32_bf16 a[8:11], a[192:195], v[96:99], a[8:11]
    v_cvt_pk_bf16_f32 v22, v244, v245
    v_cvt_pk_bf16_f32 v23, v246, v247
    v_mfma_f32_16x16x32_bf16 a[28:31], a[192:195], v[100:103], a[28:31]
    buffer_store_dwordx4 v[20:23], v28, s[44:47], s76 offen offset:1152 sc0 sc1
    v_mfma_f32_16x16x32_bf16 a[48:51], a[192:195], v[104:107], a[48:51]
    v_accvgpr_read_b32 v240, a2
    v_accvgpr_read_b32 v241, a22
    v_mfma_f32_16x16x32_bf16 a[68:71], a[192:195], v[108:111], a[68:71]
    v_accvgpr_read_b32 v242, a42
    v_accvgpr_read_b32 v243, a62
    v_mfma_f32_16x16x32_bf16 a[88:91], a[192:195], v[112:115], a[88:91]
    v_accvgpr_read_b32 v244, a82
    v_accvgpr_read_b32 v245, a102
    v_mfma_f32_16x16x32_bf16 a[108:111], a[192:195], v[116:119], a[108:111]
    ds_read_b128 a[212:215], v10 offset:18432
    v_mfma_f32_16x16x32_bf16 a[128:131], a[192:195], v[120:123], a[128:131]
    v_accvgpr_read_b32 v246, a122
    v_accvgpr_read_b32 v247, a142
    v_mfma_f32_16x16x32_bf16 a[148:151], a[192:195], v[124:127], a[148:151]
    v_cvt_pk_bf16_f32 v24, v240, v241
    v_cvt_pk_bf16_f32 v25, v242, v243
    v_mfma_f32_16x16x32_bf16 a[168:171], a[228:231], a[192:195], a[168:171]
    v_cvt_pk_bf16_f32 v26, v244, v245
    v_cvt_pk_bf16_f32 v27, v246, v247
    s_waitcnt lgkmcnt(4)
    v_mfma_f32_16x16x32_bf16 a[8:11], a[196:199], v[128:131], a[8:11]
    buffer_store_dwordx4 v[24:27], v28, s[44:47], s76 offen offset:2304 sc0 sc1
    v_mfma_f32_16x16x32_bf16 a[28:31], a[196:199], v[132:135], a[28:31]
    v_accvgpr_read_b32 v240, a3
    v_accvgpr_read_b32 v241, a23
    v_mfma_f32_16x16x32_bf16 a[48:51], a[196:199], v[136:139], a[48:51]
    v_accvgpr_read_b32 v242, a43
    v_accvgpr_read_b32 v243, a63
    v_mfma_f32_16x16x32_bf16 a[68:71], a[196:199], v[140:143], a[68:71]
    buffer_load_dword v249, v30, s[44:47], s96 offen offset:0 sc1
    v_mfma_f32_16x16x32_bf16 a[88:91], a[196:199], v[144:147], a[88:91]
    v_accvgpr_read_b32 v244, a83
    v_accvgpr_read_b32 v245, a103
    v_mfma_f32_16x16x32_bf16 a[108:111], a[196:199], v[148:151], a[108:111]
    ds_read_b128 a[216:219], v10 offset:23552
    v_mfma_f32_16x16x32_bf16 a[128:131], a[196:199], v[152:155], a[128:131]
    buffer_load_dword v249, v30, s[44:47], s96 offen offset:128 sc1
    v_mfma_f32_16x16x32_bf16 a[148:151], a[196:199], v[156:159], a[148:151]
    v_accvgpr_read_b32 v246, a123
    v_accvgpr_read_b32 v247, a143
    v_mfma_f32_16x16x32_bf16 a[168:171], a[232:235], a[196:199], a[168:171]
    v_cvt_pk_bf16_f32 v16, v240, v241
    v_cvt_pk_bf16_f32 v17, v242, v243
    s_waitcnt lgkmcnt(4)
    v_mfma_f32_16x16x32_bf16 a[8:11], a[200:203], v[160:163], a[8:11]
    buffer_load_dword v249, v30, s[44:47], s96 offen offset:256 sc1
    v_mfma_f32_16x16x32_bf16 a[28:31], a[200:203], v[164:167], a[28:31]
    v_cvt_pk_bf16_f32 v18, v244, v245
    v_cvt_pk_bf16_f32 v19, v246, v247
    v_mfma_f32_16x16x32_bf16 a[48:51], a[200:203], v[168:171], a[48:51]
    buffer_store_dwordx4 v[16:19], v28, s[44:47], s76 offen offset:3456 sc0 sc1
    v_mfma_f32_16x16x32_bf16 a[68:71], a[200:203], v[172:175], a[68:71]
    v_accvgpr_read_b32 v240, a160
    v_accvgpr_read_b32 v241, a161
    v_mfma_f32_16x16x32_bf16 a[88:91], a[200:203], v[176:179], a[88:91]
    v_accvgpr_read_b32 v242, a162
    v_accvgpr_read_b32 v243, a163
    v_mfma_f32_16x16x32_bf16 a[108:111], a[200:203], v[180:183], a[108:111]
    ds_read_b128 a[240:243], v10 offset:28672
    v_mfma_f32_16x16x32_bf16 a[128:131], a[200:203], v[184:187], a[128:131]
    v_cvt_pk_bf16_f32 v20, v240, v241
    v_cvt_pk_bf16_f32 v21, v242, v243
    v_mfma_f32_16x16x32_bf16 a[148:151], a[200:203], v[188:191], a[148:151]
    buffer_store_dwordx2 v[20:21], v29, s[44:47], s76 offen sc0 sc1
    v_mfma_f32_16x16x32_bf16 a[168:171], a[236:239], a[200:203], a[168:171]
    v_accvgpr_read_b32 v240, a4
    v_accvgpr_read_b32 v241, a24
    s_waitcnt lgkmcnt(4)
    v_mfma_f32_16x16x32_bf16 a[12:15], a[204:207], v[32:35], a[12:15]
    v_accvgpr_read_b32 v242, a44
    v_accvgpr_read_b32 v243, a64
    v_mfma_f32_16x16x32_bf16 a[32:35], a[204:207], v[36:39], a[32:35]
    v_accvgpr_read_b32 v244, a84
    v_accvgpr_read_b32 v245, a104
    v_mfma_f32_16x16x32_bf16 a[52:55], a[204:207], v[40:43], a[52:55]
    v_accvgpr_read_b32 v246, a124
    v_accvgpr_read_b32 v247, a144
    v_mfma_f32_16x16x32_bf16 a[72:75], a[204:207], v[44:47], a[72:75]
    v_cvt_pk_bf16_f32 v24, v240, v241
    v_cvt_pk_bf16_f32 v25, v242, v243
    v_mfma_f32_16x16x32_bf16 a[92:95], a[204:207], v[48:51], a[92:95]
    v_cvt_pk_bf16_f32 v26, v244, v245
    v_cvt_pk_bf16_f32 v27, v246, v247
    v_mfma_f32_16x16x32_bf16 a[112:115], a[204:207], v[52:55], a[112:115]
    ds_read_b128 a[244:247], v10 offset:9216
    v_mfma_f32_16x16x32_bf16 a[132:135], a[204:207], v[56:59], a[132:135]
    buffer_store_dwordx4 v[24:27], v28, s[44:47], s77 offen offset:0 sc0 sc1
    v_mfma_f32_16x16x32_bf16 a[152:155], a[204:207], v[60:63], a[152:155]
    v_accvgpr_read_b32 v240, a5
    v_accvgpr_read_b32 v241, a25
    v_mfma_f32_16x16x32_bf16 a[172:175], a[220:223], a[204:207], a[172:175]
    v_accvgpr_read_b32 v242, a45
    v_accvgpr_read_b32 v243, a65
    s_waitcnt lgkmcnt(4)
    v_mfma_f32_16x16x32_bf16 a[12:15], a[208:211], v[64:67], a[12:15]
    v_accvgpr_read_b32 v244, a85
    v_accvgpr_read_b32 v245, a105
    v_mfma_f32_16x16x32_bf16 a[32:35], a[208:211], v[68:71], a[32:35]
    v_accvgpr_read_b32 v246, a125
    v_accvgpr_read_b32 v247, a145
    v_mfma_f32_16x16x32_bf16 a[52:55], a[208:211], v[72:75], a[52:55]
    v_cvt_pk_bf16_f32 v16, v240, v241
    v_cvt_pk_bf16_f32 v17, v242, v243
    v_mfma_f32_16x16x32_bf16 a[72:75], a[208:211], v[76:79], a[72:75]
    v_cvt_pk_bf16_f32 v18, v244, v245
    v_cvt_pk_bf16_f32 v19, v246, v247
    v_mfma_f32_16x16x32_bf16 a[92:95], a[208:211], v[80:83], a[92:95]
    buffer_store_dwordx4 v[16:19], v28, s[44:47], s77 offen offset:1152 sc0 sc1
    v_mfma_f32_16x16x32_bf16 a[112:115], a[208:211], v[84:87], a[112:115]
    ds_read_b128 a[248:251], v10 offset:14336
    v_mfma_f32_16x16x32_bf16 a[132:135], a[208:211], v[88:91], a[132:135]
    v_accvgpr_read_b32 v240, a6
    v_accvgpr_read_b32 v241, a26
    v_mfma_f32_16x16x32_bf16 a[152:155], a[208:211], v[92:95], a[152:155]
    v_accvgpr_read_b32 v242, a46
    v_accvgpr_read_b32 v243, a66
    v_mfma_f32_16x16x32_bf16 a[172:175], a[224:227], a[208:211], a[172:175]
    v_accvgpr_read_b32 v244, a86
    v_accvgpr_read_b32 v245, a106
    s_waitcnt lgkmcnt(4)
    v_mfma_f32_16x16x32_bf16 a[12:15], a[212:215], v[96:99], a[12:15]
    v_accvgpr_read_b32 v246, a126
    v_accvgpr_read_b32 v247, a146
    v_mfma_f32_16x16x32_bf16 a[32:35], a[212:215], v[100:103], a[32:35]
    v_cvt_pk_bf16_f32 v20, v240, v241
    v_cvt_pk_bf16_f32 v21, v242, v243
    v_mfma_f32_16x16x32_bf16 a[52:55], a[212:215], v[104:107], a[52:55]
    v_cvt_pk_bf16_f32 v22, v244, v245
    v_cvt_pk_bf16_f32 v23, v246, v247
    v_mfma_f32_16x16x32_bf16 a[72:75], a[212:215], v[108:111], a[72:75]
    buffer_store_dwordx4 v[20:23], v28, s[44:47], s77 offen offset:2304 sc0 sc1
    v_mfma_f32_16x16x32_bf16 a[92:95], a[212:215], v[112:115], a[92:95]
    v_accvgpr_read_b32 v240, a7
    v_accvgpr_read_b32 v241, a27
    v_mfma_f32_16x16x32_bf16 a[112:115], a[212:215], v[116:119], a[112:115]
    ds_read_b128 a[252:255], v10 offset:19456
    v_mfma_f32_16x16x32_bf16 a[132:135], a[212:215], v[120:123], a[132:135]
    v_accvgpr_read_b32 v242, a47
    v_accvgpr_read_b32 v243, a67
    v_mfma_f32_16x16x32_bf16 a[152:155], a[212:215], v[124:127], a[152:155]
    v_accvgpr_read_b32 v244, a87
    v_accvgpr_read_b32 v245, a107
    v_mfma_f32_16x16x32_bf16 a[172:175], a[228:231], a[212:215], a[172:175]
    v_accvgpr_read_b32 v246, a127
    v_accvgpr_read_b32 v247, a147
    s_waitcnt lgkmcnt(4)
    v_mfma_f32_16x16x32_bf16 a[12:15], a[216:219], v[128:131], a[12:15]
    v_cvt_pk_bf16_f32 v24, v240, v241
    v_cvt_pk_bf16_f32 v25, v242, v243
    v_mfma_f32_16x16x32_bf16 a[32:35], a[216:219], v[132:135], a[32:35]
    v_cvt_pk_bf16_f32 v26, v244, v245
    v_cvt_pk_bf16_f32 v27, v246, v247
    v_mfma_f32_16x16x32_bf16 a[52:55], a[216:219], v[136:139], a[52:55]
    buffer_store_dwordx4 v[24:27], v28, s[44:47], s77 offen offset:3456 sc0 sc1
    v_mfma_f32_16x16x32_bf16 a[72:75], a[216:219], v[140:143], a[72:75]
    v_accvgpr_read_b32 v240, a164
    v_accvgpr_read_b32 v241, a165
    v_mfma_f32_16x16x32_bf16 a[92:95], a[216:219], v[144:147], a[92:95]
    v_accvgpr_read_b32 v242, a166
    v_accvgpr_read_b32 v243, a167
    v_mfma_f32_16x16x32_bf16 a[112:115], a[216:219], v[148:151], a[112:115]
    ds_read_b128 a[180:183], v10 offset:24576
    v_mfma_f32_16x16x32_bf16 a[132:135], a[216:219], v[152:155], a[132:135]
    v_cvt_pk_bf16_f32 v16, v240, v241
    v_cvt_pk_bf16_f32 v17, v242, v243
    v_mfma_f32_16x16x32_bf16 a[152:155], a[216:219], v[156:159], a[152:155]
    buffer_store_dwordx2 v[16:17], v29, s[44:47], s77 offen sc0 sc1
    v_mfma_f32_16x16x32_bf16 a[172:175], a[232:235], a[216:219], a[172:175]
    v_accvgpr_read_b32 v240, a8
    v_accvgpr_read_b32 v241, a28
    s_waitcnt lgkmcnt(4)
    v_mfma_f32_16x16x32_bf16 a[12:15], a[240:243], v[160:163], a[12:15]
    v_accvgpr_read_b32 v242, a48
    v_accvgpr_read_b32 v243, a68
    v_mfma_f32_16x16x32_bf16 a[32:35], a[240:243], v[164:167], a[32:35]
    v_accvgpr_read_b32 v244, a88
    v_accvgpr_read_b32 v245, a108
    v_mfma_f32_16x16x32_bf16 a[52:55], a[240:243], v[168:171], a[52:55]
    v_accvgpr_read_b32 v246, a128
    v_accvgpr_read_b32 v247, a148
    v_mfma_f32_16x16x32_bf16 a[72:75], a[240:243], v[172:175], a[72:75]
    v_cvt_pk_bf16_f32 v20, v240, v241
    v_cvt_pk_bf16_f32 v21, v242, v243
    v_mfma_f32_16x16x32_bf16 a[92:95], a[240:243], v[176:179], a[92:95]
    v_cvt_pk_bf16_f32 v22, v244, v245
    v_cvt_pk_bf16_f32 v23, v246, v247
    v_mfma_f32_16x16x32_bf16 a[112:115], a[240:243], v[180:183], a[112:115]
    ds_read_b128 a[184:187], v10 offset:29696
    v_mfma_f32_16x16x32_bf16 a[132:135], a[240:243], v[184:187], a[132:135]
    buffer_store_dwordx4 v[20:23], v28, s[44:47], s78 offen offset:0 sc0 sc1
    v_mfma_f32_16x16x32_bf16 a[152:155], a[240:243], v[188:191], a[152:155]
    v_accvgpr_read_b32 v240, a9
    v_accvgpr_read_b32 v241, a29
    v_mfma_f32_16x16x32_bf16 a[172:175], a[236:239], a[240:243], a[172:175]
    v_accvgpr_read_b32 v242, a49
    v_accvgpr_read_b32 v243, a69
    s_waitcnt lgkmcnt(4)
    v_mfma_f32_16x16x32_bf16 a[16:19], a[244:247], v[32:35], a[16:19]
    v_accvgpr_read_b32 v244, a89
    v_accvgpr_read_b32 v245, a109
    v_mfma_f32_16x16x32_bf16 a[36:39], a[244:247], v[36:39], a[36:39]
    v_accvgpr_read_b32 v246, a129
    v_accvgpr_read_b32 v247, a149
    v_mfma_f32_16x16x32_bf16 a[56:59], a[244:247], v[40:43], a[56:59]
    v_cvt_pk_bf16_f32 v24, v240, v241
    v_cvt_pk_bf16_f32 v25, v242, v243
    v_mfma_f32_16x16x32_bf16 a[76:79], a[244:247], v[44:47], a[76:79]
    v_cvt_pk_bf16_f32 v26, v244, v245
    v_cvt_pk_bf16_f32 v27, v246, v247
    v_mfma_f32_16x16x32_bf16 a[96:99], a[244:247], v[48:51], a[96:99]
    buffer_store_dwordx4 v[24:27], v28, s[44:47], s78 offen offset:1152 sc0 sc1
    v_mfma_f32_16x16x32_bf16 a[116:119], a[244:247], v[52:55], a[116:119]
    v_accvgpr_read_b32 v240, a10
    v_accvgpr_read_b32 v241, a30
    v_mfma_f32_16x16x32_bf16 a[136:139], a[244:247], v[56:59], a[136:139]
    v_accvgpr_read_b32 v242, a50
    v_accvgpr_read_b32 v243, a70
    v_mfma_f32_16x16x32_bf16 a[156:159], a[244:247], v[60:63], a[156:159]
    v_accvgpr_read_b32 v244, a90
    v_accvgpr_read_b32 v245, a110
    v_mfma_f32_16x16x32_bf16 a[176:179], a[220:223], a[244:247], a[176:179]
    v_accvgpr_read_b32 v246, a130
    v_accvgpr_read_b32 v247, a150
    s_waitcnt lgkmcnt(3)
    v_mfma_f32_16x16x32_bf16 a[16:19], a[248:251], v[64:67], a[16:19]
    v_cvt_pk_bf16_f32 v16, v240, v241
    v_cvt_pk_bf16_f32 v17, v242, v243
    v_mfma_f32_16x16x32_bf16 a[36:39], a[248:251], v[68:71], a[36:39]
    v_cvt_pk_bf16_f32 v18, v244, v245
    v_cvt_pk_bf16_f32 v19, v246, v247
    v_mfma_f32_16x16x32_bf16 a[56:59], a[248:251], v[72:75], a[56:59]
    buffer_store_dwordx4 v[16:19], v28, s[44:47], s78 offen offset:2304 sc0 sc1
    v_mfma_f32_16x16x32_bf16 a[76:79], a[248:251], v[76:79], a[76:79]
    v_accvgpr_read_b32 v240, a11
    v_accvgpr_read_b32 v241, a31
    v_mfma_f32_16x16x32_bf16 a[96:99], a[248:251], v[80:83], a[96:99]
    v_accvgpr_read_b32 v242, a51
    v_accvgpr_read_b32 v243, a71
    v_mfma_f32_16x16x32_bf16 a[116:119], a[248:251], v[84:87], a[116:119]
    v_accvgpr_read_b32 v244, a91
    v_accvgpr_read_b32 v245, a111
    v_mfma_f32_16x16x32_bf16 a[136:139], a[248:251], v[88:91], a[136:139]
    v_accvgpr_read_b32 v246, a131
    v_accvgpr_read_b32 v247, a151
    v_mfma_f32_16x16x32_bf16 a[156:159], a[248:251], v[92:95], a[156:159]
    v_cvt_pk_bf16_f32 v20, v240, v241
    v_cvt_pk_bf16_f32 v21, v242, v243
    v_mfma_f32_16x16x32_bf16 a[176:179], a[224:227], a[248:251], a[176:179]
    v_cvt_pk_bf16_f32 v22, v244, v245
    v_cvt_pk_bf16_f32 v23, v246, v247
    s_waitcnt lgkmcnt(2)
    v_mfma_f32_16x16x32_bf16 a[16:19], a[252:255], v[96:99], a[16:19]
    buffer_store_dwordx4 v[20:23], v28, s[44:47], s78 offen offset:3456 sc0 sc1
    v_mfma_f32_16x16x32_bf16 a[36:39], a[252:255], v[100:103], a[36:39]
    v_accvgpr_read_b32 v240, a168
    v_accvgpr_read_b32 v241, a169
    v_mfma_f32_16x16x32_bf16 a[56:59], a[252:255], v[104:107], a[56:59]
    v_accvgpr_read_b32 v242, a170
    v_accvgpr_read_b32 v243, a171
    v_mfma_f32_16x16x32_bf16 a[76:79], a[252:255], v[108:111], a[76:79]
    v_cvt_pk_bf16_f32 v24, v240, v241
    v_cvt_pk_bf16_f32 v25, v242, v243
    v_mfma_f32_16x16x32_bf16 a[96:99], a[252:255], v[112:115], a[96:99]
    buffer_store_dwordx2 v[24:25], v29, s[44:47], s78 offen sc0 sc1
    v_mfma_f32_16x16x32_bf16 a[116:119], a[252:255], v[116:119], a[116:119]
    v_accvgpr_read_b32 v240, a12
    v_accvgpr_read_b32 v241, a32
    v_mfma_f32_16x16x32_bf16 a[136:139], a[252:255], v[120:123], a[136:139]
    v_accvgpr_read_b32 v242, a52
    v_accvgpr_read_b32 v243, a72
    v_mfma_f32_16x16x32_bf16 a[156:159], a[252:255], v[124:127], a[156:159]
    v_accvgpr_read_b32 v244, a92
    v_accvgpr_read_b32 v245, a112
    v_mfma_f32_16x16x32_bf16 a[176:179], a[228:231], a[252:255], a[176:179]
    v_accvgpr_read_b32 v246, a132
    v_accvgpr_read_b32 v247, a152
    s_waitcnt lgkmcnt(1)
    v_mfma_f32_16x16x32_bf16 a[16:19], a[180:183], v[128:131], a[16:19]
    v_cvt_pk_bf16_f32 v16, v240, v241
    v_cvt_pk_bf16_f32 v17, v242, v243
    v_mfma_f32_16x16x32_bf16 a[36:39], a[180:183], v[132:135], a[36:39]
    v_cvt_pk_bf16_f32 v18, v244, v245
    v_cvt_pk_bf16_f32 v19, v246, v247
    v_mfma_f32_16x16x32_bf16 a[56:59], a[180:183], v[136:139], a[56:59]
    buffer_store_dwordx4 v[16:19], v28, s[44:47], s79 offen offset:0 sc0 sc1
    v_mfma_f32_16x16x32_bf16 a[76:79], a[180:183], v[140:143], a[76:79]
    v_accvgpr_read_b32 v240, a13
    v_accvgpr_read_b32 v241, a33
    v_mfma_f32_16x16x32_bf16 a[96:99], a[180:183], v[144:147], a[96:99]
    v_accvgpr_read_b32 v242, a53
    v_accvgpr_read_b32 v243, a73
    v_mfma_f32_16x16x32_bf16 a[116:119], a[180:183], v[148:151], a[116:119]
    v_accvgpr_read_b32 v244, a93
    v_accvgpr_read_b32 v245, a113
    v_mfma_f32_16x16x32_bf16 a[136:139], a[180:183], v[152:155], a[136:139]
    v_accvgpr_read_b32 v246, a133
    v_accvgpr_read_b32 v247, a153
    v_mfma_f32_16x16x32_bf16 a[156:159], a[180:183], v[156:159], a[156:159]
    v_cvt_pk_bf16_f32 v20, v240, v241
    v_cvt_pk_bf16_f32 v21, v242, v243
    v_mfma_f32_16x16x32_bf16 a[176:179], a[232:235], a[180:183], a[176:179]
    v_cvt_pk_bf16_f32 v22, v244, v245
    v_cvt_pk_bf16_f32 v23, v246, v247
    s_waitcnt lgkmcnt(0)
    v_mfma_f32_16x16x32_bf16 a[16:19], a[184:187], v[160:163], a[16:19]
    buffer_store_dwordx4 v[20:23], v28, s[44:47], s79 offen offset:1152 sc0 sc1
    v_mfma_f32_16x16x32_bf16 a[36:39], a[184:187], v[164:167], a[36:39]
    v_accvgpr_read_b32 v240, a14
    v_accvgpr_read_b32 v241, a34
    v_mfma_f32_16x16x32_bf16 a[56:59], a[184:187], v[168:171], a[56:59]
    v_accvgpr_read_b32 v242, a54
    v_accvgpr_read_b32 v243, a74
    v_mfma_f32_16x16x32_bf16 a[76:79], a[184:187], v[172:175], a[76:79]
    v_accvgpr_read_b32 v244, a94
    v_accvgpr_read_b32 v245, a114
    v_mfma_f32_16x16x32_bf16 a[96:99], a[184:187], v[176:179], a[96:99]
    v_accvgpr_read_b32 v246, a134
    v_accvgpr_read_b32 v247, a154
    v_mfma_f32_16x16x32_bf16 a[116:119], a[184:187], v[180:183], a[116:119]
    v_cvt_pk_bf16_f32 v24, v240, v241
    v_cvt_pk_bf16_f32 v25, v242, v243
    v_mfma_f32_16x16x32_bf16 a[136:139], a[184:187], v[184:187], a[136:139]
    v_cvt_pk_bf16_f32 v26, v244, v245
    v_cvt_pk_bf16_f32 v27, v246, v247
    v_mfma_f32_16x16x32_bf16 a[156:159], a[184:187], v[188:191], a[156:159]
    buffer_store_dwordx4 v[24:27], v28, s[44:47], s79 offen offset:2304 sc0 sc1
    v_mfma_f32_16x16x32_bf16 a[176:179], a[236:239], a[184:187], a[176:179]
    v_accvgpr_read_b32 v240, a15
    v_accvgpr_read_b32 v241, a35
    s_nop 7
    v_accvgpr_read_b32 v242, a55
    v_accvgpr_read_b32 v243, a75
    v_accvgpr_read_b32 v244, a95
    v_accvgpr_read_b32 v245, a115
    v_accvgpr_read_b32 v246, a135
    v_accvgpr_read_b32 v247, a155
    v_cvt_pk_bf16_f32 v16, v240, v241
    v_cvt_pk_bf16_f32 v17, v242, v243
    v_cvt_pk_bf16_f32 v18, v244, v245
    v_cvt_pk_bf16_f32 v19, v246, v247
    buffer_store_dwordx4 v[16:19], v28, s[44:47], s79 offen offset:3456 sc0 sc1
    v_accvgpr_read_b32 v240, a172
    v_accvgpr_read_b32 v241, a173
    v_accvgpr_read_b32 v242, a174
    v_accvgpr_read_b32 v243, a175
    v_cvt_pk_bf16_f32 v20, v240, v241
    v_cvt_pk_bf16_f32 v21, v242, v243
    buffer_store_dwordx2 v[20:21], v29, s[44:47], s79 offen sc0 sc1
    v_accvgpr_read_b32 v240, a16
    v_accvgpr_read_b32 v241, a36
    v_accvgpr_read_b32 v242, a56
    v_accvgpr_read_b32 v243, a76
    v_accvgpr_read_b32 v244, a96
    v_accvgpr_read_b32 v245, a116
    v_accvgpr_read_b32 v246, a136
    v_accvgpr_read_b32 v247, a156
    v_cvt_pk_bf16_f32 v24, v240, v241
    v_cvt_pk_bf16_f32 v25, v242, v243
    v_cvt_pk_bf16_f32 v26, v244, v245
    v_cvt_pk_bf16_f32 v27, v246, v247
    buffer_store_dwordx4 v[24:27], v28, s[44:47], s80 offen offset:0 sc0 sc1
    v_accvgpr_read_b32 v240, a17
    v_accvgpr_read_b32 v241, a37
    v_accvgpr_read_b32 v242, a57
    v_accvgpr_read_b32 v243, a77
    v_accvgpr_read_b32 v244, a97
    v_accvgpr_read_b32 v245, a117
    v_accvgpr_read_b32 v246, a137
    v_accvgpr_read_b32 v247, a157
    v_cvt_pk_bf16_f32 v16, v240, v241
    v_cvt_pk_bf16_f32 v17, v242, v243
    v_cvt_pk_bf16_f32 v18, v244, v245
    v_cvt_pk_bf16_f32 v19, v246, v247
    buffer_store_dwordx4 v[16:19], v28, s[44:47], s80 offen offset:1152 sc0 sc1
    v_accvgpr_read_b32 v240, a18
    v_accvgpr_read_b32 v241, a38
    v_accvgpr_read_b32 v242, a58
    v_accvgpr_read_b32 v243, a78
    v_accvgpr_read_b32 v244, a98
    v_accvgpr_read_b32 v245, a118
    v_accvgpr_read_b32 v246, a138
    v_accvgpr_read_b32 v247, a158
    v_cvt_pk_bf16_f32 v20, v240, v241
    v_cvt_pk_bf16_f32 v21, v242, v243
    v_cvt_pk_bf16_f32 v22, v244, v245
    v_cvt_pk_bf16_f32 v23, v246, v247
    buffer_store_dwordx4 v[20:23], v28, s[44:47], s80 offen offset:2304 sc0 sc1
    v_accvgpr_read_b32 v240, a19
    v_accvgpr_read_b32 v241, a39
    v_accvgpr_read_b32 v242, a59
    v_accvgpr_read_b32 v243, a79
    v_accvgpr_read_b32 v244, a99
    v_accvgpr_read_b32 v245, a119
    v_accvgpr_read_b32 v246, a139
    v_accvgpr_read_b32 v247, a159
    v_cvt_pk_bf16_f32 v24, v240, v241
    v_cvt_pk_bf16_f32 v25, v242, v243
    v_cvt_pk_bf16_f32 v26, v244, v245
    v_cvt_pk_bf16_f32 v27, v246, v247
    buffer_store_dwordx4 v[24:27], v28, s[44:47], s80 offen offset:3456 sc0 sc1
    v_accvgpr_read_b32 v240, a176
    v_accvgpr_read_b32 v241, a177
    v_accvgpr_read_b32 v242, a178
    v_accvgpr_read_b32 v243, a179
    v_cvt_pk_bf16_f32 v16, v240, v241
    v_cvt_pk_bf16_f32 v17, v242, v243
    buffer_store_dwordx2 v[16:17], v29, s[44:47], s80 offen sc0 sc1
    s_branch L_final
L_main_end:
    s_endpgm
.section .rodata,"a"
.p2align 6
.amdhsa_kernel parallel_sum__ssm_conv_s4d__dense_activation_silu__prompt_kernel
  .amdhsa_next_free_vgpr 512
  .amdhsa_next_free_sgpr 102
  .amdhsa_accum_offset 256
  .amdhsa_group_segment_fixed_size 0
  .amdhsa_kernarg_size 104
  .amdhsa_user_sgpr_count 2
  .amdhsa_user_sgpr_kernarg_segment_ptr 1
  .amdhsa_system_sgpr_workgroup_id_x 1
.end_amdhsa_kernel
```
